```python
import torch

def _softmax(x, axis=-1):
    return torch.softmax(x, dim=axis)

def _gelu(x):
    return torch.nn.functional.gelu(x, approximate='tanh')

def _silu(x):
    return torch.nn.functional.silu(x)

def _sigmoid(x):
    return torch.sigmoid(x)

def _layernorm(x, axis=-1, eps=1e-05):
    m = x.mean(dim=axis, keepdim=True)
    v = x.var(dim=axis, keepdim=True, unbiased=False)
    return (x - m) / torch.sqrt(v + eps)

def _scatter_add(tgt, idx, src, axis=0):
    return tgt.clone().index_add_(axis, idx, src)

def _segment_sum(src, seg, n):
    out = torch.zeros((n,) + src.shape[1:], dtype=src.dtype)
    return out.index_add_(0, seg, src)

def _pad(x, pw):
    flat = tuple((v for pair in reversed(pw) for v in pair))
    return torch.nn.functional.pad(x, flat)
kernel_name = 'sequential_preLN__spectral_fnet__mixer_gmlp__prompt'

def setup_inputs():

    _w = lambda a: (lambda t: t.to(torch.bfloat16) if t.is_floating_point() else t)(torch.as_tensor(a))

    def _A_setup():
        B, S, D = (1, 2048, 640)
        ns = torch.arange(S)[:, None] * torch.arange(S)[None, :]
        nd = torch.arange(D)[:, None] * torch.arange(D)[None, :]
        Ws_re = torch.cos(-2.0 * torch.pi * ns / S).to(float)
        Ws_im = torch.sin(-2.0 * torch.pi * ns / S).to(float)
        Wd_re = torch.cos(-2.0 * torch.pi * nd / D).to(float)
        Wd_im = torch.sin(-2.0 * torch.pi * nd / D).to(float)
        return {'x': _w((lambda *s: torch.randn(*s, dtype=torch.bfloat16) * 0.05)(B, S, D)), 'dft_seq_re': _w(Ws_re), 'dft_seq_im': _w(Ws_im), 'dft_hid_re': _w(Wd_re), 'dft_hid_im': _w(Wd_im)}
    _A_in = _A_setup()

    def _B_setup():
        B, S, D, F = (1, 2048, 640, 1536)
        Fh = F // 2
        return {'x': _w((lambda *s: torch.randn(*s, dtype=torch.bfloat16) * 0.05)(B, S, D)), 'w_in': _w((lambda *s: torch.randn(*s, dtype=torch.bfloat16) * 0.8)(D, 2 * Fh)), 'w_sp': _w(0.01 * (lambda *s: torch.randn(*s, dtype=torch.bfloat16) * 0.8)(S, S)), 'b_sp': _w(1.0 + 0.01 * (lambda *s: torch.randn(*s, dtype=torch.bfloat16) * 0.8)(S)), 'w_out': _w((lambda *s: torch.randn(*s, dtype=torch.bfloat16) * 0.8)(Fh, D))}
    _B_in = _B_setup()
    return {'A_x': _A_in['x'], 'A_dft_seq_re': _A_in['dft_seq_re'], 'A_dft_seq_im': _A_in['dft_seq_im'], 'A_dft_hid_re': _A_in['dft_hid_re'], 'A_dft_hid_im': _A_in['dft_hid_im'], 'B_x': _B_in['x'], 'B_w_in': _B_in['w_in'], 'B_w_sp': _B_in['w_sp'], 'B_b_sp': _B_in['b_sp'], 'B_w_out': _B_in['w_out']}

def reference(A_x, A_dft_seq_re, A_dft_seq_im, A_dft_hid_re, A_dft_hid_im, B_x, B_w_in, B_w_sp, B_b_sp, B_w_out):

    def _A_ref(x, dft_seq_re, dft_seq_im, dft_hid_re, dft_hid_im):
        a = torch.einsum('bsd,ed->bse', x, dft_hid_re)
        b = torch.einsum('bsd,ed->bse', x, dft_hid_im)
        y = torch.einsum('ts,bse->bte', dft_seq_re, a) - torch.einsum('ts,bse->bte', dft_seq_im, b)
        return y

    def _B_ref(x, w_in, w_sp, b_sp, w_out):
        B, S, D = x.shape
        F = w_in.shape[-1]
        Fh = F // 2
        z = _gelu(torch.einsum('bsd,df->bsf', x, w_in))
        z1 = z[..., :Fh].clone()
        z2 = _layernorm(z[..., Fh:], axis=-1)
        g = torch.einsum('ts,bsf->btf', w_sp, z2) + b_sp[None, :, None]
        return torch.einsum('bsf,fd->bsd', z1 * g, w_out)
    x = A_x
    h = x + _A_ref(_layernorm(x, axis=-1), A_dft_seq_re, A_dft_seq_im, A_dft_hid_re, A_dft_hid_im)
    h2 = h + _B_ref(_layernorm(h, axis=-1), B_w_in, B_w_sp, B_b_sp, B_w_out)
    return h2
```

```asm
; @launch grid=(256,1,1) block=(512,1,1) lds=163840
.amdgcn_target "amdgcn-amd-amdhsa--gfx950"
.text
.globl sequential_preLN__spectral_fnet__mixer_gmlp__prompt_kernel
.p2align 8
.type sequential_preLN__spectral_fnet__mixer_gmlp__prompt_kernel,@function
sequential_preLN__spectral_fnet__mixer_gmlp__prompt_kernel:
    s_cmp_ge_u32 s2, 256
    s_cbranch_scc1 END
    s_load_dwordx2 s[4:5], s[0:1], 0
    s_load_dwordx2 s[44:45], s[0:1], 96
    s_load_dwordx2 s[24:25], s[0:1], 48
    s_load_dwordx2 s[28:29], s[0:1], 56
    s_load_dwordx2 s[32:33], s[0:1], 64
    s_load_dwordx2 s[36:37], s[0:1], 72
    s_load_dwordx2 s[40:41], s[0:1], 80
    s_getpc_b64 s[48:49]
    s_mov_b32 s50, CODE_BYTES
    s_mov_b32 s51, 0x20000
    s_lshr_b32 s54, s2, 3
    s_lshl_b32 s72, s54, 7
    v_xor_b32 v3, 0x100, v0
    v_lshlrev_b32_e64 v3, 12, v3
    s_mov_b64 exec, 0xffff
    buffer_load_dword v190, v3, s[48:51], s72 offen
    s_mov_b64 exec, -1
    v_lshrrev_b32 v3, 6, v0
    v_and_b32 v1, 63, v0
    v_readfirstlane_b32 s3, v3
    s_mov_b32 s6, 2621440
    s_mov_b32 s7, 0x20000
    s_mov_b32 s46, 16777216
    s_mov_b32 s47, 0x20000
    s_mov_b32 s26, 1966080
    s_mov_b32 s27, 0x20000
    s_mov_b32 s30, 8388608
    s_mov_b32 s31, 0x20000
    s_mov_b32 s34, 4096
    s_mov_b32 s35, 0x20000
    s_mov_b32 s38, 983040
    s_mov_b32 s39, 0x20000
    s_mov_b32 s42, 2621440
    s_mov_b32 s43, 0x20000
    v_lshlrev_b32 v2, 4, v1
    s_and_b32 s53, s2, 7
    s_mov_b32 s55, 0xffff0000
    s_and_b32 s52, s3, 3
    s_lshl_b32 s56, s53, 2
    s_lshr_b32 s72, s54, 3
    s_add_u32 s56, s56, s72
    s_bfe_u32 s57, s54, 0x10002
    s_and_b32 s58, s54, 3
    s_lshl_b32 s72, s53, 2
    s_sub_u32 s73, 60, s72
    s_cmp_ge_u32 s54, 16
    s_cselect_b32 s59, s73, s72
    s_add_u32 s59, s59, s52
    s_and_b32 s60, s54, 15
    s_lshr_b32 s69, s54, 2
    s_lshl_b32 s72, s53, 3
    s_add_u32 s69, s69, s72
    s_and_b32 s70, s54, 3
    s_cmp_ge_u32 s3, 4
    s_cbranch_scc1 XPROG
    s_mov_b32 s87, 0
    s_lshl_b32 s71, s69, 3
    s_lshl_b32 s72, s52, 1
    s_add_u32 s71, s71, s72
    v_lshlrev_b32 v4, 2, v1
    s_mul_i32 s86, s52, 10272
    s_cmp_eq_u32 s71, 0
    s_cselect_b32 s80, -1, 0
    s_mov_b32 s81, 0
    s_add_u32 s72, s70, 0
    s_and_b32 s72, s72, 3
    s_mul_i32 s65, s72, 2560
    s_add_u32 s65, s65, s86
    s_lshr_b32 s73, s72, 1
    s_add_u32 s73, s73, s71
    s_mul_i32 s73, s73, 1280
    s_sub_u32 s74, 1310720, s73
    s_add_u32 s75, 1310720, s73
    s_sub_u32 s89, 2621440, s73
    s_cmp_eq_u32 s73, 0
    s_cselect_b32 s89, 655360, s89
    s_cselect_b32 s75, 1966080, s75
    s_bitcmp1_b32 s72, 0
    s_cselect_b32 s88, s74, s73
    s_cselect_b32 s89, s75, s89
    s_add_u32 s72, s70, 1
    s_and_b32 s72, s72, 3
    s_mul_i32 s66, s72, 2560
    s_add_u32 s66, s66, s86
    s_lshr_b32 s73, s72, 1
    s_add_u32 s73, s73, s71
    s_mul_i32 s73, s73, 1280
    s_sub_u32 s74, 1310720, s73
    s_add_u32 s75, 1310720, s73
    s_sub_u32 s91, 2621440, s73
    s_cmp_eq_u32 s73, 0
    s_cselect_b32 s91, 655360, s91
    s_cselect_b32 s75, 1966080, s75
    s_bitcmp1_b32 s72, 0
    s_cselect_b32 s90, s74, s73
    s_cselect_b32 s91, s75, s91
    s_add_u32 s72, s70, 2
    s_and_b32 s72, s72, 3
    s_mul_i32 s67, s72, 2560
    s_add_u32 s67, s67, s86
    s_lshr_b32 s73, s72, 1
    s_add_u32 s73, s73, s71
    s_mul_i32 s73, s73, 1280
    s_sub_u32 s74, 1310720, s73
    s_add_u32 s75, 1310720, s73
    s_sub_u32 s93, 2621440, s73
    s_cmp_eq_u32 s73, 0
    s_cselect_b32 s93, 655360, s93
    s_cselect_b32 s75, 1966080, s75
    s_bitcmp1_b32 s72, 0
    s_cselect_b32 s92, s74, s73
    s_cselect_b32 s93, s75, s93
    s_add_u32 s72, s70, 3
    s_and_b32 s72, s72, 3
    s_mul_i32 s68, s72, 2560
    s_add_u32 s68, s68, s86
    s_lshr_b32 s73, s72, 1
    s_add_u32 s73, s73, s71
    s_mul_i32 s73, s73, 1280
    s_sub_u32 s74, 1310720, s73
    s_add_u32 s75, 1310720, s73
    s_sub_u32 s95, 2621440, s73
    s_cmp_eq_u32 s73, 0
    s_cselect_b32 s95, 655360, s95
    s_cselect_b32 s75, 1966080, s75
    s_bitcmp1_b32 s72, 0
    s_cselect_b32 s94, s74, s73
    s_cselect_b32 s95, s75, s95
    s_waitcnt lgkmcnt(0)
    s_add_u32 m0, s65, 0
    s_nop 0
    buffer_load_dwordx4 v2, s[4:7], s88 offen lds
    buffer_load_dword v4, s[4:7], s88 offen offset:1024 lds
    s_add_u32 m0, s65, 1280
    s_nop 0
    buffer_load_dwordx4 v2, s[4:7], s89 offen lds
    buffer_load_dword v4, s[4:7], s89 offen offset:1024 lds
    s_add_u32 m0, s66, 0
    s_nop 0
    buffer_load_dwordx4 v2, s[4:7], s90 offen lds
    buffer_load_dword v4, s[4:7], s90 offen offset:1024 lds
    s_add_u32 m0, s66, 1280
    s_nop 0
    buffer_load_dwordx4 v2, s[4:7], s91 offen lds
    buffer_load_dword v4, s[4:7], s91 offen offset:1024 lds
    s_add_u32 m0, s67, 0
    s_nop 0
    buffer_load_dwordx4 v2, s[4:7], s92 offen lds
    buffer_load_dword v4, s[4:7], s92 offen offset:1024 lds
    s_add_u32 m0, s67, 1280
    s_nop 0
    buffer_load_dwordx4 v2, s[4:7], s93 offen lds
    buffer_load_dword v4, s[4:7], s93 offen offset:1024 lds
    s_add_u32 m0, s68, 0
    s_nop 0
    buffer_load_dwordx4 v2, s[4:7], s94 offen lds
    buffer_load_dword v4, s[4:7], s94 offen offset:1024 lds
    s_add_u32 m0, s68, 1280
    s_nop 0
    buffer_load_dwordx4 v2, s[4:7], s95 offen lds
    buffer_load_dword v4, s[4:7], s95 offen offset:1024 lds
    s_load_dword s96, s[44:45], 0
    v_mov_b32 v5, 144352
    v_mov_b32_e64 v6, 0
    ds_write_b32 v5, v6
    s_sub_u32 s64, s59, s52
    s_lshr_b32 s63, s54, 3
    s_and_b32 s62, s63, 1
    s_lshl_b32 s62, s62, 1
    s_add_u32 s64, s64, s62
    s_lshl_b32 s64, s64, 1
    s_add_u32 s64, s64, s52
    s_and_b32 s62, s54, 7
    s_sub_u32 s61, s64, s52
    s_lshr_b32 s61, s61, 1
    s_lshl_b32 s63, s63, 1
    s_add_u32 s63, s63, s62
    v_lshrrev_b32_e64 v10, 3, v1
    v_mul_u32_u24 v30, 8192, v10
    v_lshrrev_b32 v10, 4, v1
    v_and_b32 v11, 7, v1
    v_xor_b32_e64 v10, v10, v11
    v_lshl_add_u32 v30, v10, 4, v30
    v_xor_b32_e64 v31, 64, v30
    v_add_u32 v31, 65536, v31
    s_mov_b32 s87, s72
    v_and_b32 v9, 31, v1
    v_cmp_eq_u32 s[82:83], 0, v9
    v_cmp_eq_u32 s[84:85], 31, v9
    v_lshrrev_b32_e64 v10, 5, v1
    v_mul_u32_u24 v11, 5120, v10
    v_add_u32 v11, s86, v11
    v_mul_u32_u24 v9, 20, v9
    v_add_u32 v12, v11, v9
    v_sub_u32 v16, v11, v9
    v_add_u32 v16, 1260, v16
    v_add_u32 v13, 1280, v12
    v_add_u32 v17, 1280, v16
    v_add_u32 v14, 2560, v12
    v_add_u32 v18, 2560, v16
    v_add_u32 v15, 3840, v12
    v_add_u32 v19, 3840, v16
    v_cndmask_b32 v20, 0, 1.0, s[82:83]
    v_mul_u32_u24 v11, 640, v10
    v_add3_u32 v21, v11, v9, s86
    v_add_u32 v22, 1280, v21
    v_add_u32 v23, 2560, v21
    v_add_u32 v24, 3840, v21
    s_lshl_b32 s72, s52, 3
    s_add_u32 s72, s72, 144256
    v_lshl_add_u32 v25, v10, 2, s72
    s_mov_b32 s93, 0x3acccccd
    s_mov_b32 s94, 0x3a4ccccd
    s_mov_b32 s95, 0x3727c5ac
    s_waitcnt lgkmcnt(0)
    s_mul_i32 s96, s96, 0x2C9277B5
    s_add_u32 s96, s96, 0xAC564B05
    s_waitcnt vmcnt(0)
    s_sub_u32 s72, s59, s52
    s_lshl_b32 s72, s72, 2
    s_and_b32 s73, s54, 15
    s_add_u32 s72, s72, s73
    s_lshl_b32 s72, s72, 15
    s_lshl_b32 s73, s52, 13
    s_add_u32 s72, s72, s73
    s_bfe_u32 s73, s54, 0x10002
    s_lshl_b32 s73, s73, 1
    s_add_u32 s73, s73, 4
    v_bfe_u32 v10, v1, 4, 1
    v_bfe_u32 v11, v1, 3, 1
    v_sub_u32 v11, v10, v11
    v_add_u32 v11, s73, v11
    v_and_b32 v11, 3, v11
    v_lshlrev_b32 v10, 12, v10
    v_lshl_add_u32 v10, v11, 10, v10
    v_and_b32_e64 v11, 7, v1
    v_lshl_add_u32 v10, v11, 7, v10
    s_mov_b32 exec_hi, 0
    buffer_load_dword v40, v10, s[28:31], s72 offen
    s_mov_b32 exec_hi, -1
    ds_read2_b32 v[64:65], v12 offset0:0 offset1:1
    ds_read2_b32 v[74:75], v16 offset0:4 offset1:5
    ds_read2_b32 v[72:73], v16 offset0:2 offset1:3
    ds_read2_b32 v[66:67], v12 offset0:2 offset1:3
    ds_read2_b32 v[70:71], v16 offset0:0 offset1:1
    ds_read_b32 v68, v12 offset:16
    ds_read2_b32 v[76:77], v13 offset0:0 offset1:1
    ds_read2_b32 v[86:87], v17 offset0:4 offset1:5
    ds_read2_b32 v[84:85], v17 offset0:2 offset1:3
    ds_read2_b32 v[78:79], v13 offset0:2 offset1:3
    ds_read2_b32 v[82:83], v17 offset0:0 offset1:1
    ds_read_b32 v80, v13 offset:16
    ds_read2_b32 v[88:89], v14 offset0:0 offset1:1
    ds_read2_b32 v[98:99], v18 offset0:4 offset1:5
    ds_read2_b32 v[96:97], v18 offset0:2 offset1:3
    ds_read2_b32 v[90:91], v14 offset0:2 offset1:3
    ds_read2_b32 v[94:95], v18 offset0:0 offset1:1
    ds_read_b32 v92, v14 offset:16
    ds_read2_b32 v[100:101], v15 offset0:0 offset1:1
    ds_read2_b32 v[110:111], v19 offset0:4 offset1:5
    ds_read2_b32 v[108:109], v19 offset0:2 offset1:3
    ds_read2_b32 v[102:103], v15 offset0:2 offset1:3
    ds_read2_b32 v[106:107], v19 offset0:0 offset1:1
    ds_read_b32 v104, v15 offset:16
    s_waitcnt lgkmcnt(15)
    v_lshlrev_b32 v4, 16, v64
    v_and_b32 v5, s55, v64
    v_lshlrev_b32 v6, 16, v75
    v_and_b32_e64 v7, s55, v74
    v_cndmask_b32 v6, v6, 0, s[82:83]
    v_pk_add_f32 v[112:113], v[4:5], v[6:7]
    v_pk_add_f32 v[152:153], v[4:5], v[6:7] neg_lo:[0,1] neg_hi:[0,1]
    v_pk_mul_f32 v[56:57], v[112:113], v[112:113]
    v_pk_fma_f32 v[56:57], v[152:153], v[152:153], v[56:57]
    v_lshlrev_b32 v4, 16, v65
    v_and_b32 v5, s55, v65
    v_lshlrev_b32 v6, 16, v74
    v_and_b32 v7, s55, v73
    v_pk_add_f32 v[114:115], v[4:5], v[6:7]
    v_pk_add_f32 v[154:155], v[4:5], v[6:7] neg_lo:[0,1] neg_hi:[0,1]
    v_pk_add_f32 v[48:49], v[114:115], v[112:113]
    v_pk_fma_f32 v[56:57], v[114:115], v[114:115], v[56:57]
    v_pk_fma_f32 v[56:57], v[154:155], v[154:155], v[56:57]
    v_lshlrev_b32 v4, 16, v66
    v_and_b32 v5, s55, v66
    v_lshlrev_b32 v6, 16, v73
    v_and_b32 v7, s55, v72
    v_pk_add_f32 v[116:117], v[4:5], v[6:7]
    v_pk_add_f32 v[156:157], v[4:5], v[6:7] neg_lo:[0,1] neg_hi:[0,1]
    v_pk_add_f32 v[48:49], v[116:117], v[48:49]
    v_pk_fma_f32 v[56:57], v[116:117], v[116:117], v[56:57]
    v_pk_fma_f32 v[56:57], v[156:157], v[156:157], v[56:57]
    v_lshlrev_b32 v4, 16, v67
    v_and_b32 v5, s55, v67
    v_lshlrev_b32 v6, 16, v72
    v_and_b32 v7, s55, v71
    v_pk_add_f32 v[118:119], v[4:5], v[6:7]
    v_pk_add_f32 v[158:159], v[4:5], v[6:7] neg_lo:[0,1] neg_hi:[0,1]
    v_pk_add_f32 v[48:49], v[118:119], v[48:49]
    v_pk_fma_f32 v[56:57], v[118:119], v[118:119], v[56:57]
    v_pk_fma_f32 v[56:57], v[158:159], v[158:159], v[56:57]
    v_lshlrev_b32 v4, 16, v68
    v_and_b32 v5, s55, v68
    v_lshlrev_b32 v6, 16, v71
    v_and_b32 v7, s55, v70
    v_pk_add_f32 v[120:121], v[4:5], v[6:7]
    v_pk_add_f32 v[160:161], v[4:5], v[6:7] neg_lo:[0,1] neg_hi:[0,1]
    v_pk_add_f32 v[48:49], v[120:121], v[48:49]
    v_pk_fma_f32 v[56:57], v[120:121], v[120:121], v[56:57]
    v_pk_fma_f32 v[56:57], v[160:161], v[160:161], v[56:57]
    v_lshlrev_b32_e64 v26, 16, v70
    v_cndmask_b32 v26, 0, v26, s[84:85]
    v_add_f32 v48, v48, v49
    v_add_f32 v56, v56, v57
    v_add_f32 v48, v48, v26
    v_add_f32 v4, v26, v26
    v_fmac_f32 v56, v4, v26
    s_waitcnt lgkmcnt(12)
    v_lshlrev_b32 v4, 16, v76
    v_and_b32 v5, s55, v76
    v_lshlrev_b32 v6, 16, v87
    v_and_b32 v7, s55, v86
    v_cndmask_b32 v6, v6, 0, s[82:83]
    v_pk_add_f32 v[122:123], v[4:5], v[6:7]
    v_pk_add_f32 v[162:163], v[4:5], v[6:7] neg_lo:[0,1] neg_hi:[0,1]
    v_pk_mul_f32 v[58:59], v[122:123], v[122:123]
    v_pk_fma_f32 v[58:59], v[162:163], v[162:163], v[58:59]
    v_lshlrev_b32 v4, 16, v77
    v_and_b32 v5, s55, v77
    v_lshlrev_b32 v6, 16, v86
    v_and_b32 v7, s55, v85
    v_pk_add_f32 v[124:125], v[4:5], v[6:7]
    v_pk_add_f32 v[164:165], v[4:5], v[6:7] neg_lo:[0,1] neg_hi:[0,1]
    v_pk_add_f32 v[50:51], v[124:125], v[122:123]
    v_pk_fma_f32 v[58:59], v[124:125], v[124:125], v[58:59]
    v_pk_fma_f32 v[58:59], v[164:165], v[164:165], v[58:59]
    v_lshlrev_b32 v4, 16, v78
    v_and_b32 v5, s55, v78
    v_lshlrev_b32 v6, 16, v85
    v_and_b32 v7, s55, v84
    v_pk_add_f32 v[126:127], v[4:5], v[6:7]
    v_pk_add_f32 v[166:167], v[4:5], v[6:7] neg_lo:[0,1] neg_hi:[0,1]
    v_pk_add_f32 v[50:51], v[126:127], v[50:51]
    v_pk_fma_f32 v[58:59], v[126:127], v[126:127], v[58:59]
    v_pk_fma_f32 v[58:59], v[166:167], v[166:167], v[58:59]
    v_lshlrev_b32 v4, 16, v79
    v_and_b32 v5, s55, v79
    v_lshlrev_b32 v6, 16, v84
    v_and_b32 v7, s55, v83
    v_pk_add_f32 v[128:129], v[4:5], v[6:7]
    v_pk_add_f32 v[168:169], v[4:5], v[6:7] neg_lo:[0,1] neg_hi:[0,1]
    v_pk_add_f32 v[50:51], v[128:129], v[50:51]
    v_pk_fma_f32 v[58:59], v[128:129], v[128:129], v[58:59]
    v_pk_fma_f32 v[58:59], v[168:169], v[168:169], v[58:59]
    v_lshlrev_b32 v4, 16, v80
    v_and_b32 v5, s55, v80
    v_lshlrev_b32 v6, 16, v83
    v_and_b32 v7, s55, v82
    v_pk_add_f32 v[130:131], v[4:5], v[6:7]
    v_pk_add_f32 v[170:171], v[4:5], v[6:7] neg_lo:[0,1] neg_hi:[0,1]
    v_pk_add_f32 v[50:51], v[130:131], v[50:51]
    v_pk_fma_f32 v[58:59], v[130:131], v[130:131], v[58:59]
    v_pk_fma_f32 v[58:59], v[170:171], v[170:171], v[58:59]
    v_lshlrev_b32_e64 v27, 16, v82
    v_cndmask_b32 v27, 0, v27, s[84:85]
    v_add_f32 v50, v50, v51
    v_add_f32 v58, v58, v59
    v_add_f32 v50, v50, v27
    v_add_f32 v4, v27, v27
    v_fmac_f32 v58, v4, v27
    s_waitcnt lgkmcnt(6)
    v_lshlrev_b32 v4, 16, v88
    v_and_b32 v5, s55, v88
    v_lshlrev_b32 v6, 16, v99
    v_and_b32 v7, s55, v98
    v_cndmask_b32 v6, v6, 0, s[82:83]
    v_pk_add_f32 v[132:133], v[4:5], v[6:7]
    v_pk_add_f32 v[172:173], v[4:5], v[6:7] neg_lo:[0,1] neg_hi:[0,1]
    v_pk_mul_f32 v[60:61], v[132:133], v[132:133]
    v_pk_fma_f32 v[60:61], v[172:173], v[172:173], v[60:61]
    v_lshlrev_b32 v4, 16, v89
    v_and_b32 v5, s55, v89
    v_lshlrev_b32 v6, 16, v98
    v_and_b32 v7, s55, v97
    v_pk_add_f32 v[134:135], v[4:5], v[6:7]
    v_pk_add_f32 v[174:175], v[4:5], v[6:7] neg_lo:[0,1] neg_hi:[0,1]
    v_pk_add_f32 v[52:53], v[134:135], v[132:133]
    v_pk_fma_f32 v[60:61], v[134:135], v[134:135], v[60:61]
    v_pk_fma_f32 v[60:61], v[174:175], v[174:175], v[60:61]
    v_lshlrev_b32 v4, 16, v90
    v_and_b32 v5, s55, v90
    v_lshlrev_b32 v6, 16, v97
    v_and_b32 v7, s55, v96
    v_pk_add_f32 v[136:137], v[4:5], v[6:7]
    v_pk_add_f32 v[176:177], v[4:5], v[6:7] neg_lo:[0,1] neg_hi:[0,1]
    v_pk_add_f32 v[52:53], v[136:137], v[52:53]
    v_pk_fma_f32 v[60:61], v[136:137], v[136:137], v[60:61]
    v_pk_fma_f32 v[60:61], v[176:177], v[176:177], v[60:61]
    v_lshlrev_b32 v4, 16, v91
    v_and_b32 v5, s55, v91
    v_lshlrev_b32 v6, 16, v96
    v_and_b32 v7, s55, v95
    v_pk_add_f32 v[138:139], v[4:5], v[6:7]
    v_pk_add_f32 v[178:179], v[4:5], v[6:7] neg_lo:[0,1] neg_hi:[0,1]
    v_pk_add_f32 v[52:53], v[138:139], v[52:53]
    v_pk_fma_f32 v[60:61], v[138:139], v[138:139], v[60:61]
    v_pk_fma_f32 v[60:61], v[178:179], v[178:179], v[60:61]
    v_lshlrev_b32 v4, 16, v92
    v_and_b32 v5, s55, v92
    v_lshlrev_b32 v6, 16, v95
    v_and_b32 v7, s55, v94
    v_pk_add_f32 v[140:141], v[4:5], v[6:7]
    v_pk_add_f32 v[180:181], v[4:5], v[6:7] neg_lo:[0,1] neg_hi:[0,1]
    v_pk_add_f32 v[52:53], v[140:141], v[52:53]
    v_pk_fma_f32 v[60:61], v[140:141], v[140:141], v[60:61]
    v_pk_fma_f32 v[60:61], v[180:181], v[180:181], v[60:61]
    v_lshlrev_b32_e64 v28, 16, v94
    v_cndmask_b32 v28, 0, v28, s[84:85]
    v_add_f32 v52, v52, v53
    v_add_f32 v60, v60, v61
    v_add_f32 v52, v52, v28
    v_add_f32 v4, v28, v28
    v_fmac_f32 v60, v4, v28
    s_waitcnt lgkmcnt(0)
    v_lshlrev_b32 v4, 16, v100
    v_and_b32 v5, s55, v100
    v_lshlrev_b32 v6, 16, v111
    v_and_b32 v7, s55, v110
    v_cndmask_b32 v6, v6, 0, s[82:83]
    v_pk_add_f32 v[142:143], v[4:5], v[6:7]
    v_pk_add_f32 v[182:183], v[4:5], v[6:7] neg_lo:[0,1] neg_hi:[0,1]
    v_pk_mul_f32 v[62:63], v[142:143], v[142:143]
    v_pk_fma_f32 v[62:63], v[182:183], v[182:183], v[62:63]
    v_lshlrev_b32 v4, 16, v101
    v_and_b32 v5, s55, v101
    v_lshlrev_b32 v6, 16, v110
    v_and_b32 v7, s55, v109
    v_pk_add_f32 v[144:145], v[4:5], v[6:7]
    v_pk_add_f32 v[184:185], v[4:5], v[6:7] neg_lo:[0,1] neg_hi:[0,1]
    v_pk_add_f32 v[54:55], v[144:145], v[142:143]
    v_pk_fma_f32 v[62:63], v[144:145], v[144:145], v[62:63]
    v_pk_fma_f32 v[62:63], v[184:185], v[184:185], v[62:63]
    v_lshlrev_b32 v4, 16, v102
    v_and_b32 v5, s55, v102
    v_lshlrev_b32 v6, 16, v109
    v_and_b32 v7, s55, v108
    v_pk_add_f32 v[146:147], v[4:5], v[6:7]
    v_pk_add_f32 v[186:187], v[4:5], v[6:7] neg_lo:[0,1] neg_hi:[0,1]
    v_pk_add_f32 v[54:55], v[146:147], v[54:55]
    v_pk_fma_f32 v[62:63], v[146:147], v[146:147], v[62:63]
    v_pk_fma_f32 v[62:63], v[186:187], v[186:187], v[62:63]
    v_lshlrev_b32 v4, 16, v103
    v_and_b32 v5, s55, v103
    v_lshlrev_b32 v6, 16, v108
    v_and_b32 v7, s55, v107
    v_pk_add_f32 v[148:149], v[4:5], v[6:7]
    v_pk_add_f32 v[188:189], v[4:5], v[6:7] neg_lo:[0,1] neg_hi:[0,1]
    v_pk_add_f32 v[54:55], v[148:149], v[54:55]
    v_pk_fma_f32 v[62:63], v[148:149], v[148:149], v[62:63]
    v_pk_fma_f32 v[62:63], v[188:189], v[188:189], v[62:63]
    v_lshlrev_b32 v4, 16, v104
    v_and_b32 v5, s55, v104
    v_lshlrev_b32 v6, 16, v107
    v_and_b32 v7, s55, v106
    v_pk_add_f32 v[150:151], v[4:5], v[6:7]
    v_pk_add_f32 v[190:191], v[4:5], v[6:7] neg_lo:[0,1] neg_hi:[0,1]
    v_pk_add_f32 v[54:55], v[150:151], v[54:55]
    v_pk_fma_f32 v[62:63], v[150:151], v[150:151], v[62:63]
    v_pk_fma_f32 v[62:63], v[190:191], v[190:191], v[62:63]
    v_lshlrev_b32_e64 v29, 16, v106
    v_cndmask_b32 v29, 0, v29, s[84:85]
    v_add_f32 v54, v54, v55
    v_add_f32 v62, v62, v63
    v_add_f32 v54, v54, v29
    v_add_f32 v4, v29, v29
    v_fmac_f32_e64 v62, v4, v29
    v_add_f32_dpp v48, v48, v48 quad_perm:[1,0,3,2] row_mask:0xf bank_mask:0xf
    v_add_f32_dpp v50, v50, v50 quad_perm:[1,0,3,2] row_mask:0xf bank_mask:0xf
    v_add_f32_dpp v52, v52, v52 quad_perm:[1,0,3,2] row_mask:0xf bank_mask:0xf
    v_add_f32_dpp v54, v54, v54 quad_perm:[1,0,3,2] row_mask:0xf bank_mask:0xf
    v_add_f32_dpp v56, v56, v56 quad_perm:[1,0,3,2] row_mask:0xf bank_mask:0xf
    v_add_f32_dpp v58, v58, v58 quad_perm:[1,0,3,2] row_mask:0xf bank_mask:0xf
    v_add_f32_dpp v60, v60, v60 quad_perm:[1,0,3,2] row_mask:0xf bank_mask:0xf
    v_add_f32_dpp v62, v62, v62 quad_perm:[1,0,3,2] row_mask:0xf bank_mask:0xf
    v_add_f32_dpp v48, v48, v48 quad_perm:[2,3,0,1] row_mask:0xf bank_mask:0xf
    v_add_f32_dpp v50, v50, v50 quad_perm:[2,3,0,1] row_mask:0xf bank_mask:0xf
    v_add_f32_dpp v52, v52, v52 quad_perm:[2,3,0,1] row_mask:0xf bank_mask:0xf
    v_add_f32_dpp v54, v54, v54 quad_perm:[2,3,0,1] row_mask:0xf bank_mask:0xf
    v_add_f32_dpp v56, v56, v56 quad_perm:[2,3,0,1] row_mask:0xf bank_mask:0xf
    v_add_f32_dpp v58, v58, v58 quad_perm:[2,3,0,1] row_mask:0xf bank_mask:0xf
    v_add_f32_dpp v60, v60, v60 quad_perm:[2,3,0,1] row_mask:0xf bank_mask:0xf
    v_add_f32_dpp v62, v62, v62 quad_perm:[2,3,0,1] row_mask:0xf bank_mask:0xf
    v_add_f32_dpp v48, v48, v48 row_half_mirror row_mask:0xf bank_mask:0xf
    v_add_f32_dpp v50, v50, v50 row_half_mirror row_mask:0xf bank_mask:0xf
    v_add_f32_dpp v52, v52, v52 row_half_mirror row_mask:0xf bank_mask:0xf
    v_add_f32_dpp v54, v54, v54 row_half_mirror row_mask:0xf bank_mask:0xf
    v_add_f32_dpp v56, v56, v56 row_half_mirror row_mask:0xf bank_mask:0xf
    v_add_f32_dpp v58, v58, v58 row_half_mirror row_mask:0xf bank_mask:0xf
    v_add_f32_dpp v60, v60, v60 row_half_mirror row_mask:0xf bank_mask:0xf
    v_add_f32_dpp v62, v62, v62 row_half_mirror row_mask:0xf bank_mask:0xf
    v_add_f32_dpp v48, v48, v48 row_mirror row_mask:0xf bank_mask:0xf
    v_add_f32_dpp v50, v50, v50 row_mirror row_mask:0xf bank_mask:0xf
    v_add_f32_dpp v52, v52, v52 row_mirror row_mask:0xf bank_mask:0xf
    v_add_f32_dpp v54, v54, v54 row_mirror row_mask:0xf bank_mask:0xf
    v_add_f32_dpp v56, v56, v56 row_mirror row_mask:0xf bank_mask:0xf
    v_add_f32_dpp v58, v58, v58 row_mirror row_mask:0xf bank_mask:0xf
    v_add_f32_dpp v60, v60, v60 row_mirror row_mask:0xf bank_mask:0xf
    v_add_f32_dpp v62, v62, v62 row_mirror row_mask:0xf bank_mask:0xf
    v_mov_b32 v49, v48
    v_mov_b32 v51, v50
    v_mov_b32 v53, v52
    v_mov_b32 v55, v54
    v_mov_b32 v57, v56
    v_mov_b32 v59, v58
    v_mov_b32 v61, v60
    v_mov_b32 v63, v62
    v_permlane16_swap_b32 v48, v49
    v_permlane16_swap_b32 v50, v51
    v_permlane16_swap_b32 v52, v53
    v_permlane16_swap_b32 v54, v55
    v_permlane16_swap_b32 v56, v57
    v_permlane16_swap_b32 v58, v59
    v_permlane16_swap_b32 v60, v61
    v_permlane16_swap_b32 v62, v63
    v_add_f32 v48, v48, v49
    v_add_f32 v50, v50, v51
    v_add_f32 v52, v52, v53
    v_add_f32 v54, v54, v55
    v_add_f32 v56, v56, v57
    v_add_f32 v58, v58, v59
    v_add_f32 v60, v60, v61
    v_add_f32 v62, v62, v63
    v_mul_f32 v48, s93, v48
    v_mul_f32 v50, s93, v50
    v_mul_f32 v52, s93, v52
    v_mul_f32 v54, s93, v54
    v_mul_f32 v49, v48, v48
    v_mul_f32 v51, v50, v50
    v_mul_f32 v53, v52, v52
    v_mul_f32 v55, v54, v54
    v_fma_f32 v56, v56, s94, -v49
    v_fma_f32 v58, v58, s94, -v51
    v_fma_f32 v60, v60, s94, -v53
    v_fma_f32 v62, v62, s94, -v55
    v_add_f32 v56, s95, v56
    v_add_f32 v58, s95, v58
    v_add_f32 v60, s95, v60
    v_add_f32 v62, s95, v62
    v_rsq_f32 v56, v56
    v_rsq_f32 v58, v58
    v_rsq_f32 v60, v60
    v_rsq_f32 v62, v62
    v_fmac_f32 v112, v20, v48
    v_fmac_f32 v122, v20, v50
    v_fmac_f32 v132, v20, v52
    v_fmac_f32 v142, v20, v54
    v_sub_f32 v26, v26, v48
    v_sub_f32 v27, v27, v50
    v_sub_f32 v28, v28, v52
    v_sub_f32 v29, v29, v54
    v_cndmask_b32 v72, v58, 0, s[80:81]
    v_cndmask_b32 v74, v62, 0, s[80:81]
    v_cndmask_b32 v76, v56, 0, s[80:81]
    v_cndmask_b32 v78, v60, 0, s[80:81]
    v_cndmask_b32 v80, -v58, v58, s[80:81]
    v_mul_f32 v82, v56, v48
    v_mul_f32 v84, v60, v52
    v_fmac_f32 v82, v72, v50
    v_fmac_f32 v84, v74, v54
    v_mul_f32 v82, -2.0, v82
    v_mul_f32 v84, -2.0, v84
    v_pk_fma_f32 v[86:87], v[56:57], v[112:113], v[82:83] op_sel_hi:[0,1,0]
    v_pk_fma_f32 v[88:89], v[60:61], v[132:133], v[84:85] op_sel_hi:[0,1,0]
    v_pk_mul_f32 v[90:91], v[76:77], v[152:153] op_sel_hi:[0,1]
    v_pk_mul_f32 v[92:93], v[78:79], v[172:173] op_sel_hi:[0,1]
    v_pk_fma_f32 v[86:87], v[72:73], v[122:123], v[86:87] op_sel_hi:[0,1,1]
    v_pk_fma_f32 v[88:89], v[74:75], v[142:143], v[88:89] op_sel_hi:[0,1,1]
    v_pk_fma_f32 v[90:91], v[80:81], v[162:163], v[90:91] op_sel_hi:[0,1,1]
    v_pk_fma_f32 v[92:93], v[62:63], v[182:183], v[92:93] op_sel_hi:[0,1,1] neg_lo:[1,0,0] neg_hi:[1,0,0]
    v_pk_add_f32 v[94:95], v[86:87], v[88:89]
    v_pk_add_f32 v[96:97], v[86:87], v[88:89] neg_lo:[0,1] neg_hi:[0,1]
    v_pk_add_f32 v[98:99], v[90:91], v[92:93] neg_lo:[0,1] neg_hi:[0,1]
    v_pk_add_f32 v[100:101], v[90:91], v[92:93]
    v_cvt_pk_bf16_f32 v64, v94, v95
    v_cvt_pk_bf16_f32 v66, v96, v97
    v_cvt_pk_bf16_f32 v68, v98, v99
    v_cvt_pk_bf16_f32 v70, v100, v101
    v_pk_fma_f32 v[86:87], v[56:57], v[114:115], v[82:83] op_sel_hi:[0,1,0]
    v_pk_fma_f32 v[88:89], v[60:61], v[134:135], v[84:85] op_sel_hi:[0,1,0]
    v_pk_mul_f32 v[90:91], v[76:77], v[154:155] op_sel_hi:[0,1]
    v_pk_mul_f32 v[92:93], v[78:79], v[174:175] op_sel_hi:[0,1]
    v_pk_fma_f32 v[86:87], v[72:73], v[124:125], v[86:87] op_sel_hi:[0,1,1]
    v_pk_fma_f32 v[88:89], v[74:75], v[144:145], v[88:89] op_sel_hi:[0,1,1]
    v_pk_fma_f32 v[90:91], v[80:81], v[164:165], v[90:91] op_sel_hi:[0,1,1]
    v_pk_fma_f32 v[92:93], v[62:63], v[184:185], v[92:93] op_sel_hi:[0,1,1] neg_lo:[1,0,0] neg_hi:[1,0,0]
    v_pk_add_f32 v[94:95], v[86:87], v[88:89]
    v_pk_add_f32 v[96:97], v[86:87], v[88:89] neg_lo:[0,1] neg_hi:[0,1]
    v_pk_add_f32 v[98:99], v[90:91], v[92:93] neg_lo:[0,1] neg_hi:[0,1]
    v_pk_add_f32 v[100:101], v[90:91], v[92:93]
    v_cvt_pk_bf16_f32 v65, v94, v95
    v_cvt_pk_bf16_f32 v67, v96, v97
    v_cvt_pk_bf16_f32 v69, v98, v99
    v_cvt_pk_bf16_f32 v71, v100, v101
    ds_write2_b32 v21, v64, v65 offset0:0 offset1:1
    ds_write2_b32 v22, v66, v67 offset0:0 offset1:1
    ds_write2_b32 v23, v68, v69 offset0:0 offset1:1
    ds_write2_b32 v24, v70, v71 offset0:0 offset1:1
    v_pk_fma_f32 v[86:87], v[56:57], v[116:117], v[82:83] op_sel_hi:[0,1,0]
    v_pk_fma_f32 v[88:89], v[60:61], v[136:137], v[84:85] op_sel_hi:[0,1,0]
    v_pk_mul_f32 v[90:91], v[76:77], v[156:157] op_sel_hi:[0,1]
    v_pk_mul_f32 v[92:93], v[78:79], v[176:177] op_sel_hi:[0,1]
    v_pk_fma_f32 v[86:87], v[72:73], v[126:127], v[86:87] op_sel_hi:[0,1,1]
    v_pk_fma_f32 v[88:89], v[74:75], v[146:147], v[88:89] op_sel_hi:[0,1,1]
    v_pk_fma_f32 v[90:91], v[80:81], v[166:167], v[90:91] op_sel_hi:[0,1,1]
    v_pk_fma_f32 v[92:93], v[62:63], v[186:187], v[92:93] op_sel_hi:[0,1,1] neg_lo:[1,0,0] neg_hi:[1,0,0]
    v_pk_add_f32 v[94:95], v[86:87], v[88:89]
    v_pk_add_f32 v[96:97], v[86:87], v[88:89] neg_lo:[0,1] neg_hi:[0,1]
    v_pk_add_f32 v[98:99], v[90:91], v[92:93] neg_lo:[0,1] neg_hi:[0,1]
    v_pk_add_f32 v[100:101], v[90:91], v[92:93]
    v_cvt_pk_bf16_f32 v64, v94, v95
    v_cvt_pk_bf16_f32 v66, v96, v97
    v_cvt_pk_bf16_f32 v68, v98, v99
    v_cvt_pk_bf16_f32 v70, v100, v101
    v_pk_fma_f32 v[86:87], v[56:57], v[118:119], v[82:83] op_sel_hi:[0,1,0]
    v_pk_fma_f32 v[88:89], v[60:61], v[138:139], v[84:85] op_sel_hi:[0,1,0]
    v_pk_mul_f32 v[90:91], v[76:77], v[158:159] op_sel_hi:[0,1]
    v_pk_mul_f32 v[92:93], v[78:79], v[178:179] op_sel_hi:[0,1]
    v_pk_fma_f32 v[86:87], v[72:73], v[128:129], v[86:87] op_sel_hi:[0,1,1]
    v_pk_fma_f32 v[88:89], v[74:75], v[148:149], v[88:89] op_sel_hi:[0,1,1]
    v_pk_fma_f32 v[90:91], v[80:81], v[168:169], v[90:91] op_sel_hi:[0,1,1]
    v_pk_fma_f32 v[92:93], v[62:63], v[188:189], v[92:93] op_sel_hi:[0,1,1] neg_lo:[1,0,0] neg_hi:[1,0,0]
    v_pk_add_f32 v[94:95], v[86:87], v[88:89]
    v_pk_add_f32 v[96:97], v[86:87], v[88:89] neg_lo:[0,1] neg_hi:[0,1]
    v_pk_add_f32 v[98:99], v[90:91], v[92:93] neg_lo:[0,1] neg_hi:[0,1]
    v_pk_add_f32 v[100:101], v[90:91], v[92:93]
    v_cvt_pk_bf16_f32 v65, v94, v95
    v_cvt_pk_bf16_f32 v67, v96, v97
    v_cvt_pk_bf16_f32 v69, v98, v99
    v_cvt_pk_bf16_f32 v71, v100, v101
    ds_write2_b32 v21, v64, v65 offset0:2 offset1:3
    ds_write2_b32 v22, v66, v67 offset0:2 offset1:3
    ds_write2_b32 v23, v68, v69 offset0:2 offset1:3
    ds_write2_b32 v24, v70, v71 offset0:2 offset1:3
    v_pk_fma_f32 v[86:87], v[56:57], v[120:121], v[82:83] op_sel_hi:[0,1,0]
    v_pk_fma_f32 v[88:89], v[60:61], v[140:141], v[84:85] op_sel_hi:[0,1,0]
    v_pk_mul_f32 v[90:91], v[76:77], v[160:161] op_sel_hi:[0,1]
    v_pk_mul_f32 v[92:93], v[78:79], v[180:181] op_sel_hi:[0,1]
    v_pk_fma_f32 v[86:87], v[72:73], v[130:131], v[86:87] op_sel_hi:[0,1,1]
    v_pk_fma_f32 v[88:89], v[74:75], v[150:151], v[88:89] op_sel_hi:[0,1,1]
    v_pk_fma_f32 v[90:91], v[80:81], v[170:171], v[90:91] op_sel_hi:[0,1,1]
    v_pk_fma_f32 v[92:93], v[62:63], v[190:191], v[92:93] op_sel_hi:[0,1,1] neg_lo:[1,0,0] neg_hi:[1,0,0]
    v_pk_add_f32 v[94:95], v[86:87], v[88:89]
    v_pk_add_f32 v[96:97], v[86:87], v[88:89] neg_lo:[0,1] neg_hi:[0,1]
    v_pk_add_f32 v[98:99], v[90:91], v[92:93] neg_lo:[0,1] neg_hi:[0,1]
    v_pk_add_f32 v[100:101], v[90:91], v[92:93]
    v_cvt_pk_bf16_f32 v102, v94, v95
    v_cvt_pk_bf16_f32 v103, v96, v97
    v_cvt_pk_bf16_f32 v104, v98, v99
    v_cvt_pk_bf16_f32 v105, v100, v101
    ds_write_b32 v21, v102 offset:16
    ds_write_b32 v22, v103 offset:16
    ds_write_b32 v23, v104 offset:16
    ds_write_b32 v24, v105 offset:16
    v_mul_f32 v86, v56, v26
    v_mul_f32 v87, v60, v28
    v_fmac_f32 v86, v72, v27
    v_fmac_f32 v87, v74, v29
    v_add_f32 v88, v86, v87
    v_sub_f32_e64 v89, v86, v87
    s_mov_b64 exec, s[84:85]
    ds_write2_b32 v25, v88, v89 offset0:0 offset1:8
    s_mov_b64 exec, -1
    s_cmp_lg_u32 s71, 0
    s_cbranch_scc1 skip_1
    v_mul_f32 v82, v58, v50
    v_fmac_f32 v82, v62, v54
    v_mul_f32 v82, -2.0, v82
    v_pk_fma_f32 v[90:91], v[58:59], v[122:123], v[82:83] op_sel_hi:[0,1,0]
    v_pk_fma_f32 v[90:91], v[62:63], v[142:143], v[90:91] op_sel_hi:[0,1,1]
    v_cvt_pk_bf16_f32 v106, v90, v91
    v_pk_fma_f32 v[90:91], v[58:59], v[124:125], v[82:83] op_sel_hi:[0,1,0]
    v_pk_fma_f32 v[90:91], v[62:63], v[144:145], v[90:91] op_sel_hi:[0,1,1]
    v_cvt_pk_bf16_f32 v107, v90, v91
    v_pk_fma_f32 v[90:91], v[58:59], v[126:127], v[82:83] op_sel_hi:[0,1,0]
    v_pk_fma_f32 v[90:91], v[62:63], v[146:147], v[90:91] op_sel_hi:[0,1,1]
    v_cvt_pk_bf16_f32 v108, v90, v91
    v_pk_fma_f32 v[90:91], v[58:59], v[128:129], v[82:83] op_sel_hi:[0,1,0]
    v_pk_fma_f32 v[90:91], v[62:63], v[148:149], v[90:91] op_sel_hi:[0,1,1]
    v_cvt_pk_bf16_f32 v109, v90, v91
    v_pk_fma_f32 v[90:91], v[58:59], v[130:131], v[82:83] op_sel_hi:[0,1,0]
    v_pk_fma_f32 v[90:91], v[62:63], v[150:151], v[90:91] op_sel_hi:[0,1,1]
    v_cvt_pk_bf16_f32 v110, v90, v91
    v_mul_f32 v90, v58, v27
    v_fmac_f32 v90, v62, v29
    v_add_u32 v11, 143616, v9
    v_mov_b32 v10, 144320
    s_mov_b64 exec, s[80:81]
    ds_write2_b32 v11, v106, v107 offset0:0 offset1:1
    ds_write2_b32 v11, v108, v109 offset0:2 offset1:3
    ds_write_b32 v11, v110 offset:16
    s_mov_b64 exec, 0x80000000
    ds_write_b32 v10, v90
    s_mov_b64 exec, -1
skip_1:
    s_waitcnt lgkmcnt(0)
    s_barrier
    s_mov_b32 s72, s87
    s_lshl_b32 s99, s70, 6
    s_add_u32 s99, s99, s69
    v_and_b32 v10, 3, v1
    s_lshl_b32 s75, s52, 2
    v_add_u32 v10, s75, v10
    v_mul_u32_u24 v10, 2560, v10
    v_lshrrev_b32 v11, 2, v1
    v_lshlrev_b32 v11, 4, v11
    s_mul_i32 s75, s58, 160
    v_add_u32_e64 v11, s75, v11
    v_sub_u32 v28, 1264, v11
    v_add_u32 v29, 16, v28
    v_cmp_eq_u32 vcc, 0, v11
    v_mov_b32 v30, 640
    s_nop 0
    v_cndmask_b32 v29, v29, v30, vcc
    s_lshl_b32 s72, s56, 5
    s_add_u32 s73, s72, s57
    s_mul_i32 s73, s73, 1280
    s_sub_u32 s72, s57, s72
    s_add_u32 s72, s72, 2046
    s_mul_i32 s72, s72, 1280
    v_add_u32 v30, s73, v10
    v_sub_u32 v31, s72, v10
    v_add_u32 v10, v30, v11
    buffer_load_dwordx4 v[64:67], v10, s[4:7], 0 offen
    v_add_u32_e64 v10, v30, v28
    buffer_load_dwordx4 v[68:71], v10, s[4:7], 0 offen
    v_add_u32_e64 v10, v30, v29
    buffer_load_dword v72, v10, s[4:7], 0 offen
    v_add_u32_e64 v10, v31, v11
    buffer_load_dwordx4 v[76:79], v10, s[4:7], 0 offen
    v_add_u32_e64 v10, v31, v28
    buffer_load_dwordx4 v[80:83], v10, s[4:7], 0 offen
    v_add_u32_e64 v10, v31, v29
    buffer_load_dword v84, v10, s[4:7], 0 offen
    s_lshl_b32 s95, s53, 7
    s_add_u32 s95, s95, 32768
    v_and_b32 v28, 31, v1
    v_lshlrev_b32_e64 v28, 2, v28
    buffer_load_dword v29, v28, s[44:47], s95 offen sc1
    s_lshr_b32 s72, s52, 1
    s_lshl_b32 s72, s72, 1
    s_add_u32 s72, s72, s57
    s_lshl_b32 s72, s72, 2
    s_add_u32 s72, s72, s58
    s_lshl_b32 s72, s72, 1
    s_and_b32 s73, s52, 1
    s_add_u32 s72, s72, s73
    s_mul_i32 s72, s72, 40960
    s_add_u32 s72, s72, 65536
    s_add_u32 s73, s56, s58
    s_and_b32 s73, s73, 3
    s_lshl_b32 s73, s73, 1
    s_add_u32 s74, s73, 0
    s_and_b32 s74, s74, 7
    s_mul_i32 s74, s74, 5120
    s_add_u32 s80, s74, s72
    s_add_u32 s74, s73, 1
    s_and_b32 s74, s74, 7
    s_mul_i32 s74, s74, 5120
    s_add_u32 s81, s74, s72
    s_add_u32 s74, s73, 2
    s_and_b32 s74, s74, 7
    s_mul_i32 s74, s74, 5120
    s_add_u32 s82, s74, s72
    s_add_u32 s74, s73, 3
    s_and_b32 s74, s74, 7
    s_mul_i32 s74, s74, 5120
    s_add_u32 s83, s74, s72
    s_add_u32 s74, s73, 4
    s_and_b32 s74, s74, 7
    s_mul_i32 s74, s74, 5120
    s_add_u32 s84, s74, s72
    s_add_u32 s74, s73, 5
    s_and_b32 s74, s74, 7
    s_mul_i32 s74, s74, 5120
    s_add_u32 s85, s74, s72
    s_add_u32 s74, s73, 6
    s_and_b32 s74, s74, 7
    s_mul_i32 s74, s74, 5120
    s_add_u32 s86, s74, s72
    s_add_u32 s74, s73, 7
    s_and_b32 s74, s74, 7
    s_mul_i32 s74, s74, 5120
    s_add_u32 s87, s74, s72
    v_add_u32 v3, 4096, v2
    v_lshrrev_b32 v10, 2, v1
    v_lshlrev_b32_e64 v23, 5, v10
    s_mul_i32 s69, s58, 320
    s_mul_i32 s73, s57, 1280
    s_add_u32 s69, s69, s73
    s_add_u32 s69, s69, 1409024
    s_mul_i32 s74, s52, 9216
    s_add_u32 s74, s74, 123136
    v_and_b32 v12, 15, v1
    v_mul_u32_u24 v12, 336, v12
    v_lshrrev_b32_e64 v13, 4, v1
    v_lshl_add_u32 v12, v13, 4, v12
    v_add_u32 v16, s74, v12
    v_and_b32 v12, 3, v1
    s_lshl_b32 s75, s52, 2
    v_add_u32 v12, s75, v12
    v_mul_u32_u24 v13, 336, v12
    v_add_u32 v13, 123136, v13
    v_add_u32 v17, v13, v23
    s_cmp_eq_u32 s57, 0
    s_cselect_b32 s75, 336, 0
    s_cselect_b32 s76, 0, 0x80000000
    v_add_u32 v18, s75, v17
    v_lshlrev_b32 v13, 8, v10
    v_lshl_add_u32 v19, v12, 4, v13
    v_sub_u32_e64 v14, 15, v12
    v_lshl_add_u32 v20, v14, 4, v13
    v_lshlrev_b32 v24, 31, v1
    v_or_b32 v24, 1.0, v24
    v_xor_b32 v26, s76, v24
    v_lshlrev_b32 v21, 3, v12
    v_lshlrev_b32 v22, 3, v14
    s_cmp_eq_u32 s58, 0
    s_cselect_b32 s70, 15, 0
    s_mov_b32 s71, 0
    s_lshl_b32 s72, s56, 1
    s_add_u32 s72, s72, s57
    s_sub_u32 s73, 126, s72
    s_lshl_b32 s75, s57, 1
    s_add_u32 s73, s73, s75
    s_mul_i32 s75, s58, 2560
    s_add_u32 s75, s75, 1572864
    s_lshl_b32 s76, s58, 7
    s_add_u32 s76, s76, 4194304
    s_mul_i32 s88, s72, 20480
    s_add_u32 s88, s88, s75
    s_add_u32 s89, s88, 10240
    s_lshl_b32 s92, s72, 9
    s_add_u32 s92, s92, s76
    s_mul_i32 s90, s73, 20480
    s_add_u32 s90, s90, s75
    s_add_u32 s91, s90, 10240
    s_lshl_b32 s93, s73, 9
    s_add_u32 s93, s93, s76
    v_cmp_gt_u32 vcc, 40, v1
    v_mov_b32 v10, 0x40000000
    s_nop 0
    v_cndmask_b32 v19, v10, v19, vcc
    v_cndmask_b32 v20, v10, v20, vcc
    s_lshl_b32 s72, s56, 5
    s_add_u32 s73, s72, 32
    s_add_u32 s72, s72, s57
    v_and_b32 v120, 15, v1
    v_lshl_add_u32 v120, v120, 1, s72
    v_cvt_f32_u32 v120, v120
    v_cvt_f32_u32 v121, s73
    v_mul_f32 v120, 0x3a000000, v120
    v_mul_f32 v121, 0x3a000000, v121
    s_and_b32 s72, s52, 1
    s_lshl_b32 s72, s72, 8
    v_lshrrev_b32_e64 v128, 4, v1
    v_lshl_add_u32 v128, v128, 3, s72
    v_cvt_f32_u32 v128, v128
    s_cmp_ge_u32 s52, 2
    s_cselect_b32 s72, 0x3e800000, 0
    v_fma_f32 v122, v120, v128, s72
    v_fma_f32 v123, v121, v128, s72
    v_cos_f32 v124, v120
    v_cos_f32 v125, v121
    s_add_u32 s73, s56, s58
    s_lshl_b32 s73, s73, 1
    v_pk_add_f32 v[124:125], v[124:125], v[124:125]
    s_add_u32 s72, s73, 0
    s_and_b32 s72, s72, 7
    s_lshl_b32 s72, s72, 5
    v_cvt_f32_u32 v128, s72
    v_pk_fma_f32 v[88:89], v[120:121], v[128:129], v[122:123] op_sel_hi:[1,0,1]
    v_fract_f32 v88, v88
    v_fract_f32 v89, v89
    v_pk_add_f32 v[90:91], v[88:89], v[120:121]
    s_add_u32 s72, s73, 1
    s_and_b32 s72, s72, 7
    s_lshl_b32 s72, s72, 5
    v_cvt_f32_u32 v128, s72
    v_pk_fma_f32 v[104:105], v[120:121], v[128:129], v[122:123] op_sel_hi:[1,0,1]
    v_fract_f32 v104, v104
    v_fract_f32 v105, v105
    v_pk_add_f32 v[106:107], v[104:105], v[120:121]
    v_cos_f32 v88, v88
    v_cos_f32 v89, v89
    v_cos_f32 v90, v90
    v_cos_f32 v91, v91
    v_cos_f32 v104, v104
    v_cos_f32 v105, v105
    v_cos_f32 v106, v106
    v_cos_f32 v107, v107
    v_pk_fma_f32 v[92:93], v[124:125], v[90:91], v[88:89] neg_lo:[0,0,1] neg_hi:[0,0,1]
    v_pk_fma_f32 v[108:109], v[124:125], v[106:107], v[104:105] neg_lo:[0,0,1] neg_hi:[0,0,1]
    v_pk_fma_f32 v[94:95], v[124:125], v[92:93], v[90:91] neg_lo:[0,0,1] neg_hi:[0,0,1]
    v_pk_fma_f32 v[110:111], v[124:125], v[108:109], v[106:107] neg_lo:[0,0,1] neg_hi:[0,0,1]
    v_pk_fma_f32 v[96:97], v[124:125], v[94:95], v[92:93] neg_lo:[0,0,1] neg_hi:[0,0,1]
    v_pk_fma_f32 v[112:113], v[124:125], v[110:111], v[108:109] neg_lo:[0,0,1] neg_hi:[0,0,1]
    v_pk_fma_f32 v[98:99], v[124:125], v[96:97], v[94:95] neg_lo:[0,0,1] neg_hi:[0,0,1]
    v_pk_fma_f32 v[114:115], v[124:125], v[112:113], v[110:111] neg_lo:[0,0,1] neg_hi:[0,0,1]
    v_pk_fma_f32 v[100:101], v[124:125], v[98:99], v[96:97] neg_lo:[0,0,1] neg_hi:[0,0,1]
    v_pk_fma_f32 v[116:117], v[124:125], v[114:115], v[112:113] neg_lo:[0,0,1] neg_hi:[0,0,1]
    v_pk_fma_f32 v[102:103], v[124:125], v[100:101], v[98:99] neg_lo:[0,0,1] neg_hi:[0,0,1]
    v_pk_fma_f32 v[118:119], v[124:125], v[116:117], v[114:115] neg_lo:[0,0,1] neg_hi:[0,0,1]
    v_cvt_pk_bf16_f32 v130, v88, v90
    v_cvt_pk_bf16_f32 v134, v89, v91
    v_cvt_pk_bf16_f32 v131, v92, v94
    v_cvt_pk_bf16_f32 v135, v93, v95
    v_cvt_pk_bf16_f32 v132, v96, v98
    v_cvt_pk_bf16_f32 v136, v97, v99
    v_cvt_pk_bf16_f32 v133, v100, v102
    v_cvt_pk_bf16_f32 v137, v101, v103
    v_accvgpr_write_b32 a0, v130
    v_accvgpr_write_b32 a32, v134
    v_accvgpr_write_b32 a1, v131
    v_accvgpr_write_b32 a33, v135
    v_accvgpr_write_b32 a2, v132
    v_accvgpr_write_b32 a34, v136
    v_accvgpr_write_b32 a3, v133
    v_accvgpr_write_b32 a35, v137
    v_cvt_pk_bf16_f32 v130, v104, v106
    v_cvt_pk_bf16_f32 v134, v105, v107
    v_cvt_pk_bf16_f32 v131, v108, v110
    v_cvt_pk_bf16_f32 v135, v109, v111
    v_cvt_pk_bf16_f32 v132, v112, v114
    v_cvt_pk_bf16_f32 v136, v113, v115
    v_cvt_pk_bf16_f32 v133, v116, v118
    v_cvt_pk_bf16_f32 v137, v117, v119
    v_accvgpr_write_b32 a4, v130
    v_accvgpr_write_b32 a36, v134
    v_accvgpr_write_b32 a5, v131
    v_accvgpr_write_b32 a37, v135
    v_accvgpr_write_b32 a6, v132
    v_accvgpr_write_b32 a38, v136
    v_accvgpr_write_b32 a7, v133
    v_accvgpr_write_b32 a39, v137
    s_add_u32 s72, s73, 2
    s_and_b32 s72, s72, 7
    s_lshl_b32 s72, s72, 5
    v_cvt_f32_u32 v128, s72
    v_pk_fma_f32 v[88:89], v[120:121], v[128:129], v[122:123] op_sel_hi:[1,0,1]
    v_fract_f32 v88, v88
    v_fract_f32 v89, v89
    v_pk_add_f32 v[90:91], v[88:89], v[120:121]
    s_add_u32 s72, s73, 3
    s_and_b32 s72, s72, 7
    s_lshl_b32 s72, s72, 5
    v_cvt_f32_u32 v128, s72
    v_pk_fma_f32 v[104:105], v[120:121], v[128:129], v[122:123] op_sel_hi:[1,0,1]
    v_fract_f32 v104, v104
    v_fract_f32 v105, v105
    v_pk_add_f32 v[106:107], v[104:105], v[120:121]
    v_cos_f32 v88, v88
    v_cos_f32 v89, v89
    v_cos_f32 v90, v90
    v_cos_f32 v91, v91
    v_cos_f32 v104, v104
    v_cos_f32 v105, v105
    v_cos_f32 v106, v106
    v_cos_f32 v107, v107
    v_pk_fma_f32 v[92:93], v[124:125], v[90:91], v[88:89] neg_lo:[0,0,1] neg_hi:[0,0,1]
    v_pk_fma_f32 v[108:109], v[124:125], v[106:107], v[104:105] neg_lo:[0,0,1] neg_hi:[0,0,1]
    v_pk_fma_f32 v[94:95], v[124:125], v[92:93], v[90:91] neg_lo:[0,0,1] neg_hi:[0,0,1]
    v_pk_fma_f32 v[110:111], v[124:125], v[108:109], v[106:107] neg_lo:[0,0,1] neg_hi:[0,0,1]
    v_pk_fma_f32 v[96:97], v[124:125], v[94:95], v[92:93] neg_lo:[0,0,1] neg_hi:[0,0,1]
    v_pk_fma_f32 v[112:113], v[124:125], v[110:111], v[108:109] neg_lo:[0,0,1] neg_hi:[0,0,1]
    v_pk_fma_f32 v[98:99], v[124:125], v[96:97], v[94:95] neg_lo:[0,0,1] neg_hi:[0,0,1]
    v_pk_fma_f32 v[114:115], v[124:125], v[112:113], v[110:111] neg_lo:[0,0,1] neg_hi:[0,0,1]
    v_pk_fma_f32 v[100:101], v[124:125], v[98:99], v[96:97] neg_lo:[0,0,1] neg_hi:[0,0,1]
    v_pk_fma_f32 v[116:117], v[124:125], v[114:115], v[112:113] neg_lo:[0,0,1] neg_hi:[0,0,1]
    v_pk_fma_f32 v[102:103], v[124:125], v[100:101], v[98:99] neg_lo:[0,0,1] neg_hi:[0,0,1]
    v_pk_fma_f32 v[118:119], v[124:125], v[116:117], v[114:115] neg_lo:[0,0,1] neg_hi:[0,0,1]
    v_cvt_pk_bf16_f32 v130, v88, v90
    v_cvt_pk_bf16_f32 v134, v89, v91
    v_cvt_pk_bf16_f32 v131, v92, v94
    v_cvt_pk_bf16_f32 v135, v93, v95
    v_cvt_pk_bf16_f32 v132, v96, v98
    v_cvt_pk_bf16_f32 v136, v97, v99
    v_cvt_pk_bf16_f32 v133, v100, v102
    v_cvt_pk_bf16_f32 v137, v101, v103
    v_accvgpr_write_b32 a8, v130
    v_accvgpr_write_b32 a40, v134
    v_accvgpr_write_b32 a9, v131
    v_accvgpr_write_b32 a41, v135
    v_accvgpr_write_b32 a10, v132
    v_accvgpr_write_b32 a42, v136
    v_accvgpr_write_b32 a11, v133
    v_accvgpr_write_b32 a43, v137
    v_cvt_pk_bf16_f32 v130, v104, v106
    v_cvt_pk_bf16_f32 v134, v105, v107
    v_cvt_pk_bf16_f32 v131, v108, v110
    v_cvt_pk_bf16_f32 v135, v109, v111
    v_cvt_pk_bf16_f32 v132, v112, v114
    v_cvt_pk_bf16_f32 v136, v113, v115
    v_cvt_pk_bf16_f32 v133, v116, v118
    v_cvt_pk_bf16_f32 v137, v117, v119
    v_accvgpr_write_b32 a12, v130
    v_accvgpr_write_b32 a44, v134
    v_accvgpr_write_b32 a13, v131
    v_accvgpr_write_b32 a45, v135
    v_accvgpr_write_b32 a14, v132
    v_accvgpr_write_b32 a46, v136
    v_accvgpr_write_b32 a15, v133
    v_accvgpr_write_b32 a47, v137
    s_add_u32 s72, s73, 4
    s_and_b32 s72, s72, 7
    s_lshl_b32 s72, s72, 5
    v_cvt_f32_u32 v128, s72
    v_pk_fma_f32 v[88:89], v[120:121], v[128:129], v[122:123] op_sel_hi:[1,0,1]
    v_fract_f32 v88, v88
    v_fract_f32 v89, v89
    v_pk_add_f32 v[90:91], v[88:89], v[120:121]
    s_add_u32 s72, s73, 5
    s_and_b32 s72, s72, 7
    s_lshl_b32 s72, s72, 5
    v_cvt_f32_u32 v128, s72
    v_pk_fma_f32 v[104:105], v[120:121], v[128:129], v[122:123] op_sel_hi:[1,0,1]
    v_fract_f32 v104, v104
    v_fract_f32 v105, v105
    v_pk_add_f32 v[106:107], v[104:105], v[120:121]
    v_cos_f32 v88, v88
    v_cos_f32 v89, v89
    v_cos_f32 v90, v90
    v_cos_f32 v91, v91
    v_cos_f32 v104, v104
    v_cos_f32 v105, v105
    v_cos_f32 v106, v106
    v_cos_f32 v107, v107
    v_pk_fma_f32 v[92:93], v[124:125], v[90:91], v[88:89] neg_lo:[0,0,1] neg_hi:[0,0,1]
    v_pk_fma_f32 v[108:109], v[124:125], v[106:107], v[104:105] neg_lo:[0,0,1] neg_hi:[0,0,1]
    v_pk_fma_f32 v[94:95], v[124:125], v[92:93], v[90:91] neg_lo:[0,0,1] neg_hi:[0,0,1]
    v_pk_fma_f32 v[110:111], v[124:125], v[108:109], v[106:107] neg_lo:[0,0,1] neg_hi:[0,0,1]
    v_pk_fma_f32 v[96:97], v[124:125], v[94:95], v[92:93] neg_lo:[0,0,1] neg_hi:[0,0,1]
    v_pk_fma_f32 v[112:113], v[124:125], v[110:111], v[108:109] neg_lo:[0,0,1] neg_hi:[0,0,1]
    v_pk_fma_f32 v[98:99], v[124:125], v[96:97], v[94:95] neg_lo:[0,0,1] neg_hi:[0,0,1]
    v_pk_fma_f32 v[114:115], v[124:125], v[112:113], v[110:111] neg_lo:[0,0,1] neg_hi:[0,0,1]
    v_pk_fma_f32 v[100:101], v[124:125], v[98:99], v[96:97] neg_lo:[0,0,1] neg_hi:[0,0,1]
    v_pk_fma_f32 v[116:117], v[124:125], v[114:115], v[112:113] neg_lo:[0,0,1] neg_hi:[0,0,1]
    v_pk_fma_f32 v[102:103], v[124:125], v[100:101], v[98:99] neg_lo:[0,0,1] neg_hi:[0,0,1]
    v_pk_fma_f32 v[118:119], v[124:125], v[116:117], v[114:115] neg_lo:[0,0,1] neg_hi:[0,0,1]
    v_cvt_pk_bf16_f32 v130, v88, v90
    v_cvt_pk_bf16_f32 v134, v89, v91
    v_cvt_pk_bf16_f32 v131, v92, v94
    v_cvt_pk_bf16_f32 v135, v93, v95
    v_cvt_pk_bf16_f32 v132, v96, v98
    v_cvt_pk_bf16_f32 v136, v97, v99
    v_cvt_pk_bf16_f32 v133, v100, v102
    v_cvt_pk_bf16_f32 v137, v101, v103
    v_accvgpr_write_b32 a16, v130
    v_accvgpr_write_b32 a48, v134
    v_accvgpr_write_b32 a17, v131
    v_accvgpr_write_b32 a49, v135
    v_accvgpr_write_b32 a18, v132
    v_accvgpr_write_b32 a50, v136
    v_accvgpr_write_b32 a19, v133
    v_accvgpr_write_b32 a51, v137
    v_cvt_pk_bf16_f32 v130, v104, v106
    v_cvt_pk_bf16_f32 v134, v105, v107
    v_cvt_pk_bf16_f32 v131, v108, v110
    v_cvt_pk_bf16_f32 v135, v109, v111
    v_cvt_pk_bf16_f32 v132, v112, v114
    v_cvt_pk_bf16_f32 v136, v113, v115
    v_cvt_pk_bf16_f32 v133, v116, v118
    v_cvt_pk_bf16_f32 v137, v117, v119
    v_accvgpr_write_b32 a20, v130
    v_accvgpr_write_b32 a52, v134
    v_accvgpr_write_b32 a21, v131
    v_accvgpr_write_b32 a53, v135
    v_accvgpr_write_b32 a22, v132
    v_accvgpr_write_b32 a54, v136
    v_accvgpr_write_b32 a23, v133
    v_accvgpr_write_b32 a55, v137
    s_add_u32 s72, s73, 6
    s_and_b32 s72, s72, 7
    s_lshl_b32 s72, s72, 5
    v_cvt_f32_u32 v128, s72
    v_pk_fma_f32 v[88:89], v[120:121], v[128:129], v[122:123] op_sel_hi:[1,0,1]
    v_fract_f32 v88, v88
    v_fract_f32 v89, v89
    v_pk_add_f32 v[90:91], v[88:89], v[120:121]
    s_add_u32 s72, s73, 7
    s_and_b32 s72, s72, 7
    s_lshl_b32 s72, s72, 5
    v_cvt_f32_u32 v128, s72
    v_pk_fma_f32 v[104:105], v[120:121], v[128:129], v[122:123] op_sel_hi:[1,0,1]
    v_fract_f32 v104, v104
    v_fract_f32 v105, v105
    v_pk_add_f32 v[106:107], v[104:105], v[120:121]
    v_cos_f32 v88, v88
    v_cos_f32 v89, v89
    v_cos_f32 v90, v90
    v_cos_f32 v91, v91
    v_cos_f32 v104, v104
    v_cos_f32 v105, v105
    v_cos_f32 v106, v106
    v_cos_f32 v107, v107
    v_pk_fma_f32 v[92:93], v[124:125], v[90:91], v[88:89] neg_lo:[0,0,1] neg_hi:[0,0,1]
    v_pk_fma_f32 v[108:109], v[124:125], v[106:107], v[104:105] neg_lo:[0,0,1] neg_hi:[0,0,1]
    v_pk_fma_f32 v[94:95], v[124:125], v[92:93], v[90:91] neg_lo:[0,0,1] neg_hi:[0,0,1]
    v_pk_fma_f32 v[110:111], v[124:125], v[108:109], v[106:107] neg_lo:[0,0,1] neg_hi:[0,0,1]
    v_pk_fma_f32 v[96:97], v[124:125], v[94:95], v[92:93] neg_lo:[0,0,1] neg_hi:[0,0,1]
    v_pk_fma_f32 v[112:113], v[124:125], v[110:111], v[108:109] neg_lo:[0,0,1] neg_hi:[0,0,1]
    v_pk_fma_f32 v[98:99], v[124:125], v[96:97], v[94:95] neg_lo:[0,0,1] neg_hi:[0,0,1]
    v_pk_fma_f32 v[114:115], v[124:125], v[112:113], v[110:111] neg_lo:[0,0,1] neg_hi:[0,0,1]
    v_pk_fma_f32 v[100:101], v[124:125], v[98:99], v[96:97] neg_lo:[0,0,1] neg_hi:[0,0,1]
    v_pk_fma_f32 v[116:117], v[124:125], v[114:115], v[112:113] neg_lo:[0,0,1] neg_hi:[0,0,1]
    v_pk_fma_f32 v[102:103], v[124:125], v[100:101], v[98:99] neg_lo:[0,0,1] neg_hi:[0,0,1]
    v_pk_fma_f32 v[118:119], v[124:125], v[116:117], v[114:115] neg_lo:[0,0,1] neg_hi:[0,0,1]
    v_cvt_pk_bf16_f32 v130, v88, v90
    v_cvt_pk_bf16_f32 v134, v89, v91
    v_cvt_pk_bf16_f32 v131, v92, v94
    v_cvt_pk_bf16_f32 v135, v93, v95
    v_cvt_pk_bf16_f32 v132, v96, v98
    v_cvt_pk_bf16_f32 v136, v97, v99
    v_cvt_pk_bf16_f32 v133, v100, v102
    v_cvt_pk_bf16_f32 v137, v101, v103
    v_accvgpr_write_b32 a24, v130
    v_accvgpr_write_b32 a56, v134
    v_accvgpr_write_b32 a25, v131
    v_accvgpr_write_b32 a57, v135
    v_accvgpr_write_b32 a26, v132
    v_accvgpr_write_b32 a58, v136
    v_accvgpr_write_b32 a27, v133
    v_accvgpr_write_b32 a59, v137
    v_cvt_pk_bf16_f32 v130, v104, v106
    v_cvt_pk_bf16_f32 v134, v105, v107
    v_cvt_pk_bf16_f32 v131, v108, v110
    v_cvt_pk_bf16_f32 v135, v109, v111
    v_cvt_pk_bf16_f32 v132, v112, v114
    v_cvt_pk_bf16_f32 v136, v113, v115
    v_cvt_pk_bf16_f32 v133, v116, v118
    v_cvt_pk_bf16_f32 v137, v117, v119
    v_accvgpr_write_b32 a28, v130
    v_accvgpr_write_b32 a60, v134
    v_accvgpr_write_b32 a29, v131
    v_accvgpr_write_b32 a61, v135
    v_accvgpr_write_b32 a30, v132
    v_accvgpr_write_b32 a62, v136
    v_accvgpr_write_b32 a31, v133
    v_accvgpr_write_b32 a63, v137
    s_waitcnt vmcnt(7)
    s_barrier
    s_waitcnt vmcnt(0)
    s_mov_b32 s98, 0x100000
xp_2:
    v_subrev_u32 v30, s96, v29
    v_cmp_lt_u32 vcc, 15, v30
    s_cbranch_vccz xpd_3
    buffer_load_dword v29, v28, s[44:47], s95 offen sc1
    s_waitcnt vmcnt(0)
    s_sub_u32 s98, s98, 1
    s_cbranch_scc0 xp_2
xpd_3:
    v_readfirstlane_b32 s72, v30
    s_nop 1
    v_cmp_ne_u32 vcc, s72, v30
    s_nop 0
    s_cmp_eq_u64 vcc, 0
    s_cselect_b32 s97, 1, 0
    v_lshlrev_b32 v32, 16, v64
    v_and_b32 v33, s55, v64
    v_lshlrev_b32 v34, 16, v65
    v_and_b32 v35, s55, v65
    v_lshlrev_b32 v36, 16, v66
    v_and_b32 v37, s55, v66
    v_lshlrev_b32 v38, 16, v67
    v_and_b32 v39, s55, v67
    v_lshlrev_b32 v40, 16, v72
    v_and_b32 v41, s55, v71
    v_lshlrev_b32 v42, 16, v71
    v_and_b32 v43, s55, v70
    v_lshlrev_b32 v44, 16, v70
    v_and_b32 v45, s55, v69
    v_lshlrev_b32 v46, 16, v69
    v_and_b32 v47, s55, v68
    v_lshlrev_b32 v48, 16, v76
    v_and_b32 v49, s55, v76
    v_lshlrev_b32 v50, 16, v77
    v_and_b32 v51, s55, v77
    v_lshlrev_b32 v52, 16, v78
    v_and_b32 v53, s55, v78
    v_lshlrev_b32 v54, 16, v79
    v_and_b32 v55, s55, v79
    v_lshlrev_b32 v56, 16, v84
    v_and_b32 v57, s55, v83
    v_lshlrev_b32 v58, 16, v83
    v_and_b32 v59, s55, v82
    v_lshlrev_b32 v60, 16, v82
    v_and_b32 v61, s55, v81
    v_lshlrev_b32 v62, 16, v81
    v_and_b32_e64 v63, s55, v80
    s_cmp_lg_u32 s52, 1
    s_cbranch_scc1 skip_4
    s_lshl_b32 s99, s58, 6
    s_lshl_b32 s72, s99, 7
    s_add_u32 s72, s72, 1441792
    v_min_u32 v11, 63, v1
    v_lshlrev_b32 v11, 7, v11
    s_mov_b32 s98, 0x100000
poll_5:
    buffer_load_dword v10, v11, s[44:47], s72 offen sc1
    s_waitcnt vmcnt(0)
    v_cmp_ne_u32 vcc, s96, v10
    s_cbranch_vccz polled_6
    s_sub_u32 s98, s98, 1
    s_cbranch_scc0 poll_5
polled_6:
skip_4:
    s_cmp_lg_u32 s52, 2
    s_cbranch_scc1 skip_7
    s_mul_i32 s99, s60, 3
    s_add_u32 s99, s99, 48
    s_lshr_b32 s99, s99, 1
    s_mul_i32 s99, s99, 5
    s_lshl_b32 s72, s99, 7
    s_add_u32 s72, s72, 1441792
    v_min_u32 v11, 9, v1
    v_lshlrev_b32 v11, 7, v11
    s_mov_b32 s98, 0x100000
poll_8:
    buffer_load_dword v10, v11, s[44:47], s72 offen sc1
    s_waitcnt vmcnt(0)
    v_cmp_ne_u32 vcc, s96, v10
    s_cbranch_vccz polled_9
    s_sub_u32 s98, s98, 1
    s_cbranch_scc0 poll_8
polled_9:
skip_7:
    s_waitcnt lgkmcnt(0)
    s_barrier
    buffer_load_dwordx4 v[64:67], v2, s[44:47], s80 offen offset:0 sc1
    buffer_load_dwordx4 v[68:71], v2, s[44:47], s80 offen offset:1024 sc1
    buffer_load_dwordx4 v[72:75], v2, s[44:47], s80 offen offset:2048 sc1
    buffer_load_dwordx4 v[76:79], v2, s[44:47], s80 offen offset:3072 sc1
    buffer_load_dwordx4 v[80:83], v3, s[44:47], s80 offen offset:0 sc1
    buffer_load_dwordx4 v[84:87], v2, s[44:47], s81 offen offset:0 sc1
    buffer_load_dwordx4 v[88:91], v2, s[44:47], s81 offen offset:1024 sc1
    buffer_load_dwordx4 v[92:95], v2, s[44:47], s81 offen offset:2048 sc1
    buffer_load_dwordx4 v[96:99], v2, s[44:47], s81 offen offset:3072 sc1
    buffer_load_dwordx4 v[100:103], v3, s[44:47], s81 offen offset:0 sc1
    buffer_load_dwordx4 v[104:107], v2, s[44:47], s82 offen offset:0 sc1
    buffer_load_dwordx4 v[108:111], v2, s[44:47], s82 offen offset:1024 sc1
    buffer_load_dwordx4 v[112:115], v2, s[44:47], s82 offen offset:2048 sc1
    buffer_load_dwordx4 v[116:119], v2, s[44:47], s82 offen offset:3072 sc1
    buffer_load_dwordx4 v[120:123], v3, s[44:47], s82 offen offset:0 sc1
    buffer_load_dwordx4 v[124:127], v2, s[44:47], s83 offen offset:0 sc1
    buffer_load_dwordx4 v[128:131], v2, s[44:47], s83 offen offset:1024 sc1
    buffer_load_dwordx4 v[132:135], v2, s[44:47], s83 offen offset:2048 sc1
    buffer_load_dwordx4 v[136:139], v2, s[44:47], s83 offen offset:3072 sc1
    buffer_load_dwordx4 v[140:143], v3, s[44:47], s83 offen offset:0 sc1
    buffer_load_dwordx4 v[184:187], v23, s[44:47], s69 offen sc1
    buffer_load_dwordx4 v[188:191], v23, s[44:47], s69 offen offset:16 sc1
    s_waitcnt vmcnt(21)
    v_mfma_f32_16x16x32_bf16 v[144:147], v[64:67], a[0:3], 0
    v_mfma_f32_16x16x32_bf16 v[164:167], v[64:67], a[32:35], 0
    s_waitcnt vmcnt(20)
    v_mfma_f32_16x16x32_bf16 v[148:151], v[68:71], a[0:3], 0
    v_mfma_f32_16x16x32_bf16 v[168:171], v[68:71], a[32:35], 0
    s_waitcnt vmcnt(19)
    v_mfma_f32_16x16x32_bf16 v[152:155], v[72:75], a[0:3], 0
    v_mfma_f32_16x16x32_bf16 v[172:175], v[72:75], a[32:35], 0
    s_waitcnt vmcnt(18)
    v_mfma_f32_16x16x32_bf16 v[156:159], v[76:79], a[0:3], 0
    v_mfma_f32_16x16x32_bf16 v[176:179], v[76:79], a[32:35], 0
    s_waitcnt vmcnt(17)
    v_mfma_f32_16x16x32_bf16 v[160:163], v[80:83], a[0:3], 0
    v_mfma_f32_16x16x32_bf16 v[180:183], v[80:83], a[32:35], 0
    buffer_load_dwordx4 v[64:67], v2, s[44:47], s84 offen offset:0 sc1
    buffer_load_dwordx4 v[68:71], v2, s[44:47], s84 offen offset:1024 sc1
    buffer_load_dwordx4 v[72:75], v2, s[44:47], s84 offen offset:2048 sc1
    buffer_load_dwordx4 v[76:79], v2, s[44:47], s84 offen offset:3072 sc1
    buffer_load_dwordx4 v[80:83], v3, s[44:47], s84 offen offset:0 sc1
    s_waitcnt vmcnt(21)
    v_mfma_f32_16x16x32_bf16 v[144:147], v[84:87], a[4:7], v[144:147]
    v_mfma_f32_16x16x32_bf16 v[164:167], v[84:87], a[36:39], v[164:167]
    s_waitcnt vmcnt(20)
    v_mfma_f32_16x16x32_bf16 v[148:151], v[88:91], a[4:7], v[148:151]
    v_mfma_f32_16x16x32_bf16 v[168:171], v[88:91], a[36:39], v[168:171]
    s_waitcnt vmcnt(19)
    v_mfma_f32_16x16x32_bf16 v[152:155], v[92:95], a[4:7], v[152:155]
    v_mfma_f32_16x16x32_bf16 v[172:175], v[92:95], a[36:39], v[172:175]
    s_waitcnt vmcnt(18)
    v_mfma_f32_16x16x32_bf16 v[156:159], v[96:99], a[4:7], v[156:159]
    v_mfma_f32_16x16x32_bf16 v[176:179], v[96:99], a[36:39], v[176:179]
    s_waitcnt vmcnt(17)
    v_mfma_f32_16x16x32_bf16 v[160:163], v[100:103], a[4:7], v[160:163]
    v_mfma_f32_16x16x32_bf16 v[180:183], v[100:103], a[36:39], v[180:183]
    buffer_load_dwordx4 v[84:87], v2, s[44:47], s85 offen offset:0 sc1
    buffer_load_dwordx4 v[88:91], v2, s[44:47], s85 offen offset:1024 sc1
    buffer_load_dwordx4 v[92:95], v2, s[44:47], s85 offen offset:2048 sc1
    buffer_load_dwordx4 v[96:99], v2, s[44:47], s85 offen offset:3072 sc1
    buffer_load_dwordx4 v[100:103], v3, s[44:47], s85 offen offset:0 sc1
    s_waitcnt vmcnt(21)
    v_mfma_f32_16x16x32_bf16 v[144:147], v[104:107], a[8:11], v[144:147]
    v_mfma_f32_16x16x32_bf16 v[164:167], v[104:107], a[40:43], v[164:167]
    s_waitcnt vmcnt(20)
    v_mfma_f32_16x16x32_bf16 v[148:151], v[108:111], a[8:11], v[148:151]
    v_mfma_f32_16x16x32_bf16 v[168:171], v[108:111], a[40:43], v[168:171]
    s_waitcnt vmcnt(19)
    v_mfma_f32_16x16x32_bf16 v[152:155], v[112:115], a[8:11], v[152:155]
    v_mfma_f32_16x16x32_bf16 v[172:175], v[112:115], a[40:43], v[172:175]
    s_waitcnt vmcnt(18)
    v_mfma_f32_16x16x32_bf16 v[156:159], v[116:119], a[8:11], v[156:159]
    v_mfma_f32_16x16x32_bf16 v[176:179], v[116:119], a[40:43], v[176:179]
    s_waitcnt vmcnt(17)
    v_mfma_f32_16x16x32_bf16 v[160:163], v[120:123], a[8:11], v[160:163]
    v_mfma_f32_16x16x32_bf16 v[180:183], v[120:123], a[40:43], v[180:183]
    buffer_load_dwordx4 v[104:107], v2, s[44:47], s86 offen offset:0 sc1
    buffer_load_dwordx4 v[108:111], v2, s[44:47], s86 offen offset:1024 sc1
    buffer_load_dwordx4 v[112:115], v2, s[44:47], s86 offen offset:2048 sc1
    buffer_load_dwordx4 v[116:119], v2, s[44:47], s86 offen offset:3072 sc1
    buffer_load_dwordx4 v[120:123], v3, s[44:47], s86 offen offset:0 sc1
    s_waitcnt vmcnt(21)
    v_mfma_f32_16x16x32_bf16 v[144:147], v[124:127], a[12:15], v[144:147]
    v_mfma_f32_16x16x32_bf16 v[164:167], v[124:127], a[44:47], v[164:167]
    s_waitcnt vmcnt(20)
    v_mfma_f32_16x16x32_bf16 v[148:151], v[128:131], a[12:15], v[148:151]
    v_mfma_f32_16x16x32_bf16 v[168:171], v[128:131], a[44:47], v[168:171]
    s_waitcnt vmcnt(19)
    v_mfma_f32_16x16x32_bf16 v[152:155], v[132:135], a[12:15], v[152:155]
    v_mfma_f32_16x16x32_bf16 v[172:175], v[132:135], a[44:47], v[172:175]
    s_waitcnt vmcnt(18)
    v_mfma_f32_16x16x32_bf16 v[156:159], v[136:139], a[12:15], v[156:159]
    v_mfma_f32_16x16x32_bf16 v[176:179], v[136:139], a[44:47], v[176:179]
    s_waitcnt vmcnt(17)
    v_mfma_f32_16x16x32_bf16 v[160:163], v[140:143], a[12:15], v[160:163]
    v_mfma_f32_16x16x32_bf16 v[180:183], v[140:143], a[44:47], v[180:183]
    buffer_load_dwordx4 v[124:127], v2, s[44:47], s87 offen offset:0 sc1
    buffer_load_dwordx4 v[128:131], v2, s[44:47], s87 offen offset:1024 sc1
    buffer_load_dwordx4 v[132:135], v2, s[44:47], s87 offen offset:2048 sc1
    buffer_load_dwordx4 v[136:139], v2, s[44:47], s87 offen offset:3072 sc1
    buffer_load_dwordx4 v[140:143], v3, s[44:47], s87 offen offset:0 sc1
    s_waitcnt vmcnt(19)
    v_mfma_f32_16x16x32_bf16 v[144:147], v[64:67], a[16:19], v[144:147]
    v_mfma_f32_16x16x32_bf16 v[164:167], v[64:67], a[48:51], v[164:167]
    s_waitcnt vmcnt(18)
    v_mfma_f32_16x16x32_bf16 v[148:151], v[68:71], a[16:19], v[148:151]
    v_mfma_f32_16x16x32_bf16 v[168:171], v[68:71], a[48:51], v[168:171]
    s_waitcnt vmcnt(17)
    v_mfma_f32_16x16x32_bf16 v[152:155], v[72:75], a[16:19], v[152:155]
    v_mfma_f32_16x16x32_bf16 v[172:175], v[72:75], a[48:51], v[172:175]
    s_waitcnt vmcnt(16)
    v_mfma_f32_16x16x32_bf16 v[156:159], v[76:79], a[16:19], v[156:159]
    v_mfma_f32_16x16x32_bf16 v[176:179], v[76:79], a[48:51], v[176:179]
    s_waitcnt vmcnt(15)
    v_mfma_f32_16x16x32_bf16 v[160:163], v[80:83], a[16:19], v[160:163]
    v_mfma_f32_16x16x32_bf16 v[180:183], v[80:83], a[48:51], v[180:183]
    s_barrier
    s_waitcnt vmcnt(14)
    v_mfma_f32_16x16x32_bf16 v[144:147], v[84:87], a[20:23], v[144:147]
    v_mfma_f32_16x16x32_bf16 v[164:167], v[84:87], a[52:55], v[164:167]
    s_waitcnt vmcnt(13)
    v_mfma_f32_16x16x32_bf16 v[148:151], v[88:91], a[20:23], v[148:151]
    v_mfma_f32_16x16x32_bf16 v[168:171], v[88:91], a[52:55], v[168:171]
    s_waitcnt vmcnt(12)
    v_mfma_f32_16x16x32_bf16 v[152:155], v[92:95], a[20:23], v[152:155]
    v_mfma_f32_16x16x32_bf16 v[172:175], v[92:95], a[52:55], v[172:175]
    s_waitcnt vmcnt(11)
    v_mfma_f32_16x16x32_bf16 v[156:159], v[96:99], a[20:23], v[156:159]
    v_mfma_f32_16x16x32_bf16 v[176:179], v[96:99], a[52:55], v[176:179]
    s_waitcnt vmcnt(10)
    v_mfma_f32_16x16x32_bf16 v[160:163], v[100:103], a[20:23], v[160:163]
    v_mfma_f32_16x16x32_bf16 v[180:183], v[100:103], a[52:55], v[180:183]
    s_waitcnt vmcnt(9)
    v_mfma_f32_16x16x32_bf16 v[144:147], v[104:107], a[24:27], v[144:147]
    v_mfma_f32_16x16x32_bf16 v[164:167], v[104:107], a[56:59], v[164:167]
    s_waitcnt vmcnt(8)
    v_mfma_f32_16x16x32_bf16 v[148:151], v[108:111], a[24:27], v[148:151]
    v_mfma_f32_16x16x32_bf16 v[168:171], v[108:111], a[56:59], v[168:171]
    s_waitcnt vmcnt(7)
    v_mfma_f32_16x16x32_bf16 v[152:155], v[112:115], a[24:27], v[152:155]
    v_mfma_f32_16x16x32_bf16 v[172:175], v[112:115], a[56:59], v[172:175]
    s_waitcnt vmcnt(6)
    v_mfma_f32_16x16x32_bf16 v[156:159], v[116:119], a[24:27], v[156:159]
    v_mfma_f32_16x16x32_bf16 v[176:179], v[116:119], a[56:59], v[176:179]
    s_waitcnt vmcnt(5)
    v_mfma_f32_16x16x32_bf16 v[160:163], v[120:123], a[24:27], v[160:163]
    v_mfma_f32_16x16x32_bf16 v[180:183], v[120:123], a[56:59], v[180:183]
    s_waitcnt vmcnt(4)
    v_mfma_f32_16x16x32_bf16 v[144:147], v[124:127], a[28:31], v[144:147]
    v_mfma_f32_16x16x32_bf16 v[164:167], v[124:127], a[60:63], v[164:167]
    s_waitcnt vmcnt(3)
    v_mfma_f32_16x16x32_bf16 v[148:151], v[128:131], a[28:31], v[148:151]
    v_mfma_f32_16x16x32_bf16 v[168:171], v[128:131], a[60:63], v[168:171]
    s_waitcnt vmcnt(2)
    v_mfma_f32_16x16x32_bf16 v[152:155], v[132:135], a[28:31], v[152:155]
    v_mfma_f32_16x16x32_bf16 v[172:175], v[132:135], a[60:63], v[172:175]
    s_waitcnt vmcnt(1)
    v_mfma_f32_16x16x32_bf16 v[156:159], v[136:139], a[28:31], v[156:159]
    v_mfma_f32_16x16x32_bf16 v[176:179], v[136:139], a[60:63], v[176:179]
    s_waitcnt vmcnt(0)
    v_mfma_f32_16x16x32_bf16 v[160:163], v[140:143], a[28:31], v[160:163]
    v_mfma_f32_16x16x32_bf16 v[180:183], v[140:143], a[60:63], v[180:183]
    ds_write_b128 v16, v[144:147] offset:0
    ds_write_b128 v16, v[148:151] offset:64
    ds_write_b128 v16, v[152:155] offset:128
    s_nop 0
    ds_write_b128 v16, v[156:159] offset:192
    s_nop 1
    ds_write_b128 v16, v[160:163] offset:256
    s_mov_b32 exec_lo, 0x00010001
    s_mov_b32 exec_hi, 0x00010001
    ds_write_b128 v16, v[164:167] offset:5376
    ds_write_b128 v16, v[168:171] offset:5440
    ds_write_b128 v16, v[172:175] offset:5504
    ds_write_b128 v16, v[176:179] offset:5568
    ds_write_b128 v16, v[180:183] offset:5632
    s_mov_b64 exec, -1
    s_waitcnt lgkmcnt(0)
    s_barrier
    ds_read_b128 v[64:67], v17 offset:0
    ds_read_b128 v[72:75], v17 offset:9216
    ds_read_b128 v[80:83], v17 offset:18432
    ds_read_b128 v[88:91], v17 offset:27648
    ds_read_b128 v[68:71], v17 offset:16
    ds_read_b128 v[76:79], v17 offset:9232
    ds_read_b128 v[84:87], v17 offset:18448
    ds_read_b128 v[92:95], v17 offset:27664
    ds_read_b128 v[96:99], v18 offset:0
    ds_read_b128 v[104:107], v18 offset:9216
    ds_read_b128 v[112:115], v18 offset:18432
    ds_read_b128 v[120:123], v18 offset:27648
    ds_read_b128 v[100:103], v18 offset:16
    ds_read_b128 v[108:111], v18 offset:9232
    ds_read_b128 v[116:119], v18 offset:18448
    ds_read_b128 v[124:127], v18 offset:27664
    s_waitcnt lgkmcnt(12)
    v_pk_add_f32 v[64:65], v[64:65], v[72:73]
    v_pk_add_f32 v[80:81], v[80:81], v[88:89]
    v_pk_add_f32 v[72:73], v[64:65], v[80:81] neg_lo:[0,1] neg_hi:[0,1]
    v_pk_add_f32 v[88:89], v[64:65], v[80:81]
    v_pk_fma_f32 v[72:73], v[24:25], v[184:185], v[72:73] op_sel_hi:[0,1,1]
    v_pk_fma_f32 v[88:89], v[26:27], v[184:185], v[88:89] op_sel_hi:[0,1,1]
    v_cndmask_b32 v72, v72, 0, s[70:71]
    v_pk_add_f32 v[32:33], v[32:33], v[72:73]
    v_pk_add_f32 v[40:41], v[40:41], v[88:89]
    v_cvt_pk_bf16_f32 v144, v32, v33
    v_cvt_pk_bf16_f32 v148, v40, v41
    v_pk_add_f32 v[66:67], v[66:67], v[74:75]
    v_pk_add_f32 v[82:83], v[82:83], v[90:91]
    v_pk_add_f32 v[74:75], v[66:67], v[82:83] neg_lo:[0,1] neg_hi:[0,1]
    v_pk_add_f32 v[90:91], v[66:67], v[82:83]
    v_pk_fma_f32 v[74:75], v[24:25], v[186:187], v[74:75] op_sel_hi:[0,1,1]
    v_pk_fma_f32 v[90:91], v[26:27], v[186:187], v[90:91] op_sel_hi:[0,1,1]
    v_pk_add_f32 v[34:35], v[34:35], v[74:75]
    v_pk_add_f32 v[42:43], v[42:43], v[90:91]
    v_cvt_pk_bf16_f32 v145, v34, v35
    v_cvt_pk_bf16_f32 v149, v42, v43
    s_waitcnt lgkmcnt(8)
    s_nop 0
    v_pk_add_f32 v[68:69], v[68:69], v[76:77]
    v_pk_add_f32 v[84:85], v[84:85], v[92:93]
    v_pk_add_f32 v[76:77], v[68:69], v[84:85] neg_lo:[0,1] neg_hi:[0,1]
    v_pk_add_f32 v[92:93], v[68:69], v[84:85]
    v_pk_fma_f32 v[76:77], v[24:25], v[188:189], v[76:77] op_sel_hi:[0,1,1]
    v_pk_fma_f32 v[92:93], v[26:27], v[188:189], v[92:93] op_sel_hi:[0,1,1]
    v_pk_add_f32 v[36:37], v[36:37], v[76:77]
    v_pk_add_f32 v[44:45], v[44:45], v[92:93]
    v_cvt_pk_bf16_f32 v146, v36, v37
    v_cvt_pk_bf16_f32 v150, v44, v45
    v_pk_add_f32 v[70:71], v[70:71], v[78:79]
    v_pk_add_f32 v[86:87], v[86:87], v[94:95]
    v_pk_add_f32 v[78:79], v[70:71], v[86:87] neg_lo:[0,1] neg_hi:[0,1]
    v_pk_add_f32 v[94:95], v[70:71], v[86:87]
    v_pk_fma_f32 v[78:79], v[24:25], v[190:191], v[78:79] op_sel_hi:[0,1,1]
    v_pk_fma_f32 v[94:95], v[26:27], v[190:191], v[94:95] op_sel_hi:[0,1,1]
    v_pk_add_f32 v[38:39], v[38:39], v[78:79]
    v_pk_add_f32 v[46:47], v[46:47], v[94:95]
    v_cvt_pk_bf16_f32 v147, v38, v39
    v_cvt_pk_bf16_f32 v151, v46, v47
    buffer_store_dwordx4 v[144:147], v19, s[44:47], s88 offen
    buffer_store_dwordx4 v[148:151], v19, s[44:47], s89 offen
    s_waitcnt lgkmcnt(4)
    s_nop 0
    v_pk_add_f32 v[96:97], v[96:97], v[104:105]
    v_pk_add_f32 v[112:113], v[112:113], v[120:121]
    v_pk_add_f32 v[104:105], v[96:97], v[112:113] neg_lo:[0,1] neg_hi:[0,1]
    v_pk_add_f32 v[120:121], v[96:97], v[112:113]
    v_pk_fma_f32 v[104:105], v[26:27], v[184:185], v[104:105] op_sel_hi:[0,1,1] neg_lo:[1,0,0] neg_hi:[1,0,0]
    v_pk_fma_f32 v[120:121], v[24:25], v[184:185], v[120:121] op_sel_hi:[0,1,1] neg_lo:[1,0,0] neg_hi:[1,0,0]
    v_cndmask_b32 v120, v120, 0, s[70:71]
    v_pk_add_f32 v[48:49], v[48:49], v[120:121]
    v_pk_add_f32 v[56:57], v[56:57], v[104:105]
    v_cvt_pk_bf16_f32 v152, v48, v49
    v_cvt_pk_bf16_f32 v156, v56, v57
    v_pk_add_f32 v[98:99], v[98:99], v[106:107]
    v_pk_add_f32 v[114:115], v[114:115], v[122:123]
    v_pk_add_f32 v[106:107], v[98:99], v[114:115] neg_lo:[0,1] neg_hi:[0,1]
    v_pk_add_f32 v[122:123], v[98:99], v[114:115]
    v_pk_fma_f32 v[106:107], v[26:27], v[186:187], v[106:107] op_sel_hi:[0,1,1] neg_lo:[1,0,0] neg_hi:[1,0,0]
    v_pk_fma_f32 v[122:123], v[24:25], v[186:187], v[122:123] op_sel_hi:[0,1,1] neg_lo:[1,0,0] neg_hi:[1,0,0]
    v_pk_add_f32 v[50:51], v[50:51], v[122:123]
    v_pk_add_f32 v[58:59], v[58:59], v[106:107]
    v_cvt_pk_bf16_f32 v153, v50, v51
    v_cvt_pk_bf16_f32 v157, v58, v59
    s_waitcnt lgkmcnt(0)
    s_nop 0
    v_pk_add_f32 v[100:101], v[100:101], v[108:109]
    v_pk_add_f32 v[116:117], v[116:117], v[124:125]
    v_pk_add_f32 v[108:109], v[100:101], v[116:117] neg_lo:[0,1] neg_hi:[0,1]
    v_pk_add_f32 v[124:125], v[100:101], v[116:117]
    v_pk_fma_f32 v[108:109], v[26:27], v[188:189], v[108:109] op_sel_hi:[0,1,1] neg_lo:[1,0,0] neg_hi:[1,0,0]
    v_pk_fma_f32 v[124:125], v[24:25], v[188:189], v[124:125] op_sel_hi:[0,1,1] neg_lo:[1,0,0] neg_hi:[1,0,0]
    v_pk_add_f32 v[52:53], v[52:53], v[124:125]
    v_pk_add_f32 v[60:61], v[60:61], v[108:109]
    v_cvt_pk_bf16_f32 v154, v52, v53
    v_cvt_pk_bf16_f32 v158, v60, v61
    v_pk_add_f32 v[102:103], v[102:103], v[110:111]
    v_pk_add_f32 v[118:119], v[118:119], v[126:127]
    v_pk_add_f32 v[110:111], v[102:103], v[118:119] neg_lo:[0,1] neg_hi:[0,1]
    v_pk_add_f32 v[126:127], v[102:103], v[118:119]
    v_pk_fma_f32 v[110:111], v[26:27], v[190:191], v[110:111] op_sel_hi:[0,1,1] neg_lo:[1,0,0] neg_hi:[1,0,0]
    v_pk_fma_f32 v[126:127], v[24:25], v[190:191], v[126:127] op_sel_hi:[0,1,1] neg_lo:[1,0,0] neg_hi:[1,0,0]
    v_pk_add_f32 v[54:55], v[54:55], v[126:127]
    v_pk_add_f32 v[62:63], v[62:63], v[110:111]
    v_cvt_pk_bf16_f32 v155, v54, v55
    v_cvt_pk_bf16_f32 v159, v62, v63
    buffer_store_dwordx4 v[152:155], v20, s[44:47], s90 offen
    buffer_store_dwordx4 v[156:159], v20, s[44:47], s91 offen
    v_pk_mul_f32 v[162:163], v[32:33], v[32:33]
    v_pk_mul_f32 v[166:167], v[48:49], v[48:49]
    v_pk_add_f32 v[160:161], v[32:33], v[34:35]
    v_pk_fma_f32 v[162:163], v[34:35], v[34:35], v[162:163]
    v_pk_add_f32 v[164:165], v[48:49], v[50:51]
    v_pk_fma_f32 v[166:167], v[50:51], v[50:51], v[166:167]
    v_pk_add_f32 v[160:161], v[160:161], v[36:37]
    v_pk_fma_f32 v[162:163], v[36:37], v[36:37], v[162:163]
    v_pk_add_f32 v[164:165], v[164:165], v[52:53]
    v_pk_fma_f32 v[166:167], v[52:53], v[52:53], v[166:167]
    v_pk_add_f32 v[160:161], v[160:161], v[38:39]
    v_pk_fma_f32 v[162:163], v[38:39], v[38:39], v[162:163]
    v_pk_add_f32 v[164:165], v[164:165], v[54:55]
    v_pk_fma_f32 v[166:167], v[54:55], v[54:55], v[166:167]
    v_pk_add_f32 v[160:161], v[160:161], v[40:41]
    v_pk_fma_f32 v[162:163], v[40:41], v[40:41], v[162:163]
    v_pk_add_f32 v[164:165], v[164:165], v[56:57]
    v_pk_fma_f32 v[166:167], v[56:57], v[56:57], v[166:167]
    v_pk_add_f32 v[160:161], v[160:161], v[42:43]
    v_pk_fma_f32 v[162:163], v[42:43], v[42:43], v[162:163]
    v_pk_add_f32 v[164:165], v[164:165], v[58:59]
    v_pk_fma_f32 v[166:167], v[58:59], v[58:59], v[166:167]
    v_pk_add_f32 v[160:161], v[160:161], v[44:45]
    v_pk_fma_f32 v[162:163], v[44:45], v[44:45], v[162:163]
    v_pk_add_f32 v[164:165], v[164:165], v[60:61]
    v_pk_fma_f32 v[166:167], v[60:61], v[60:61], v[166:167]
    v_pk_add_f32 v[160:161], v[160:161], v[46:47]
    v_pk_fma_f32 v[162:163], v[46:47], v[46:47], v[162:163]
    v_pk_add_f32 v[164:165], v[164:165], v[62:63]
    v_pk_fma_f32 v[166:167], v[62:63], v[62:63], v[166:167]
    v_cmp_gt_u32 vcc, 40, v1
    v_add_f32 v160, v160, v161
    v_add_f32 v162, v162, v163
    v_add_f32 v164, v164, v165
    v_add_f32_e64 v166, v166, v167
    v_cndmask_b32 v160, 0, v160, vcc
    v_cndmask_b32 v162, 0, v162, vcc
    v_cndmask_b32 v164, 0, v164, vcc
    v_cndmask_b32 v166, 0, v166, vcc
    v_add_f32_dpp v160, v160, v160 row_ror:4 row_mask:0xf bank_mask:0xf
    v_add_f32_dpp v162, v162, v162 row_ror:4 row_mask:0xf bank_mask:0xf
    v_add_f32_dpp v164, v164, v164 row_ror:4 row_mask:0xf bank_mask:0xf
    v_add_f32_dpp v166, v166, v166 row_ror:4 row_mask:0xf bank_mask:0xf
    v_add_f32_dpp v160, v160, v160 row_ror:8 row_mask:0xf bank_mask:0xf
    v_add_f32_dpp v162, v162, v162 row_ror:8 row_mask:0xf bank_mask:0xf
    v_add_f32_dpp v164, v164, v164 row_ror:8 row_mask:0xf bank_mask:0xf
    v_add_f32_dpp v166, v166, v166 row_ror:8 row_mask:0xf bank_mask:0xf
    v_mov_b32 v161, v160
    v_mov_b32 v163, v162
    v_mov_b32 v165, v164
    v_mov_b32 v167, v166
    v_permlane16_swap_b32 v160, v161
    v_permlane16_swap_b32 v162, v163
    v_permlane16_swap_b32 v164, v165
    v_permlane16_swap_b32 v166, v167
    v_add_f32 v160, v160, v161
    v_add_f32 v162, v162, v163
    v_add_f32 v164, v164, v165
    v_add_f32 v166, v166, v167
    v_mov_b32 v161, v160
    v_mov_b32 v163, v162
    v_mov_b32 v165, v164
    v_mov_b32 v167, v166
    v_permlane32_swap_b32 v160, v161
    v_permlane32_swap_b32 v162, v163
    v_permlane32_swap_b32 v164, v165
    v_permlane32_swap_b32 v166, v167
    v_add_f32 v160, v160, v161
    v_add_f32 v162, v162, v163
    v_add_f32 v164, v164, v165
    v_add_f32 v166, v166, v167
    v_mov_b32 v161, v162
    v_mov_b32_e64 v165, v166
    s_mov_b64 exec, 15
    buffer_store_dwordx2 v[160:161], v21, s[44:47], s92 offen
    buffer_store_dwordx2 v[164:165], v22, s[44:47], s93 offen
    s_mov_b64 exec, -1
    v_add_u32 v184, 61440, v2
    v_mov_b32 v188, 0xffffff00
    s_lshl_b32 s80, s59, 10
    s_add_u32 s80, s80, 4194304
    s_mul_i32 s81, s59, 40960
    s_add_u32 s81, s81, 1572864
    s_add_u32 s82, s81, 20480
    s_mov_b32 s90, 0xbdd2d3e7
    s_mov_b32 s91, 0xbdd2d3e7
    v_mov_b32 v14, 0xc0135761
    s_lshl_b32 s83, s59, 12
    s_add_u32 s83, s83, 11534336
    s_lshl_b32 s84, s60, 4
    s_add_u32 s84, s84, s83
    s_mul_i32 s85, s60, 192
    s_add_u32 s85, s85, s59
    s_lshl_b32 s85, s85, 10
    s_add_u32 s85, s85, 4718592
    s_add_u32 s92, s85, 65536
    s_add_u32 s93, s85, 131072
    s_lshl_b32 s86, s52, 8
    s_add_u32 s86, s86, 159744
    s_mov_b32 s87, 0x3727c5ac
    s_mov_b32 s88, 0x3acccccd
    s_mov_b32 s89, 0x3aaaaaab
    v_lshrrev_b32 v185, 5, v1
    v_lshlrev_b32 v185, 6, v185
    v_and_b32_e64 v10, 7, v1
    v_lshl_add_u32 v185, v10, 3, v185
    v_add_u32 v185, s86, v185
    v_lshrrev_b32 v12, 4, v1
    v_lshl_add_u32 v12, v12, 4, s86
    v_and_b32 v10, 15, v1
    v_lshlrev_b32 v186, 2, v10
    v_add_u32 v186, 160768, v186
    v_lshrrev_b32 v187, 2, v1
    v_lshlrev_b32 v187, 8, v187
    v_and_b32_e64 v10, 3, v1
    v_lshl_add_u32 v13, v10, 4, v187
    s_waitcnt vmcnt(0)
    s_barrier
    s_cmp_lg_u32 s52, 0
    s_cbranch_scc1 skip_10
    s_lshl_b32 s99, s53, 5
    s_add_u32 s99, s99, s54
    s_lshl_b32 s72, s99, 2
    s_add_u32 s72, s72, 8192
    v_mov_b32 v10, s96
    v_mov_b32 v11, 0
    s_mov_b64 exec, 1
    s_cmp_eq_u32 s97, 0
    s_cbranch_scc1 fs_slow_11
    buffer_store_dword v10, v11, s[44:47], s72 offen
    s_branch fs_done_12
fs_slow_11:
    buffer_wbl2 sc1
    s_waitcnt vmcnt(0)
    buffer_store_dword v10, v11, s[44:47], s72 offen sc1
fs_done_12:
    s_mov_b64 exec, -1
skip_10:
    s_sub_u32 s72, 63, s59
    s_min_u32 s99, s72, s59
    s_lshl_b32 s99, s99, 3
    s_lshl_b32 s72, s99, 2
    s_add_u32 s72, s72, 8192
    v_min_u32 v11, 7, v1
    v_lshlrev_b32_e64 v11, 2, v11
    s_mov_b32 s98, 0x100000
poll_13:
    buffer_load_dword v10, v11, s[44:47], s72 offen sc1
    s_waitcnt vmcnt(0)
    v_cmp_ne_u32 vcc, s96, v10
    s_cbranch_vccz polled_14
    s_sub_u32 s98, s98, 1
    s_cbranch_scc0 poll_13
polled_14:
    buffer_load_dwordx4 v[64:67], v2, s[44:47], s81 offen offset:0 sc1
    buffer_load_dwordx4 v[68:71], v2, s[44:47], s82 offen offset:0 sc1
    buffer_load_dwordx4 v[72:75], v2, s[44:47], s81 offen offset:1024 sc1
    buffer_load_dwordx4 v[76:79], v2, s[44:47], s82 offen offset:1024 sc1
    buffer_load_dwordx4 v[4:7], v2, s[44:47], s80 offen sc1
    buffer_load_dwordx4 v[80:83], v2, s[44:47], s81 offen offset:2048 sc1
    buffer_load_dwordx4 v[84:87], v2, s[44:47], s82 offen offset:2048 sc1
    buffer_load_dwordx4 v[88:91], v2, s[44:47], s81 offen offset:3072 sc1
    buffer_load_dwordx4 v[92:95], v2, s[44:47], s82 offen offset:3072 sc1
    s_add_u32 s81, s81, 4096
    s_add_u32 s82, s82, 4096
    buffer_load_dwordx4 v[96:99], v2, s[44:47], s81 offen offset:0 sc1
    buffer_load_dwordx4 v[100:103], v2, s[44:47], s82 offen offset:0 sc1
    buffer_load_dwordx4 v[104:107], v2, s[44:47], s81 offen offset:1024 sc1
    buffer_load_dwordx4 v[108:111], v2, s[44:47], s82 offen offset:1024 sc1
    ds_read_b128 v[160:163], v2 offset:0
    ds_read_b128 v[164:167], v2 offset:20480
    ds_read_b128 v[168:171], v2 offset:40960
    ds_read_b128 v[172:175], v2 offset:1024
    ds_read_b128 v[176:179], v2 offset:21504
    s_waitcnt lgkmcnt(4) vmcnt(11)
    v_mfma_f32_16x16x32_bf16 v[16:19], v[64:67], v[160:163], 0
    v_mfma_f32_16x16x32_bf16 v[28:31], v[68:71], v[160:163], 0
    ds_read_b128 v[180:183], v2 offset:41984
    buffer_load_dwordx4 v[112:115], v2, s[44:47], s81 offen offset:2048 sc1
    buffer_load_dwordx4 v[116:119], v2, s[44:47], s82 offen offset:2048 sc1
    s_waitcnt lgkmcnt(4)
    v_mfma_f32_16x16x32_bf16 v[20:23], v[64:67], v[164:167], 0
    v_mfma_f32_16x16x32_bf16 v[32:35], v[68:71], v[164:167], 0
    ds_read_b128 v[160:163], v2 offset:2048
    s_waitcnt lgkmcnt(4)
    v_mfma_f32_16x16x32_bf16 v[24:27], v[64:67], v[168:171], 0
    v_mfma_f32_16x16x32_bf16 v[36:39], v[68:71], v[168:171], 0
    ds_read_b128 v[164:167], v2 offset:22528
    s_waitcnt lgkmcnt(4) vmcnt(11)
    v_mfma_f32_16x16x32_bf16 v[16:19], v[72:75], v[172:175], v[16:19]
    v_mfma_f32_16x16x32_bf16 v[28:31], v[76:79], v[172:175], v[28:31]
    ds_read_b128 v[168:171], v2 offset:43008
    buffer_load_dwordx4 v[120:123], v2, s[44:47], s81 offen offset:3072 sc1
    buffer_load_dwordx4 v[124:127], v2, s[44:47], s82 offen offset:3072 sc1
    s_add_u32 s81, s81, 4096
    s_add_u32 s82, s82, 4096
    s_waitcnt lgkmcnt(4)
    v_mfma_f32_16x16x32_bf16 v[20:23], v[72:75], v[176:179], v[20:23]
    v_mfma_f32_16x16x32_bf16 v[32:35], v[76:79], v[176:179], v[32:35]
    ds_read_b128 v[172:175], v2 offset:3072
    s_waitcnt lgkmcnt(4)
    v_mfma_f32_16x16x32_bf16 v[24:27], v[72:75], v[180:183], v[24:27]
    v_mfma_f32_16x16x32_bf16 v[36:39], v[76:79], v[180:183], v[36:39]
    ds_read_b128 v[176:179], v2 offset:23552
    s_waitcnt lgkmcnt(4) vmcnt(10)
    v_mfma_f32_16x16x32_bf16 v[16:19], v[80:83], v[160:163], v[16:19]
    v_mfma_f32_16x16x32_bf16 v[28:31], v[84:87], v[160:163], v[28:31]
    ds_read_b128 v[180:183], v2 offset:44032
    buffer_load_dwordx4 v[128:131], v2, s[44:47], s81 offen offset:0 sc1
    buffer_load_dwordx4 v[132:135], v2, s[44:47], s82 offen offset:0 sc1
    s_waitcnt lgkmcnt(4)
    v_mfma_f32_16x16x32_bf16 v[20:23], v[80:83], v[164:167], v[20:23]
    v_mfma_f32_16x16x32_bf16 v[32:35], v[84:87], v[164:167], v[32:35]
    ds_read_b128 v[160:163], v2 offset:4096
    s_waitcnt lgkmcnt(4)
    v_mfma_f32_16x16x32_bf16 v[24:27], v[80:83], v[168:171], v[24:27]
    v_mfma_f32_16x16x32_bf16 v[36:39], v[84:87], v[168:171], v[36:39]
    ds_read_b128 v[164:167], v2 offset:24576
    s_waitcnt lgkmcnt(4) vmcnt(10)
    v_mfma_f32_16x16x32_bf16 v[16:19], v[88:91], v[172:175], v[16:19]
    v_mfma_f32_16x16x32_bf16 v[28:31], v[92:95], v[172:175], v[28:31]
    ds_read_b128 v[168:171], v2 offset:45056
    buffer_load_dwordx4 v[136:139], v2, s[44:47], s81 offen offset:1024 sc1
    buffer_load_dwordx4 v[140:143], v2, s[44:47], s82 offen offset:1024 sc1
    s_waitcnt lgkmcnt(4)
    v_mfma_f32_16x16x32_bf16 v[20:23], v[88:91], v[176:179], v[20:23]
    v_mfma_f32_16x16x32_bf16 v[32:35], v[92:95], v[176:179], v[32:35]
    ds_read_b128 v[172:175], v2 offset:5120
    s_waitcnt lgkmcnt(4)
    v_mfma_f32_16x16x32_bf16 v[24:27], v[88:91], v[180:183], v[24:27]
    v_mfma_f32_16x16x32_bf16 v[36:39], v[92:95], v[180:183], v[36:39]
    ds_read_b128 v[176:179], v2 offset:25600
    v_add_f32_dpp v4, v4, v4 row_ror:8 row_mask:0xf bank_mask:0xf
    v_add_f32_dpp v5, v5, v5 row_ror:8 row_mask:0xf bank_mask:0xf
    v_add_f32_dpp v6, v6, v6 row_ror:8 row_mask:0xf bank_mask:0xf
    v_add_f32_dpp v7, v7, v7 row_ror:8 row_mask:0xf bank_mask:0xf
    v_mov_b32 v8, v4
    v_mov_b32 v9, v5
    v_mov_b32 v10, v6
    v_mov_b32 v11, v7
    v_permlane16_swap_b32 v4, v8
    v_permlane16_swap_b32 v5, v9
    v_permlane16_swap_b32 v6, v10
    v_permlane16_swap_b32 v7, v11
    v_add_f32 v4, v4, v8
    v_add_f32 v5, v5, v9
    v_add_f32 v6, v6, v10
    v_add_f32 v7, v7, v11
    v_mul_f32 v8, s88, v4
    v_mul_f32 v9, s88, v6
    v_mul_f32 v4, v8, v8
    v_mul_f32_e64 v6, v9, v9
    v_fma_f32 v5, v5, s88, -v4
    v_fma_f32 v7, v7, s88, -v6
    v_add_f32 v5, s87, v5
    v_add_f32 v7, s87, v7
    v_rsq_f32 v10, v5
    v_rsq_f32 v11, v7
    v_sub_f32 v8, 0, v8
    v_sub_f32 v9, 0, v9
    ds_write_b64 v185, v[8:9]
    ds_write_b64 v185, v[10:11] offset:128
    s_waitcnt lgkmcnt(6) vmcnt(10)
    v_mfma_f32_16x16x32_bf16 v[16:19], v[96:99], v[160:163], v[16:19]
    v_mfma_f32_16x16x32_bf16 v[28:31], v[100:103], v[160:163], v[28:31]
    ds_read_b128 v[180:183], v2 offset:46080
    buffer_load_dwordx4 v[144:147], v2, s[44:47], s81 offen offset:2048 sc1
    buffer_load_dwordx4 v[148:151], v2, s[44:47], s82 offen offset:2048 sc1
    s_waitcnt lgkmcnt(6)
    v_mfma_f32_16x16x32_bf16 v[20:23], v[96:99], v[164:167], v[20:23]
    v_mfma_f32_16x16x32_bf16 v[32:35], v[100:103], v[164:167], v[32:35]
    ds_read_b128 v[160:163], v2 offset:6144
    s_waitcnt lgkmcnt(6)
    v_mfma_f32_16x16x32_bf16 v[24:27], v[96:99], v[168:171], v[24:27]
    v_mfma_f32_16x16x32_bf16 v[36:39], v[100:103], v[168:171], v[36:39]
    ds_read_b128 v[164:167], v2 offset:26624
    s_waitcnt lgkmcnt(6) vmcnt(10)
    v_mfma_f32_16x16x32_bf16 v[16:19], v[104:107], v[172:175], v[16:19]
    v_mfma_f32_16x16x32_bf16 v[28:31], v[108:111], v[172:175], v[28:31]
    ds_read_b128 v[168:171], v2 offset:47104
    buffer_load_dwordx4 v[152:155], v2, s[44:47], s81 offen offset:3072 sc1
    buffer_load_dwordx4 v[156:159], v2, s[44:47], s82 offen offset:3072 sc1
    s_add_u32 s81, s81, 4096
    s_add_u32 s82, s82, 4096
    s_waitcnt lgkmcnt(6)
    v_mfma_f32_16x16x32_bf16 v[20:23], v[104:107], v[176:179], v[20:23]
    v_mfma_f32_16x16x32_bf16 v[32:35], v[108:111], v[176:179], v[32:35]
    ds_read_b128 v[172:175], v2 offset:7168
    s_waitcnt lgkmcnt(4)
    v_mfma_f32_16x16x32_bf16 v[24:27], v[104:107], v[180:183], v[24:27]
    v_mfma_f32_16x16x32_bf16 v[36:39], v[108:111], v[180:183], v[36:39]
    ds_read_b128 v[176:179], v2 offset:27648
    s_waitcnt lgkmcnt(4) vmcnt(10)
    v_mfma_f32_16x16x32_bf16 v[16:19], v[112:115], v[160:163], v[16:19]
    v_mfma_f32_16x16x32_bf16 v[28:31], v[116:119], v[160:163], v[28:31]
    ds_read_b128 v[180:183], v2 offset:48128
    buffer_load_dwordx4 a[0:3], v2, s[44:47], s81 offen offset:0 sc1
    buffer_load_dwordx4 a[4:7], v2, s[44:47], s82 offen offset:0 sc1
    s_waitcnt lgkmcnt(4)
    v_mfma_f32_16x16x32_bf16 v[20:23], v[112:115], v[164:167], v[20:23]
    v_mfma_f32_16x16x32_bf16 v[32:35], v[116:119], v[164:167], v[32:35]
    ds_read_b128 v[160:163], v2 offset:8192
    s_waitcnt lgkmcnt(4)
    v_mfma_f32_16x16x32_bf16 v[24:27], v[112:115], v[168:171], v[24:27]
    v_mfma_f32_16x16x32_bf16 v[36:39], v[116:119], v[168:171], v[36:39]
    ds_read_b128 v[164:167], v2 offset:28672
    s_waitcnt lgkmcnt(4) vmcnt(10)
    v_mfma_f32_16x16x32_bf16 v[16:19], v[120:123], v[172:175], v[16:19]
    v_mfma_f32_16x16x32_bf16 v[28:31], v[124:127], v[172:175], v[28:31]
    ds_read_b128 v[168:171], v2 offset:49152
    buffer_load_dwordx4 a[8:11], v2, s[44:47], s81 offen offset:1024 sc1
    buffer_load_dwordx4 a[12:15], v2, s[44:47], s82 offen offset:1024 sc1
    s_waitcnt lgkmcnt(4)
    v_mfma_f32_16x16x32_bf16 v[20:23], v[120:123], v[176:179], v[20:23]
    v_mfma_f32_16x16x32_bf16 v[32:35], v[124:127], v[176:179], v[32:35]
    ds_read_b128 v[172:175], v2 offset:9216
    s_waitcnt lgkmcnt(4)
    v_mfma_f32_16x16x32_bf16 v[24:27], v[120:123], v[180:183], v[24:27]
    v_mfma_f32_16x16x32_bf16 v[36:39], v[124:127], v[180:183], v[36:39]
    ds_read_b128 v[176:179], v2 offset:29696
    s_waitcnt lgkmcnt(4) vmcnt(10)
    v_mfma_f32_16x16x32_bf16 v[16:19], v[128:131], v[160:163], v[16:19]
    v_mfma_f32_16x16x32_bf16 v[28:31], v[132:135], v[160:163], v[28:31]
    ds_read_b128 v[180:183], v2 offset:50176
    buffer_load_dwordx4 a[16:19], v2, s[44:47], s81 offen offset:2048 sc1
    buffer_load_dwordx4 a[20:23], v2, s[44:47], s82 offen offset:2048 sc1
    s_waitcnt lgkmcnt(4)
    v_mfma_f32_16x16x32_bf16 v[20:23], v[128:131], v[164:167], v[20:23]
    v_mfma_f32_16x16x32_bf16 v[32:35], v[132:135], v[164:167], v[32:35]
    ds_read_b128 v[160:163], v2 offset:10240
    s_waitcnt lgkmcnt(4)
    v_mfma_f32_16x16x32_bf16 v[24:27], v[128:131], v[168:171], v[24:27]
    v_mfma_f32_16x16x32_bf16 v[36:39], v[132:135], v[168:171], v[36:39]
    ds_read_b128 v[164:167], v2 offset:30720
    s_barrier
    s_waitcnt lgkmcnt(4) vmcnt(10)
    v_mfma_f32_16x16x32_bf16 v[16:19], v[136:139], v[172:175], v[16:19]
    v_mfma_f32_16x16x32_bf16 v[28:31], v[140:143], v[172:175], v[28:31]
    ds_read_b128 v[168:171], v2 offset:51200
    buffer_load_dwordx4 a[24:27], v2, s[44:47], s81 offen offset:3072 sc1
    buffer_load_dwordx4 a[28:31], v2, s[44:47], s82 offen offset:3072 sc1
    s_add_u32 s81, s81, 4096
    s_add_u32 s82, s82, 4096
    s_waitcnt lgkmcnt(4)
    v_mfma_f32_16x16x32_bf16 v[20:23], v[136:139], v[176:179], v[20:23]
    v_mfma_f32_16x16x32_bf16 v[32:35], v[140:143], v[176:179], v[32:35]
    ds_read_b128 v[172:175], v2 offset:11264
    s_waitcnt lgkmcnt(4)
    v_mfma_f32_16x16x32_bf16 v[24:27], v[136:139], v[180:183], v[24:27]
    v_mfma_f32_16x16x32_bf16 v[36:39], v[140:143], v[180:183], v[36:39]
    ds_read_b128 v[176:179], v2 offset:31744
    s_waitcnt lgkmcnt(4) vmcnt(10)
    v_mfma_f32_16x16x32_bf16 v[16:19], v[144:147], v[160:163], v[16:19]
    v_mfma_f32_16x16x32_bf16 v[28:31], v[148:151], v[160:163], v[28:31]
    ds_read_b128 v[180:183], v2 offset:52224
    buffer_load_dwordx4 a[32:35], v2, s[44:47], s81 offen offset:0 sc1
    buffer_load_dwordx4 a[36:39], v2, s[44:47], s82 offen offset:0 sc1
    s_waitcnt lgkmcnt(4)
    v_mfma_f32_16x16x32_bf16 v[20:23], v[144:147], v[164:167], v[20:23]
    v_mfma_f32_16x16x32_bf16 v[32:35], v[148:151], v[164:167], v[32:35]
    ds_read_b128 v[160:163], v2 offset:12288
    s_waitcnt lgkmcnt(4)
    v_mfma_f32_16x16x32_bf16 v[24:27], v[144:147], v[168:171], v[24:27]
    v_mfma_f32_16x16x32_bf16 v[36:39], v[148:151], v[168:171], v[36:39]
    ds_read_b128 v[164:167], v2 offset:32768
    s_waitcnt lgkmcnt(4) vmcnt(10)
    v_mfma_f32_16x16x32_bf16 v[16:19], v[152:155], v[172:175], v[16:19]
    v_mfma_f32_16x16x32_bf16 v[28:31], v[156:159], v[172:175], v[28:31]
    ds_read_b128 v[168:171], v2 offset:53248
    buffer_load_dwordx4 a[40:43], v2, s[44:47], s81 offen offset:1024 sc1
    buffer_load_dwordx4 a[44:47], v2, s[44:47], s82 offen offset:1024 sc1
    s_waitcnt lgkmcnt(4)
    v_mfma_f32_16x16x32_bf16 v[20:23], v[152:155], v[176:179], v[20:23]
    v_mfma_f32_16x16x32_bf16 v[32:35], v[156:159], v[176:179], v[32:35]
    ds_read_b128 v[172:175], v2 offset:13312
    s_waitcnt lgkmcnt(4)
    v_mfma_f32_16x16x32_bf16 v[24:27], v[152:155], v[180:183], v[24:27]
    v_mfma_f32_16x16x32_bf16 v[36:39], v[156:159], v[180:183], v[36:39]
    ds_read_b128 v[176:179], v2 offset:33792
    s_waitcnt lgkmcnt(4) vmcnt(10)
    v_mfma_f32_16x16x32_bf16 v[16:19], a[0:3], v[160:163], v[16:19]
    v_mfma_f32_16x16x32_bf16 v[28:31], a[4:7], v[160:163], v[28:31]
    ds_read_b128 v[180:183], v2 offset:54272
    buffer_load_dwordx4 a[48:51], v2, s[44:47], s81 offen offset:2048 sc1
    buffer_load_dwordx4 a[52:55], v2, s[44:47], s82 offen offset:2048 sc1
    s_waitcnt lgkmcnt(4)
    v_mfma_f32_16x16x32_bf16 v[20:23], a[0:3], v[164:167], v[20:23]
    v_mfma_f32_16x16x32_bf16 v[32:35], a[4:7], v[164:167], v[32:35]
    ds_read_b128 v[160:163], v2 offset:14336
    s_waitcnt lgkmcnt(4)
    v_mfma_f32_16x16x32_bf16 v[24:27], a[0:3], v[168:171], v[24:27]
    v_mfma_f32_16x16x32_bf16 v[36:39], a[4:7], v[168:171], v[36:39]
    ds_read_b128 v[164:167], v2 offset:34816
    s_waitcnt lgkmcnt(4) vmcnt(10)
    v_mfma_f32_16x16x32_bf16 v[16:19], a[8:11], v[172:175], v[16:19]
    v_mfma_f32_16x16x32_bf16 v[28:31], a[12:15], v[172:175], v[28:31]
    ds_read_b128 v[168:171], v2 offset:55296
    buffer_load_dwordx4 a[56:59], v2, s[44:47], s81 offen offset:3072 sc1
    buffer_load_dwordx4 a[60:63], v2, s[44:47], s82 offen offset:3072 sc1
    s_waitcnt lgkmcnt(4)
    v_mfma_f32_16x16x32_bf16 v[20:23], a[8:11], v[176:179], v[20:23]
    v_mfma_f32_16x16x32_bf16 v[32:35], a[12:15], v[176:179], v[32:35]
    ds_read_b128 v[172:175], v2 offset:15360
    s_waitcnt lgkmcnt(4)
    v_mfma_f32_16x16x32_bf16 v[24:27], a[8:11], v[180:183], v[24:27]
    v_mfma_f32_16x16x32_bf16 v[36:39], a[12:15], v[180:183], v[36:39]
    ds_read_b128 v[176:179], v2 offset:35840
    s_waitcnt lgkmcnt(4) vmcnt(10)
    v_mfma_f32_16x16x32_bf16 v[16:19], a[16:19], v[160:163], v[16:19]
    v_mfma_f32_16x16x32_bf16 v[28:31], a[20:23], v[160:163], v[28:31]
    ds_read_b128 v[180:183], v2 offset:56320
    s_waitcnt lgkmcnt(4)
    v_mfma_f32_16x16x32_bf16 v[20:23], a[16:19], v[164:167], v[20:23]
    v_mfma_f32_16x16x32_bf16 v[32:35], a[20:23], v[164:167], v[32:35]
    ds_read_b128 v[160:163], v2 offset:16384
    s_waitcnt lgkmcnt(4)
    v_mfma_f32_16x16x32_bf16 v[24:27], a[16:19], v[168:171], v[24:27]
    v_mfma_f32_16x16x32_bf16 v[36:39], a[20:23], v[168:171], v[36:39]
    ds_read_b128 v[164:167], v2 offset:36864
    s_waitcnt lgkmcnt(4) vmcnt(8)
    v_mfma_f32_16x16x32_bf16 v[16:19], a[24:27], v[172:175], v[16:19]
    v_mfma_f32_16x16x32_bf16 v[28:31], a[28:31], v[172:175], v[28:31]
    ds_read_b128 v[168:171], v2 offset:57344
    s_waitcnt lgkmcnt(4)
    v_mfma_f32_16x16x32_bf16 v[20:23], a[24:27], v[176:179], v[20:23]
    v_mfma_f32_16x16x32_bf16 v[32:35], a[28:31], v[176:179], v[32:35]
    ds_read_b128 v[172:175], v2 offset:17408
    s_waitcnt lgkmcnt(4)
    v_mfma_f32_16x16x32_bf16 v[24:27], a[24:27], v[180:183], v[24:27]
    v_mfma_f32_16x16x32_bf16 v[36:39], a[28:31], v[180:183], v[36:39]
    ds_read_b128 v[176:179], v2 offset:37888
    s_waitcnt lgkmcnt(4) vmcnt(6)
    v_mfma_f32_16x16x32_bf16 v[16:19], a[32:35], v[160:163], v[16:19]
    v_mfma_f32_16x16x32_bf16 v[28:31], a[36:39], v[160:163], v[28:31]
    ds_read_b128 v[180:183], v2 offset:58368
    s_waitcnt lgkmcnt(4)
    v_mfma_f32_16x16x32_bf16 v[20:23], a[32:35], v[164:167], v[20:23]
    v_mfma_f32_16x16x32_bf16 v[32:35], a[36:39], v[164:167], v[32:35]
    ds_read_b128 v[160:163], v2 offset:18432
    s_waitcnt lgkmcnt(4)
    v_mfma_f32_16x16x32_bf16 v[24:27], a[32:35], v[168:171], v[24:27]
    v_mfma_f32_16x16x32_bf16 v[36:39], a[36:39], v[168:171], v[36:39]
    ds_read_b128 v[164:167], v2 offset:38912
    s_waitcnt lgkmcnt(4) vmcnt(4)
    v_mfma_f32_16x16x32_bf16 v[16:19], a[40:43], v[172:175], v[16:19]
    v_mfma_f32_16x16x32_bf16 v[28:31], a[44:47], v[172:175], v[28:31]
    ds_read_b128 v[168:171], v2 offset:59392
    s_waitcnt lgkmcnt(4)
    v_mfma_f32_16x16x32_bf16 v[20:23], a[40:43], v[176:179], v[20:23]
    v_mfma_f32_16x16x32_bf16 v[32:35], a[44:47], v[176:179], v[32:35]
    ds_read_b128 v[172:175], v2 offset:19456
    s_waitcnt lgkmcnt(4)
    v_mfma_f32_16x16x32_bf16 v[24:27], a[40:43], v[180:183], v[24:27]
    v_mfma_f32_16x16x32_bf16 v[36:39], a[44:47], v[180:183], v[36:39]
    ds_read_b128 v[176:179], v2 offset:39936
    s_waitcnt lgkmcnt(4) vmcnt(2)
    v_mfma_f32_16x16x32_bf16 v[16:19], a[48:51], v[160:163], v[16:19]
    v_mfma_f32_16x16x32_bf16 v[28:31], a[52:55], v[160:163], v[28:31]
    ds_read_b128 v[180:183], v2 offset:60416
    s_waitcnt lgkmcnt(4)
    v_mfma_f32_16x16x32_bf16 v[20:23], a[48:51], v[164:167], v[20:23]
    v_mfma_f32_16x16x32_bf16 v[32:35], a[52:55], v[164:167], v[32:35]
    s_waitcnt lgkmcnt(3)
    v_mfma_f32_16x16x32_bf16 v[24:27], a[48:51], v[168:171], v[24:27]
    v_mfma_f32_16x16x32_bf16 v[36:39], a[52:55], v[168:171], v[36:39]
    s_waitcnt lgkmcnt(2) vmcnt(0)
    v_mfma_f32_16x16x32_bf16 v[16:19], a[56:59], v[172:175], v[16:19]
    v_mfma_f32_16x16x32_bf16 v[28:31], a[60:63], v[172:175], v[28:31]
    s_waitcnt lgkmcnt(1)
    v_mfma_f32_16x16x32_bf16 v[20:23], a[56:59], v[176:179], v[20:23]
    v_mfma_f32_16x16x32_bf16 v[32:35], a[60:63], v[176:179], v[32:35]
    s_waitcnt lgkmcnt(0)
    v_mfma_f32_16x16x32_bf16 v[24:27], a[56:59], v[180:183], v[24:27]
    v_mfma_f32_16x16x32_bf16 v[36:39], a[60:63], v[180:183], v[36:39]
    s_barrier
    ds_read_b32 v4, v186 offset:0
    ds_read_b32 v6, v186 offset:64
    ds_read_b32 v8, v186 offset:128
    ds_read_b128 v[160:163], v12 offset:0
    ds_read_b128 v[168:171], v12 offset:128
    ds_read_b128 v[164:167], v12 offset:64
    ds_read_b128 v[172:175], v12 offset:192
    s_waitcnt lgkmcnt(2)
    s_nop 0
    v_pk_fma_f32 v[16:17], v[160:161], v[4:5], v[16:17] op_sel_hi:[1,0,1]
    v_pk_fma_f32 v[18:19], v[162:163], v[4:5], v[18:19] op_sel_hi:[1,0,1]
    v_pk_mul_f32 v[16:17], v[16:17], v[168:169]
    v_pk_mul_f32 v[18:19], v[18:19], v[170:171]
    v_pk_mul_f32 v[176:177], v[16:17], v[16:17]
    v_pk_mul_f32 v[180:181], v[18:19], v[18:19]
    v_pk_fma_f32 v[176:177], v[176:177], s[90:91], v[14:15] op_sel_hi:[1,1,0]
    v_pk_fma_f32 v[180:181], v[180:181], s[90:91], v[14:15] op_sel_hi:[1,1,0]
    v_pk_mul_f32 v[176:177], v[176:177], v[16:17]
    v_pk_mul_f32 v[180:181], v[180:181], v[18:19]
    v_exp_f32 v178, v176
    v_exp_f32 v179, v177
    v_exp_f32 v182, v180
    v_exp_f32 v183, v181
    v_pk_add_f32 v[178:179], v[178:179], 1.0 op_sel_hi:[1,0]
    v_pk_add_f32 v[182:183], v[182:183], 1.0 op_sel_hi:[1,0]
    v_rcp_f32 v176, v178
    v_rcp_f32 v177, v179
    v_rcp_f32 v180, v182
    v_rcp_f32 v181, v183
    v_pk_mul_f32 v[16:17], v[16:17], v[176:177]
    v_pk_mul_f32 v[18:19], v[18:19], v[180:181]
    v_pk_fma_f32 v[20:21], v[160:161], v[6:7], v[20:21] op_sel_hi:[1,0,1]
    v_pk_fma_f32 v[22:23], v[162:163], v[6:7], v[22:23] op_sel_hi:[1,0,1]
    v_pk_mul_f32 v[20:21], v[20:21], v[168:169]
    v_pk_mul_f32 v[22:23], v[22:23], v[170:171]
    v_pk_mul_f32 v[176:177], v[20:21], v[20:21]
    v_pk_mul_f32 v[180:181], v[22:23], v[22:23]
    v_pk_fma_f32 v[176:177], v[176:177], s[90:91], v[14:15] op_sel_hi:[1,1,0]
    v_pk_fma_f32 v[180:181], v[180:181], s[90:91], v[14:15] op_sel_hi:[1,1,0]
    v_pk_mul_f32 v[176:177], v[176:177], v[20:21]
    v_pk_mul_f32 v[180:181], v[180:181], v[22:23]
    v_exp_f32 v178, v176
    v_exp_f32 v179, v177
    v_exp_f32 v182, v180
    v_exp_f32 v183, v181
    v_pk_add_f32 v[178:179], v[178:179], 1.0 op_sel_hi:[1,0]
    v_pk_add_f32 v[182:183], v[182:183], 1.0 op_sel_hi:[1,0]
    v_rcp_f32 v176, v178
    v_rcp_f32 v177, v179
    v_rcp_f32 v180, v182
    v_rcp_f32 v181, v183
    v_pk_mul_f32 v[20:21], v[20:21], v[176:177]
    v_pk_mul_f32 v[22:23], v[22:23], v[180:181]
    v_pk_fma_f32 v[24:25], v[160:161], v[8:9], v[24:25] op_sel_hi:[1,0,1]
    v_pk_fma_f32 v[26:27], v[162:163], v[8:9], v[26:27] op_sel_hi:[1,0,1]
    v_pk_mul_f32 v[24:25], v[24:25], v[168:169]
    v_pk_mul_f32 v[26:27], v[26:27], v[170:171]
    v_pk_mul_f32 v[176:177], v[24:25], v[24:25]
    v_pk_mul_f32 v[180:181], v[26:27], v[26:27]
    v_pk_fma_f32 v[176:177], v[176:177], s[90:91], v[14:15] op_sel_hi:[1,1,0]
    v_pk_fma_f32 v[180:181], v[180:181], s[90:91], v[14:15] op_sel_hi:[1,1,0]
    v_pk_mul_f32 v[176:177], v[176:177], v[24:25]
    v_pk_mul_f32 v[180:181], v[180:181], v[26:27]
    v_exp_f32 v178, v176
    v_exp_f32 v179, v177
    v_exp_f32 v182, v180
    v_exp_f32 v183, v181
    v_pk_add_f32 v[178:179], v[178:179], 1.0 op_sel_hi:[1,0]
    v_pk_add_f32 v[182:183], v[182:183], 1.0 op_sel_hi:[1,0]
    v_rcp_f32 v176, v178
    v_rcp_f32 v177, v179
    v_rcp_f32 v180, v182
    v_rcp_f32 v181, v183
    v_pk_mul_f32 v[24:25], v[24:25], v[176:177]
    v_pk_mul_f32 v[26:27], v[26:27], v[180:181]
    s_waitcnt lgkmcnt(0)
    s_nop 0
    v_pk_fma_f32 v[28:29], v[164:165], v[4:5], v[28:29] op_sel_hi:[1,0,1]
    v_pk_fma_f32 v[30:31], v[166:167], v[4:5], v[30:31] op_sel_hi:[1,0,1]
    v_pk_mul_f32 v[28:29], v[28:29], v[172:173]
    v_pk_mul_f32 v[30:31], v[30:31], v[174:175]
    v_pk_mul_f32 v[176:177], v[28:29], v[28:29]
    v_pk_mul_f32 v[180:181], v[30:31], v[30:31]
    v_pk_fma_f32 v[176:177], v[176:177], s[90:91], v[14:15] op_sel_hi:[1,1,0]
    v_pk_fma_f32 v[180:181], v[180:181], s[90:91], v[14:15] op_sel_hi:[1,1,0]
    v_pk_mul_f32 v[176:177], v[176:177], v[28:29]
    v_pk_mul_f32 v[180:181], v[180:181], v[30:31]
    v_exp_f32 v178, v176
    v_exp_f32 v179, v177
    v_exp_f32 v182, v180
    v_exp_f32 v183, v181
    v_pk_add_f32 v[178:179], v[178:179], 1.0 op_sel_hi:[1,0]
    v_pk_add_f32 v[182:183], v[182:183], 1.0 op_sel_hi:[1,0]
    v_rcp_f32 v176, v178
    v_rcp_f32 v177, v179
    v_rcp_f32 v180, v182
    v_rcp_f32 v181, v183
    v_pk_mul_f32 v[28:29], v[28:29], v[176:177]
    v_pk_mul_f32 v[30:31], v[30:31], v[180:181]
    v_pk_fma_f32 v[32:33], v[164:165], v[6:7], v[32:33] op_sel_hi:[1,0,1]
    v_pk_fma_f32 v[34:35], v[166:167], v[6:7], v[34:35] op_sel_hi:[1,0,1]
    v_pk_mul_f32 v[32:33], v[32:33], v[172:173]
    v_pk_mul_f32 v[34:35], v[34:35], v[174:175]
    v_pk_mul_f32 v[176:177], v[32:33], v[32:33]
    v_pk_mul_f32 v[180:181], v[34:35], v[34:35]
    v_pk_fma_f32 v[176:177], v[176:177], s[90:91], v[14:15] op_sel_hi:[1,1,0]
    v_pk_fma_f32 v[180:181], v[180:181], s[90:91], v[14:15] op_sel_hi:[1,1,0]
    v_pk_mul_f32 v[176:177], v[176:177], v[32:33]
    v_pk_mul_f32 v[180:181], v[180:181], v[34:35]
    v_exp_f32 v178, v176
    v_exp_f32 v179, v177
    v_exp_f32 v182, v180
    v_exp_f32 v183, v181
    v_pk_add_f32 v[178:179], v[178:179], 1.0 op_sel_hi:[1,0]
    v_pk_add_f32 v[182:183], v[182:183], 1.0 op_sel_hi:[1,0]
    v_rcp_f32 v176, v178
    v_rcp_f32 v177, v179
    v_rcp_f32 v180, v182
    v_rcp_f32 v181, v183
    v_pk_mul_f32 v[32:33], v[32:33], v[176:177]
    v_pk_mul_f32 v[34:35], v[34:35], v[180:181]
    v_pk_fma_f32 v[36:37], v[164:165], v[8:9], v[36:37] op_sel_hi:[1,0,1]
    v_pk_fma_f32 v[38:39], v[166:167], v[8:9], v[38:39] op_sel_hi:[1,0,1]
    v_pk_mul_f32 v[36:37], v[36:37], v[172:173]
    v_pk_mul_f32 v[38:39], v[38:39], v[174:175]
    v_pk_mul_f32 v[176:177], v[36:37], v[36:37]
    v_pk_mul_f32 v[180:181], v[38:39], v[38:39]
    v_pk_fma_f32 v[176:177], v[176:177], s[90:91], v[14:15] op_sel_hi:[1,1,0]
    v_pk_fma_f32 v[180:181], v[180:181], s[90:91], v[14:15] op_sel_hi:[1,1,0]
    v_pk_mul_f32 v[176:177], v[176:177], v[36:37]
    v_pk_mul_f32 v[180:181], v[180:181], v[38:39]
    v_exp_f32 v178, v176
    v_exp_f32 v179, v177
    v_exp_f32 v182, v180
    v_exp_f32 v183, v181
    v_pk_add_f32 v[178:179], v[178:179], 1.0 op_sel_hi:[1,0]
    v_pk_add_f32 v[182:183], v[182:183], 1.0 op_sel_hi:[1,0]
    v_rcp_f32 v176, v178
    v_rcp_f32 v177, v179
    v_rcp_f32 v180, v182
    v_rcp_f32 v181, v183
    v_pk_mul_f32 v[36:37], v[36:37], v[176:177]
    v_pk_mul_f32 v[38:39], v[38:39], v[180:181]
    v_pk_add_f32 v[160:161], v[16:17], v[20:21]
    v_pk_mul_f32 v[168:169], v[16:17], v[16:17]
    v_pk_add_f32 v[160:161], v[160:161], v[24:25]
    v_pk_fma_f32 v[168:169], v[20:21], v[20:21], v[168:169]
    v_pk_fma_f32 v[168:169], v[24:25], v[24:25], v[168:169]
    v_pk_add_f32 v[162:163], v[18:19], v[22:23]
    v_pk_mul_f32 v[170:171], v[18:19], v[18:19]
    v_pk_add_f32 v[162:163], v[162:163], v[26:27]
    v_pk_fma_f32 v[170:171], v[22:23], v[22:23], v[170:171]
    v_pk_fma_f32 v[170:171], v[26:27], v[26:27], v[170:171]
    v_pk_add_f32 v[164:165], v[28:29], v[32:33]
    v_pk_mul_f32 v[172:173], v[28:29], v[28:29]
    v_pk_add_f32 v[164:165], v[164:165], v[36:37]
    v_pk_fma_f32 v[172:173], v[32:33], v[32:33], v[172:173]
    v_pk_fma_f32 v[172:173], v[36:37], v[36:37], v[172:173]
    v_pk_add_f32 v[166:167], v[30:31], v[34:35]
    v_pk_mul_f32 v[174:175], v[30:31], v[30:31]
    v_pk_add_f32 v[166:167], v[166:167], v[38:39]
    v_pk_fma_f32 v[174:175], v[34:35], v[34:35], v[174:175]
    v_pk_fma_f32 v[174:175], v[38:39], v[38:39], v[174:175]
    v_add_f32_dpp v160, v160, v160 row_ror:8 row_mask:0xf bank_mask:0xf
    v_add_f32_dpp v161, v161, v161 row_ror:8 row_mask:0xf bank_mask:0xf
    v_add_f32_dpp v162, v162, v162 row_ror:8 row_mask:0xf bank_mask:0xf
    v_add_f32_dpp v163, v163, v163 row_ror:8 row_mask:0xf bank_mask:0xf
    v_add_f32_dpp v168, v168, v168 row_ror:8 row_mask:0xf bank_mask:0xf
    v_add_f32_dpp v169, v169, v169 row_ror:8 row_mask:0xf bank_mask:0xf
    v_add_f32_dpp v170, v170, v170 row_ror:8 row_mask:0xf bank_mask:0xf
    v_add_f32_dpp v171, v171, v171 row_ror:8 row_mask:0xf bank_mask:0xf
    v_add_f32_dpp v160, v164, v164 row_ror:8 row_mask:0xf bank_mask:0xc
    v_add_f32_dpp v161, v165, v165 row_ror:8 row_mask:0xf bank_mask:0xc
    v_add_f32_dpp v162, v166, v166 row_ror:8 row_mask:0xf bank_mask:0xc
    v_add_f32_dpp v163, v167, v167 row_ror:8 row_mask:0xf bank_mask:0xc
    v_add_f32_dpp v168, v172, v172 row_ror:8 row_mask:0xf bank_mask:0xc
    v_add_f32_dpp v169, v173, v173 row_ror:8 row_mask:0xf bank_mask:0xc
    v_add_f32_dpp v170, v174, v174 row_ror:8 row_mask:0xf bank_mask:0xc
    v_add_f32_dpp v171, v175, v175 row_ror:8 row_mask:0xf bank_mask:0xc
    v_add_f32_dpp v176, v160, v160 row_half_mirror row_mask:0xf bank_mask:0xf
    v_add_f32_dpp v177, v168, v168 row_half_mirror row_mask:0xf bank_mask:0xf
    v_add_f32_dpp v178, v161, v161 row_half_mirror row_mask:0xf bank_mask:0xf
    v_add_f32_dpp v179, v169, v169 row_half_mirror row_mask:0xf bank_mask:0xf
    v_add_f32_dpp v176, v162, v162 row_half_mirror row_mask:0xf bank_mask:0xa
    v_add_f32_dpp v177, v170, v170 row_half_mirror row_mask:0xf bank_mask:0xa
    v_add_f32_dpp v178, v163, v163 row_half_mirror row_mask:0xf bank_mask:0xa
    v_add_f32_dpp v179, v171, v171 row_half_mirror row_mask:0xf bank_mask:0xa
    v_add_f32_dpp v176, v176, v176 quad_perm:[1,0,3,2] row_mask:0xf bank_mask:0xf
    v_add_f32_dpp v177, v177, v177 quad_perm:[1,0,3,2] row_mask:0xf bank_mask:0xf
    v_add_f32_dpp v178, v178, v178 quad_perm:[1,0,3,2] row_mask:0xf bank_mask:0xf
    v_add_f32_dpp v179, v179, v179 quad_perm:[1,0,3,2] row_mask:0xf bank_mask:0xf
    v_add_f32_dpp v176, v176, v176 quad_perm:[2,3,0,1] row_mask:0xf bank_mask:0xf
    v_add_f32_dpp v177, v177, v177 quad_perm:[2,3,0,1] row_mask:0xf bank_mask:0xf
    v_add_f32_dpp v178, v178, v178 quad_perm:[2,3,0,1] row_mask:0xf bank_mask:0xf
    v_add_f32_dpp v179, v179, v179 quad_perm:[2,3,0,1] row_mask:0xf bank_mask:0xf
    s_bfe_u32 s72, s96, 0x80000
    v_and_or_b32 v176, v176, v188, s72
    s_bfe_u32 s72, s96, 0x80008
    v_and_or_b32 v177, v177, v188, s72
    s_bfe_u32 s72, s96, 0x80010
    v_and_or_b32 v178, v178, v188, s72
    s_bfe_u32 s72, s96, 0x80018
    v_and_or_b32 v179, v179, v188, s72
    s_mov_b32 exec_lo, 0x11111111
    s_mov_b32 exec_hi, 0x11111111
    s_cmp_eq_u32 s97, 0
    s_cbranch_scc1 zs_slow_15
    buffer_store_dwordx4 v[176:179], v187, s[44:47], s84 offen
    s_branch zs_done_16
zs_slow_15:
    buffer_store_dwordx4 v[176:179], v187, s[44:47], s84 offen sc1
zs_done_16:
    s_mov_b64 exec, -1
    s_barrier
    ds_read_b128 v[160:163], v184 offset:0
    ds_read_b128 v[164:167], v184 offset:20480
    ds_read_b128 v[168:171], v184 offset:40960
    ds_read_b128 v[172:175], v184 offset:1024
    ds_read_b128 v[176:179], v184 offset:21504
    s_waitcnt lgkmcnt(4)
    v_mfma_f32_16x16x32_bf16 v[40:43], v[160:163], v[64:67], 0
    v_mfma_f32_16x16x32_bf16 v[52:55], v[160:163], v[68:71], 0
    ds_read_b128 v[180:183], v184 offset:41984
    s_waitcnt lgkmcnt(4)
    v_mfma_f32_16x16x32_bf16 v[44:47], v[164:167], v[64:67], 0
    v_mfma_f32_16x16x32_bf16 v[56:59], v[164:167], v[68:71], 0
    ds_read_b128 v[160:163], v184 offset:2048
    s_waitcnt lgkmcnt(4)
    v_mfma_f32_16x16x32_bf16 v[48:51], v[168:171], v[64:67], 0
    v_mfma_f32_16x16x32_bf16 v[60:63], v[168:171], v[68:71], 0
    ds_read_b128 v[164:167], v184 offset:22528
    s_waitcnt lgkmcnt(4)
    v_mfma_f32_16x16x32_bf16 v[40:43], v[172:175], v[72:75], v[40:43]
    v_mfma_f32_16x16x32_bf16 v[52:55], v[172:175], v[76:79], v[52:55]
    ds_read_b128 v[168:171], v184 offset:43008
    s_waitcnt lgkmcnt(4)
    v_mfma_f32_16x16x32_bf16 v[44:47], v[176:179], v[72:75], v[44:47]
    v_mfma_f32_16x16x32_bf16 v[56:59], v[176:179], v[76:79], v[56:59]
    ds_read_b128 v[172:175], v184 offset:3072
    s_waitcnt lgkmcnt(4)
    v_mfma_f32_16x16x32_bf16 v[48:51], v[180:183], v[72:75], v[48:51]
    v_mfma_f32_16x16x32_bf16 v[60:63], v[180:183], v[76:79], v[60:63]
    ds_read_b128 v[176:179], v184 offset:23552
    s_waitcnt lgkmcnt(4)
    v_mfma_f32_16x16x32_bf16 v[40:43], v[160:163], v[80:83], v[40:43]
    v_mfma_f32_16x16x32_bf16 v[52:55], v[160:163], v[84:87], v[52:55]
    ds_read_b128 v[180:183], v184 offset:44032
    s_waitcnt lgkmcnt(4)
    v_mfma_f32_16x16x32_bf16 v[44:47], v[164:167], v[80:83], v[44:47]
    v_mfma_f32_16x16x32_bf16 v[56:59], v[164:167], v[84:87], v[56:59]
    ds_read_b128 v[160:163], v184 offset:4096
    s_waitcnt lgkmcnt(4)
    v_mfma_f32_16x16x32_bf16 v[48:51], v[168:171], v[80:83], v[48:51]
    v_mfma_f32_16x16x32_bf16 v[60:63], v[168:171], v[84:87], v[60:63]
    ds_read_b128 v[164:167], v184 offset:24576
    s_waitcnt lgkmcnt(4)
    v_mfma_f32_16x16x32_bf16 v[40:43], v[172:175], v[88:91], v[40:43]
    v_mfma_f32_16x16x32_bf16 v[52:55], v[172:175], v[92:95], v[52:55]
    ds_read_b128 v[168:171], v184 offset:45056
    s_waitcnt lgkmcnt(4)
    v_mfma_f32_16x16x32_bf16 v[44:47], v[176:179], v[88:91], v[44:47]
    v_mfma_f32_16x16x32_bf16 v[56:59], v[176:179], v[92:95], v[56:59]
    ds_read_b128 v[172:175], v184 offset:5120
    s_waitcnt lgkmcnt(4)
    v_mfma_f32_16x16x32_bf16 v[48:51], v[180:183], v[88:91], v[48:51]
    v_mfma_f32_16x16x32_bf16 v[60:63], v[180:183], v[92:95], v[60:63]
    ds_read_b128 v[176:179], v184 offset:25600
    s_waitcnt lgkmcnt(4)
    v_mfma_f32_16x16x32_bf16 v[40:43], v[160:163], v[96:99], v[40:43]
    v_mfma_f32_16x16x32_bf16 v[52:55], v[160:163], v[100:103], v[52:55]
    ds_read_b128 v[180:183], v184 offset:46080
    s_waitcnt lgkmcnt(4)
    v_mfma_f32_16x16x32_bf16 v[44:47], v[164:167], v[96:99], v[44:47]
    v_mfma_f32_16x16x32_bf16 v[56:59], v[164:167], v[100:103], v[56:59]
    s_waitcnt lgkmcnt(3)
    v_mfma_f32_16x16x32_bf16 v[48:51], v[168:171], v[96:99], v[48:51]
    v_mfma_f32_16x16x32_bf16 v[60:63], v[168:171], v[100:103], v[60:63]
    s_waitcnt lgkmcnt(2)
    v_mfma_f32_16x16x32_bf16 v[40:43], v[172:175], v[104:107], v[40:43]
    v_mfma_f32_16x16x32_bf16 v[52:55], v[172:175], v[108:111], v[52:55]
    s_waitcnt lgkmcnt(1)
    v_mfma_f32_16x16x32_bf16 v[44:47], v[176:179], v[104:107], v[44:47]
    v_mfma_f32_16x16x32_bf16 v[56:59], v[176:179], v[108:111], v[56:59]
    s_waitcnt lgkmcnt(0)
    v_mfma_f32_16x16x32_bf16 v[48:51], v[180:183], v[104:107], v[48:51]
    v_mfma_f32_16x16x32_bf16 v[60:63], v[180:183], v[108:111], v[60:63]
    s_mov_b32 s98, 0x100000
    s_mov_b32 s72, 0x0c0c0400
    s_mov_b32 s73, 0x05040100
zl_17:
    buffer_load_dwordx4 v[160:163], v13, s[44:47], s83 offen offset:0 sc1
    buffer_load_dwordx4 v[164:167], v13, s[44:47], s83 offen offset:64 sc1
    buffer_load_dwordx4 v[168:171], v13, s[44:47], s83 offen offset:128 sc1
    buffer_load_dwordx4 v[172:175], v13, s[44:47], s83 offen offset:192 sc1
    s_waitcnt vmcnt(3)
    v_perm_b32 v4, v161, v160, s72
    v_perm_b32 v5, v163, v162, s72
    v_perm_b32 v6, v5, v4, s73
    s_waitcnt vmcnt(2)
    v_perm_b32 v4, v165, v164, s72
    v_perm_b32 v5, v167, v166, s72
    v_perm_b32 v7, v5, v4, s73
    s_waitcnt vmcnt(1)
    v_perm_b32 v4, v169, v168, s72
    v_perm_b32 v5, v171, v170, s72
    v_perm_b32 v8, v5, v4, s73
    s_waitcnt vmcnt(0)
    v_perm_b32 v4, v173, v172, s72
    v_perm_b32 v5, v175, v174, s72
    v_perm_b32 v9, v5, v4, s73
    v_xor_b32 v6, s96, v6
    v_xor_b32 v7, s96, v7
    v_xor_b32 v8, s96, v8
    v_xor_b32_e64 v9, s96, v9
    v_or3_b32 v6, v6, v7, v8
    v_or_b32_e64 v6, v6, v9
    v_cmp_ne_u32 vcc, 0, v6
    s_cbranch_vccz zlok_18
    s_sub_u32 s98, s98, 1
    s_cbranch_scc0 zl_17
zlok_18:
    v_pk_add_f32 v[160:161], v[160:161], v[164:165]
    v_pk_add_f32 v[168:169], v[168:169], v[172:173]
    v_pk_add_f32 v[162:163], v[162:163], v[166:167]
    v_pk_add_f32 v[170:171], v[170:171], v[174:175]
    v_pk_add_f32 v[160:161], v[160:161], v[168:169]
    v_pk_add_f32 v[162:163], v[162:163], v[170:171]
    s_nop 0
    s_nop 0
    v_add_f32_dpp v160, v160, v160 quad_perm:[1,0,3,2] row_mask:0xf bank_mask:0xf
    v_add_f32_dpp v161, v161, v161 quad_perm:[1,0,3,2] row_mask:0xf bank_mask:0xf
    v_add_f32_dpp v162, v162, v162 quad_perm:[1,0,3,2] row_mask:0xf bank_mask:0xf
    v_add_f32_dpp v163, v163, v163 quad_perm:[1,0,3,2] row_mask:0xf bank_mask:0xf
    v_add_f32_dpp v160, v160, v160 quad_perm:[2,3,0,1] row_mask:0xf bank_mask:0xf
    v_add_f32_dpp v161, v161, v161 quad_perm:[2,3,0,1] row_mask:0xf bank_mask:0xf
    v_add_f32_dpp v162, v162, v162 quad_perm:[2,3,0,1] row_mask:0xf bank_mask:0xf
    v_add_f32_dpp v163, v163, v163 quad_perm:[2,3,0,1] row_mask:0xf bank_mask:0xf
    v_mul_f32 v160, s89, v160
    v_mul_f32 v162, s89, v162
    v_mul_f32 v164, v160, v160
    v_mul_f32 v165, v162, v162
    v_fma_f32 v161, v161, s89, -v164
    v_fma_f32 v163, v163, s89, -v165
    v_add_f32 v161, s87, v161
    v_add_f32 v163, s87, v163
    v_rsq_f32 v161, v161
    v_rsq_f32 v163, v163
    v_mul_f32 v160, -v160, v161
    v_mul_f32 v162, -v162, v163
    s_nop 0
    s_nop 0
    v_mov_b32_dpp v168, v160 row_newbcast:0 row_mask:0xf bank_mask:0xf
    v_mov_b32_dpp v176, v161 row_newbcast:0 row_mask:0xf bank_mask:0xf
    v_mov_b32_dpp v169, v162 row_newbcast:0 row_mask:0xf bank_mask:0xf
    v_mov_b32_dpp v177, v163 row_newbcast:0 row_mask:0xf bank_mask:0xf
    v_mov_b32_dpp v170, v160 row_newbcast:4 row_mask:0xf bank_mask:0xf
    v_mov_b32_dpp v178, v161 row_newbcast:4 row_mask:0xf bank_mask:0xf
    v_mov_b32_dpp v171, v162 row_newbcast:4 row_mask:0xf bank_mask:0xf
    v_mov_b32_dpp v179, v163 row_newbcast:4 row_mask:0xf bank_mask:0xf
    v_mov_b32_dpp v172, v160 row_newbcast:8 row_mask:0xf bank_mask:0xf
    v_mov_b32_dpp v180, v161 row_newbcast:8 row_mask:0xf bank_mask:0xf
    v_mov_b32_dpp v173, v162 row_newbcast:8 row_mask:0xf bank_mask:0xf
    v_mov_b32_dpp v181, v163 row_newbcast:8 row_mask:0xf bank_mask:0xf
    v_mov_b32_dpp v174, v160 row_newbcast:12 row_mask:0xf bank_mask:0xf
    v_mov_b32_dpp v182, v161 row_newbcast:12 row_mask:0xf bank_mask:0xf
    v_mov_b32_dpp v175, v162 row_newbcast:12 row_mask:0xf bank_mask:0xf
    v_mov_b32_dpp v183, v163 row_newbcast:12 row_mask:0xf bank_mask:0xf
    v_pk_fma_f32 v[16:17], v[16:17], v[176:177], v[168:169]
    v_pk_fma_f32 v[18:19], v[18:19], v[178:179], v[170:171]
    v_pk_fma_f32 v[28:29], v[28:29], v[180:181], v[172:173]
    v_pk_fma_f32 v[30:31], v[30:31], v[182:183], v[174:175]
    v_cvt_pk_bf16_f32 v160, v16, v28
    v_cvt_pk_bf16_f32 v161, v17, v29
    v_cvt_pk_bf16_f32 v162, v18, v30
    v_cvt_pk_bf16_f32 v163, v19, v31
    buffer_store_dwordx4 v[160:163], v2, s[44:47], s85 offen sc1
    v_pk_fma_f32 v[20:21], v[20:21], v[176:177], v[168:169]
    v_pk_fma_f32 v[22:23], v[22:23], v[178:179], v[170:171]
    v_pk_fma_f32 v[32:33], v[32:33], v[180:181], v[172:173]
    v_pk_fma_f32 v[34:35], v[34:35], v[182:183], v[174:175]
    v_cvt_pk_bf16_f32 v164, v20, v32
    v_cvt_pk_bf16_f32 v165, v21, v33
    v_cvt_pk_bf16_f32 v166, v22, v34
    v_cvt_pk_bf16_f32 v167, v23, v35
    buffer_store_dwordx4 v[164:167], v2, s[44:47], s92 offen sc1
    v_pk_fma_f32 v[24:25], v[24:25], v[176:177], v[168:169]
    v_pk_fma_f32 v[26:27], v[26:27], v[178:179], v[170:171]
    v_pk_fma_f32 v[36:37], v[36:37], v[180:181], v[172:173]
    v_pk_fma_f32 v[38:39], v[38:39], v[182:183], v[174:175]
    v_cvt_pk_bf16_f32 v4, v24, v36
    v_cvt_pk_bf16_f32 v5, v25, v37
    v_cvt_pk_bf16_f32 v6, v26, v38
    v_cvt_pk_bf16_f32 v7, v27, v39
    buffer_store_dwordx4 v[4:7], v2, s[44:47], s93 offen sc1
    s_sub_u32 s64, s59, s52
    s_lshr_b32 s63, s54, 3
    s_and_b32 s62, s63, 1
    s_lshl_b32 s62, s62, 1
    s_add_u32 s64, s64, s62
    s_lshl_b32 s64, s64, 1
    s_add_u32 s64, s64, s52
    s_and_b32 s62, s54, 7
    s_sub_u32 s61, s64, s52
    s_lshr_b32 s61, s61, 1
    s_lshl_b32 s63, s63, 1
    s_add_u32 s63, s63, s62
    s_sub_u32 s8, s59, s52
    s_lshr_b32 s10, s54, 3
    s_and_b32 s9, s10, 1
    s_lshl_b32 s9, s9, 1
    s_add_u32 s8, s8, s9
    s_lshl_b32 s8, s8, 1
    s_add_u32 s8, s8, s52
    s_and_b32 s9, s54, 7
    s_cmp_ge_u32 s9, 4
    s_cselect_b32 s72, -1, 1
    s_cselect_b32 s73, 956, 0
    s_cselect_b64 vcc, -1, 0
    s_mov_b64 s[94:95], vcc
    s_mul_i32 s74, s9, 80
    v_lshrrev_b32_e64 v36, 4, v1
    v_lshl_add_u32 v36, v36, 2, s74
    v_mul_lo_u32 v36, v36, s72
    v_add_u32 v36, s73, v36
    v_and_b32 v37, 15, v1
    v_lshlrev_b32 v37, 4, v37
    s_lshl_b32 s72, s72, 4
    s_mul_i32 s75, s8, 20480
    s_add_u32 s75, s75, 1572864
    v_add_u32 v10, 0, v36
    v_lshrrev_b32 v11, 3, v10
    v_lshl_add_u32 v11, v11, 8, v37
    v_and_b32_e64 v10, 7, v10
    v_lshl_add_u32 v10, v10, 1, v11
    buffer_load_dwordx2 v[16:17], v10, s[44:47], s75 offen sc1
    v_add_u32_e64 v10, 4, v36
    v_cmp_eq_u32 vcc, 640, v10
    v_mov_b32 v11, 320
    s_nop 0
    v_cndmask_b32 v10, v10, v11, vcc
    v_lshrrev_b32_e64 v11, 3, v10
    v_lshl_add_u32 v11, v11, 8, v37
    v_and_b32_e64 v10, 7, v10
    v_lshl_add_u32 v10, v10, 1, v11
    buffer_load_dword v26, v10, s[44:47], s75 offen sc1
    v_add_u32 v36, s72, v36
    v_add_u32 v10, 0, v36
    v_lshrrev_b32_e64 v11, 3, v10
    v_lshl_add_u32 v11, v11, 8, v37
    v_and_b32_e64 v10, 7, v10
    v_lshl_add_u32 v10, v10, 1, v11
    buffer_load_dwordx2 v[18:19], v10, s[44:47], s75 offen sc1
    v_add_u32 v10, 4, v36
    v_lshrrev_b32 v11, 3, v10
    v_lshl_add_u32 v11, v11, 8, v37
    v_and_b32_e64 v10, 7, v10
    v_lshl_add_u32 v10, v10, 1, v11
    buffer_load_dword v28, v10, s[44:47], s75 offen sc1
    v_add_u32 v36, s72, v36
    v_add_u32 v10, 0, v36
    v_lshrrev_b32_e64 v11, 3, v10
    v_lshl_add_u32 v11, v11, 8, v37
    v_and_b32_e64 v10, 7, v10
    v_lshl_add_u32 v10, v10, 1, v11
    buffer_load_dwordx2 v[20:21], v10, s[44:47], s75 offen sc1
    v_add_u32 v10, 4, v36
    v_lshrrev_b32 v11, 3, v10
    v_lshl_add_u32 v11, v11, 8, v37
    v_and_b32_e64 v10, 7, v10
    v_lshl_add_u32 v10, v10, 1, v11
    buffer_load_dword v30, v10, s[44:47], s75 offen sc1
    v_add_u32 v36, s72, v36
    v_add_u32 v10, 0, v36
    v_lshrrev_b32_e64 v11, 3, v10
    v_lshl_add_u32 v11, v11, 8, v37
    v_and_b32_e64 v10, 7, v10
    v_lshl_add_u32 v10, v10, 1, v11
    buffer_load_dwordx2 v[22:23], v10, s[44:47], s75 offen sc1
    v_add_u32 v10, 4, v36
    v_lshrrev_b32 v11, 3, v10
    v_lshl_add_u32 v11, v11, 8, v37
    v_and_b32_e64 v10, 7, v10
    v_lshl_add_u32 v10, v10, 1, v11
    buffer_load_dword v32, v10, s[44:47], s75 offen sc1
    v_add_u32 v36, s72, v36
    v_add_u32 v10, 0, v36
    v_lshrrev_b32_e64 v11, 3, v10
    v_lshl_add_u32 v11, v11, 8, v37
    v_and_b32_e64 v10, 7, v10
    v_lshl_add_u32 v10, v10, 1, v11
    buffer_load_dwordx2 v[24:25], v10, s[44:47], s75 offen sc1
    v_add_u32 v10, 4, v36
    v_lshrrev_b32 v11, 3, v10
    v_lshl_add_u32 v11, v11, 8, v37
    v_and_b32_e64 v10, 7, v10
    v_lshl_add_u32 v10, v10, 1, v11
    buffer_load_dword v34, v10, s[44:47], s75 offen sc1
    s_mul_i32 s65, s52, 14336
    s_lshl_b32 s66, s52, 13
    s_add_u32 s66, s66, 122880
    s_lshl_b32 s67, s52, 11
    s_cmp_lt_u32 s52, 2
    s_cselect_b32 s77, 0, 94208
    s_add_u32 s67, s67, s77
    s_add_u32 s67, s67, 57344
    v_and_b32 v10, 15, v1
    v_lshlrev_b32 v12, 7, v10
    v_lshrrev_b32 v10, 1, v10
    v_lshrrev_b32 v11, 4, v1
    v_xor_b32_e64 v10, v10, v11
    v_lshl_add_u32 v12, v10, 4, v12
    v_xor_b32 v13, 64, v12
    v_add_u32 v185, s65, v12
    v_add_u32 v186, s65, v13
    v_add_u32 v187, s66, v12
    v_add_u32 v188, s66, v13
    v_add_u32 v189, s67, v12
    v_add_u32 v190, s67, v13
    v_and_b32 v10, 15, v1
    v_lshlrev_b32 v10, 2, v10
    s_lshr_b32 s72, s64, 1
    s_lshl_b32 s72, s72, 5
    s_and_b32 s73, s64, 1
    s_add_u32 s72, s72, s73
    s_lshl_b32 s72, s72, 1
    v_mov_b32_e64 v191, 0
    buffer_load_short_d16_hi v191, v10, s[32:35], s72 offen
    s_mul_i32 s72, s62, 384
    s_lshl_b32 s73, s52, 4
    s_add_u32 s72, s72, s73
    s_lshl_b32 s72, s72, 10
    s_add_u32 s72, s72, 4718592
    s_lshl_b32 s73, s63, 1
    s_add_u32 s74, s73, 0
    s_and_b32 s74, s74, 15
    s_lshl_b32 s74, s74, 10
    s_add_u32 s80, s74, s72
    s_add_u32 s74, s73, 1
    s_and_b32 s74, s74, 15
    s_lshl_b32 s74, s74, 10
    s_add_u32 s81, s74, s72
    s_add_u32 s74, s73, 2
    s_and_b32 s74, s74, 15
    s_lshl_b32 s74, s74, 10
    s_add_u32 s82, s74, s72
    s_add_u32 s74, s73, 3
    s_and_b32 s74, s74, 15
    s_lshl_b32 s74, s74, 10
    s_add_u32 s83, s74, s72
    s_add_u32 s74, s73, 4
    s_and_b32 s74, s74, 15
    s_lshl_b32 s74, s74, 10
    s_add_u32 s84, s74, s72
    s_add_u32 s74, s73, 5
    s_and_b32 s74, s74, 15
    s_lshl_b32 s74, s74, 10
    s_add_u32 s85, s74, s72
    v_mov_b32 v3, v2
    v_lshlrev_b32 v8, 3, v1
    s_mul_i32 s70, s64, 24576
    s_mul_i32 s73, s62, 3072
    s_add_u32 s70, s70, 8388608
    s_add_u32 s70, s70, s73
    s_lshr_b32 s74, s64, 1
    s_lshl_b32 s74, s74, 6
    s_lshl_b32 s75, s62, 3
    s_add_u32 s74, s74, s75
    s_add_u32 s74, s74, 24576
    v_and_b32 v9, 1, v1
    v_lshl_add_u32 v9, v9, 2, s74
    s_waitcnt vmcnt(11)
    s_add_u32 s72, s52, 1
    s_and_b32 s72, s72, 3
    s_mul_i32 s72, s72, 7168
    s_add_u32 s72, s72, 0
    v_add_u32_e64 v5, s72, v2
    s_add_u32 s72, s52, 2
    s_and_b32 s72, s72, 3
    s_mul_i32 s72, s72, 7168
    s_add_u32 s72, s72, 1024
    v_add_u32_e64 v6, s72, v2
    s_add_u32 s72, s52, 3
    s_and_b32 s72, s72, 3
    s_mul_i32 s72, s72, 7168
    s_add_u32 s72, s72, 2048
    v_add_u32_e64 v7, s72, v2
    s_mul_i32 s72, s52, 7168
    v_add_u32 v4, s72, v2
    s_barrier
    s_cmp_lg_u32 s52, 0
    s_cbranch_scc1 skip_19
    s_lshr_b32 s99, s60, 1
    s_lshl_b32 s99, s99, 5
    s_lshr_b32 s72, s59, 2
    s_lshl_b32 s72, s72, 1
    s_add_u32 s99, s99, s72
    s_and_b32 s72, s60, 1
    s_add_u32 s99, s99, s72
    s_lshl_b32 s72, s99, 7
    s_add_u32 s72, s72, 1474560
    v_mov_b32 v10, s96
    v_mov_b32_e64 v11, 0
    s_mov_b64 exec, 1
    buffer_store_dword v10, v11, s[44:47], s72 offen sc1
    s_mov_b64 exec, -1
skip_19:
    ds_read_b128 v[160:163], v184 offset:6144
    ds_read_b128 v[164:167], v184 offset:26624
    ds_read_b128 v[168:171], v184 offset:47104
    ds_read_b128 v[172:175], v184 offset:7168
    ds_read_b128 v[176:179], v184 offset:27648
    s_waitcnt lgkmcnt(4)
    v_mfma_f32_16x16x32_bf16 v[40:43], v[160:163], v[112:115], v[40:43]
    v_mfma_f32_16x16x32_bf16 v[52:55], v[160:163], v[116:119], v[52:55]
    ds_read_b128 v[180:183], v184 offset:48128
    s_waitcnt lgkmcnt(4)
    v_mfma_f32_16x16x32_bf16 v[44:47], v[164:167], v[112:115], v[44:47]
    v_mfma_f32_16x16x32_bf16 v[56:59], v[164:167], v[116:119], v[56:59]
    ds_read_b128 v[160:163], v184 offset:8192
    s_waitcnt lgkmcnt(4)
    v_mfma_f32_16x16x32_bf16 v[48:51], v[168:171], v[112:115], v[48:51]
    v_mfma_f32_16x16x32_bf16 v[60:63], v[168:171], v[116:119], v[60:63]
    ds_read_b128 v[164:167], v184 offset:28672
    s_waitcnt lgkmcnt(4)
    v_mfma_f32_16x16x32_bf16 v[40:43], v[172:175], v[120:123], v[40:43]
    v_mfma_f32_16x16x32_bf16 v[52:55], v[172:175], v[124:127], v[52:55]
    ds_read_b128 v[168:171], v184 offset:49152
    s_waitcnt lgkmcnt(4)
    v_mfma_f32_16x16x32_bf16 v[44:47], v[176:179], v[120:123], v[44:47]
    v_mfma_f32_16x16x32_bf16 v[56:59], v[176:179], v[124:127], v[56:59]
    ds_read_b128 v[172:175], v184 offset:9216
    s_waitcnt lgkmcnt(4)
    v_mfma_f32_16x16x32_bf16 v[48:51], v[180:183], v[120:123], v[48:51]
    v_mfma_f32_16x16x32_bf16 v[60:63], v[180:183], v[124:127], v[60:63]
    ds_read_b128 v[176:179], v184 offset:29696
    s_waitcnt lgkmcnt(4)
    v_mfma_f32_16x16x32_bf16 v[40:43], v[160:163], v[128:131], v[40:43]
    v_mfma_f32_16x16x32_bf16 v[52:55], v[160:163], v[132:135], v[52:55]
    ds_read_b128 v[180:183], v184 offset:50176
    s_waitcnt lgkmcnt(4)
    v_mfma_f32_16x16x32_bf16 v[44:47], v[164:167], v[128:131], v[44:47]
    v_mfma_f32_16x16x32_bf16 v[56:59], v[164:167], v[132:135], v[56:59]
    ds_read_b128 v[160:163], v184 offset:10240
    s_waitcnt lgkmcnt(4)
    v_mfma_f32_16x16x32_bf16 v[48:51], v[168:171], v[128:131], v[48:51]
    v_mfma_f32_16x16x32_bf16 v[60:63], v[168:171], v[132:135], v[60:63]
    ds_read_b128 v[164:167], v184 offset:30720
    s_waitcnt lgkmcnt(4)
    v_mfma_f32_16x16x32_bf16 v[40:43], v[172:175], v[136:139], v[40:43]
    v_mfma_f32_16x16x32_bf16 v[52:55], v[172:175], v[140:143], v[52:55]
    ds_read_b128 v[168:171], v184 offset:51200
    s_waitcnt lgkmcnt(4)
    v_mfma_f32_16x16x32_bf16 v[44:47], v[176:179], v[136:139], v[44:47]
    v_mfma_f32_16x16x32_bf16 v[56:59], v[176:179], v[140:143], v[56:59]
    ds_read_b128 v[172:175], v184 offset:11264
    s_waitcnt lgkmcnt(4)
    v_mfma_f32_16x16x32_bf16 v[48:51], v[180:183], v[136:139], v[48:51]
    v_mfma_f32_16x16x32_bf16 v[60:63], v[180:183], v[140:143], v[60:63]
    ds_read_b128 v[176:179], v184 offset:31744
    s_waitcnt lgkmcnt(4)
    v_mfma_f32_16x16x32_bf16 v[40:43], v[160:163], v[144:147], v[40:43]
    v_mfma_f32_16x16x32_bf16 v[52:55], v[160:163], v[148:151], v[52:55]
    ds_read_b128 v[180:183], v184 offset:52224
    s_waitcnt lgkmcnt(4)
    v_mfma_f32_16x16x32_bf16 v[44:47], v[164:167], v[144:147], v[44:47]
    v_mfma_f32_16x16x32_bf16 v[56:59], v[164:167], v[148:151], v[56:59]
    ds_read_b128 v[160:163], v184 offset:12288
    s_waitcnt lgkmcnt(4)
    v_mfma_f32_16x16x32_bf16 v[48:51], v[168:171], v[144:147], v[48:51]
    v_mfma_f32_16x16x32_bf16 v[60:63], v[168:171], v[148:151], v[60:63]
    ds_read_b128 v[164:167], v184 offset:32768
    s_waitcnt lgkmcnt(4)
    v_mfma_f32_16x16x32_bf16 v[40:43], v[172:175], v[152:155], v[40:43]
    v_mfma_f32_16x16x32_bf16 v[52:55], v[172:175], v[156:159], v[52:55]
    ds_read_b128 v[168:171], v184 offset:53248
    s_waitcnt lgkmcnt(4)
    v_mfma_f32_16x16x32_bf16 v[44:47], v[176:179], v[152:155], v[44:47]
    v_mfma_f32_16x16x32_bf16 v[56:59], v[176:179], v[156:159], v[56:59]
    ds_read_b128 v[172:175], v184 offset:13312
    s_waitcnt lgkmcnt(4)
    v_mfma_f32_16x16x32_bf16 v[48:51], v[180:183], v[152:155], v[48:51]
    v_mfma_f32_16x16x32_bf16 v[60:63], v[180:183], v[156:159], v[60:63]
    ds_read_b128 v[176:179], v184 offset:33792
    s_waitcnt lgkmcnt(4)
    v_mfma_f32_16x16x32_bf16 v[40:43], v[160:163], a[0:3], v[40:43]
    v_mfma_f32_16x16x32_bf16 v[52:55], v[160:163], a[4:7], v[52:55]
    ds_read_b128 v[180:183], v184 offset:54272
    s_waitcnt lgkmcnt(4)
    v_mfma_f32_16x16x32_bf16 v[44:47], v[164:167], a[0:3], v[44:47]
    v_mfma_f32_16x16x32_bf16 v[56:59], v[164:167], a[4:7], v[56:59]
    ds_read_b128 v[160:163], v184 offset:14336
    s_waitcnt lgkmcnt(4)
    v_mfma_f32_16x16x32_bf16 v[48:51], v[168:171], a[0:3], v[48:51]
    v_mfma_f32_16x16x32_bf16 v[60:63], v[168:171], a[4:7], v[60:63]
    ds_read_b128 v[164:167], v184 offset:34816
    s_waitcnt lgkmcnt(4)
    v_mfma_f32_16x16x32_bf16 v[40:43], v[172:175], a[8:11], v[40:43]
    v_mfma_f32_16x16x32_bf16 v[52:55], v[172:175], a[12:15], v[52:55]
    ds_read_b128 v[168:171], v184 offset:55296
    s_waitcnt lgkmcnt(4)
    v_mfma_f32_16x16x32_bf16 v[44:47], v[176:179], a[8:11], v[44:47]
    v_mfma_f32_16x16x32_bf16 v[56:59], v[176:179], a[12:15], v[56:59]
    ds_read_b128 v[172:175], v184 offset:15360
    s_waitcnt lgkmcnt(4)
    v_mfma_f32_16x16x32_bf16 v[48:51], v[180:183], a[8:11], v[48:51]
    v_mfma_f32_16x16x32_bf16 v[60:63], v[180:183], a[12:15], v[60:63]
    ds_read_b128 v[176:179], v184 offset:35840
    s_waitcnt lgkmcnt(4)
    v_mfma_f32_16x16x32_bf16 v[40:43], v[160:163], a[16:19], v[40:43]
    v_mfma_f32_16x16x32_bf16 v[52:55], v[160:163], a[20:23], v[52:55]
    ds_read_b128 v[180:183], v184 offset:56320
    s_waitcnt lgkmcnt(4)
    v_mfma_f32_16x16x32_bf16 v[44:47], v[164:167], a[16:19], v[44:47]
    v_mfma_f32_16x16x32_bf16 v[56:59], v[164:167], a[20:23], v[56:59]
    ds_read_b128 v[160:163], v184 offset:16384
    s_waitcnt lgkmcnt(4)
    v_mfma_f32_16x16x32_bf16 v[48:51], v[168:171], a[16:19], v[48:51]
    v_mfma_f32_16x16x32_bf16 v[60:63], v[168:171], a[20:23], v[60:63]
    ds_read_b128 v[164:167], v184 offset:36864
    s_waitcnt lgkmcnt(4)
    v_mfma_f32_16x16x32_bf16 v[40:43], v[172:175], a[24:27], v[40:43]
    v_mfma_f32_16x16x32_bf16 v[52:55], v[172:175], a[28:31], v[52:55]
    ds_read_b128 v[168:171], v184 offset:57344
    s_waitcnt lgkmcnt(4)
    v_mfma_f32_16x16x32_bf16 v[44:47], v[176:179], a[24:27], v[44:47]
    v_mfma_f32_16x16x32_bf16 v[56:59], v[176:179], a[28:31], v[56:59]
    ds_read_b128 v[172:175], v184 offset:17408
    s_waitcnt lgkmcnt(4)
    v_mfma_f32_16x16x32_bf16 v[48:51], v[180:183], a[24:27], v[48:51]
    v_mfma_f32_16x16x32_bf16 v[60:63], v[180:183], a[28:31], v[60:63]
    ds_read_b128 v[176:179], v184 offset:37888
    s_waitcnt lgkmcnt(4)
    v_mfma_f32_16x16x32_bf16 v[40:43], v[160:163], a[32:35], v[40:43]
    v_mfma_f32_16x16x32_bf16 v[52:55], v[160:163], a[36:39], v[52:55]
    ds_read_b128 v[180:183], v184 offset:58368
    s_waitcnt lgkmcnt(4)
    v_mfma_f32_16x16x32_bf16 v[44:47], v[164:167], a[32:35], v[44:47]
    v_mfma_f32_16x16x32_bf16 v[56:59], v[164:167], a[36:39], v[56:59]
    ds_read_b128 v[160:163], v184 offset:18432
    s_waitcnt lgkmcnt(4)
    v_mfma_f32_16x16x32_bf16 v[48:51], v[168:171], a[32:35], v[48:51]
    v_mfma_f32_16x16x32_bf16 v[60:63], v[168:171], a[36:39], v[60:63]
    ds_read_b128 v[164:167], v184 offset:38912
    s_waitcnt lgkmcnt(4)
    v_mfma_f32_16x16x32_bf16 v[40:43], v[172:175], a[40:43], v[40:43]
    v_mfma_f32_16x16x32_bf16 v[52:55], v[172:175], a[44:47], v[52:55]
    ds_read_b128 v[168:171], v184 offset:59392
    s_waitcnt lgkmcnt(4)
    v_mfma_f32_16x16x32_bf16 v[44:47], v[176:179], a[40:43], v[44:47]
    v_mfma_f32_16x16x32_bf16 v[56:59], v[176:179], a[44:47], v[56:59]
    ds_read_b128 v[172:175], v184 offset:19456
    s_waitcnt lgkmcnt(4)
    v_mfma_f32_16x16x32_bf16 v[48:51], v[180:183], a[40:43], v[48:51]
    v_mfma_f32_16x16x32_bf16 v[60:63], v[180:183], a[44:47], v[60:63]
    ds_read_b128 v[176:179], v184 offset:39936
    s_waitcnt lgkmcnt(4)
    v_mfma_f32_16x16x32_bf16 v[40:43], v[160:163], a[48:51], v[40:43]
    v_mfma_f32_16x16x32_bf16 v[52:55], v[160:163], a[52:55], v[52:55]
    ds_read_b128 v[180:183], v184 offset:60416
    s_waitcnt lgkmcnt(4)
    v_mfma_f32_16x16x32_bf16 v[44:47], v[164:167], a[48:51], v[44:47]
    v_mfma_f32_16x16x32_bf16 v[56:59], v[164:167], a[52:55], v[56:59]
    s_waitcnt lgkmcnt(3)
    v_mfma_f32_16x16x32_bf16 v[48:51], v[168:171], a[48:51], v[48:51]
    v_mfma_f32_16x16x32_bf16 v[60:63], v[168:171], a[52:55], v[60:63]
    s_waitcnt lgkmcnt(2)
    v_mfma_f32_16x16x32_bf16 v[40:43], v[172:175], a[56:59], v[40:43]
    v_mfma_f32_16x16x32_bf16 v[52:55], v[172:175], a[60:63], v[52:55]
    s_waitcnt lgkmcnt(1)
    v_mfma_f32_16x16x32_bf16 v[44:47], v[176:179], a[56:59], v[44:47]
    v_mfma_f32_16x16x32_bf16 v[56:59], v[176:179], a[60:63], v[56:59]
    s_waitcnt lgkmcnt(0)
    v_mfma_f32_16x16x32_bf16 v[48:51], v[180:183], a[56:59], v[48:51]
    v_mfma_f32_16x16x32_bf16 v[60:63], v[180:183], a[60:63], v[60:63]
    s_mov_b32 s72, 0x07060100
    s_waitcnt vmcnt(1)
    v_perm_b32 v10, v17, v26, s72
    v_perm_b32 v11, v16, v17, s72
    v_cndmask_b32 v36, v16, v10, s[94:95]
    v_cndmask_b32 v37, v17, v11, s[94:95]
    v_perm_b32 v10, v19, v28, s72
    v_perm_b32 v11, v18, v19, s72
    v_cndmask_b32 v38, v18, v10, s[94:95]
    v_cndmask_b32 v39, v19, v11, s[94:95]
    v_perm_b32 v10, v21, v30, s72
    v_perm_b32 v11, v20, v21, s72
    v_cndmask_b32 v104, v20, v10, s[94:95]
    v_cndmask_b32 v105, v21, v11, s[94:95]
    v_perm_b32 v10, v23, v32, s72
    v_perm_b32 v11, v22, v23, s72
    v_cndmask_b32 v106, v22, v10, s[94:95]
    v_cndmask_b32 v107, v23, v11, s[94:95]
    v_perm_b32 v10, v25, v34, s72
    v_perm_b32 v11, v24, v25, s72
    v_cndmask_b32 v108, v24, v10, s[94:95]
    v_cndmask_b32 v109, v25, v11, s[94:95]
    s_waitcnt vmcnt(0)
    v_mov_b32 v136, v191
    v_mov_b32 v137, v191
    v_mov_b32 v138, v191
    v_mov_b32 v139, v191
    v_mov_b32 v140, v191
    v_mov_b32 v141, v191
    v_mov_b32 v142, v191
    v_mov_b32 v143, v191
    v_mov_b32 v144, v191
    v_mov_b32 v145, v191
    v_mov_b32 v146, v191
    v_mov_b32 v147, v191
    v_mov_b32 v148, v191
    v_mov_b32 v149, v191
    v_mov_b32 v150, v191
    v_mov_b32 v151, v191
    v_mov_b32 v152, v191
    v_mov_b32 v153, v191
    v_mov_b32 v154, v191
    v_mov_b32 v155, v191
    v_mov_b32 v156, v191
    v_mov_b32 v157, v191
    v_mov_b32 v158, v191
    v_mov_b32 v159, v191
    s_barrier
    v_and_b32_e64 v12, 15, v1
    v_lshl_add_u32 v12, v12, 2, s86
    v_lshrrev_b32 v13, 4, v1
    v_lshlrev_b32 v13, 4, v13
    v_add_u32 v13, 160960, v13
    ds_read_b32 v28, v12 offset:0
    ds_read_b32 v29, v12 offset:128
    ds_read_b32 v30, v12 offset:64
    ds_read_b32 v31, v12 offset:192
    ds_read_b128 v[16:19], v13 offset:0
    ds_read_b128 v[20:23], v13 offset:64
    ds_read_b128 v[24:27], v13 offset:128
    s_mul_i32 s20, s59, 49152
    s_mul_i32 s73, s60, 1536
    s_add_u32 s20, s20, s73
    s_add_u32 s20, s20, 8388608
    s_add_u32 s21, s20, 24576
    s_lshl_b32 s22, s59, 4
    s_add_u32 s22, s22, s60
    ds_read_b128 a[0:3], v185 offset:0
    ds_read_b128 a[4:7], v186 offset:0
    ds_read_b128 a[8:11], v185 offset:2048
    ds_read_b128 a[12:15], v186 offset:2048
    ds_read_b128 a[16:19], v185 offset:4096
    ds_read_b128 a[20:23], v186 offset:4096
    ds_read_b128 a[24:27], v185 offset:6144
    ds_read_b128 a[28:31], v186 offset:6144
    ds_read_b128 a[32:35], v185 offset:8192
    ds_read_b128 a[36:39], v186 offset:8192
    ds_read_b128 a[40:43], v185 offset:10240
    ds_read_b128 a[44:47], v186 offset:10240
    ds_read_b128 a[48:51], v185 offset:12288
    ds_read_b128 a[52:55], v186 offset:12288
    ds_read_b128 a[56:59], v187 offset:0
    ds_read_b128 a[60:63], v188 offset:0
    ds_read_b128 v[160:163], v187 offset:2048
    ds_read_b128 v[164:167], v188 offset:2048
    ds_read_b128 v[168:171], v187 offset:4096
    ds_read_b128 v[172:175], v188 offset:4096
    ds_read_b128 v[176:179], v187 offset:6144
    ds_read_b128 v[180:183], v188 offset:6144
    ds_read_b128 v[184:187], v189 offset:0
    ds_read_b128 v[188:191], v190 offset:0
    s_waitcnt lgkmcnt(0)
    s_barrier
    buffer_load_dwordx4 v[64:67], v3, s[44:47], s80 offen sc1
    buffer_load_dwordx4 v[68:71], v3, s[44:47], s81 offen sc1
    buffer_load_dwordx4 v[72:75], v3, s[44:47], s82 offen sc1
    buffer_load_dwordx4 v[76:79], v3, s[44:47], s83 offen sc1
    buffer_load_dwordx4 v[80:83], v3, s[44:47], s84 offen sc1
    buffer_load_dwordx4 v[84:87], v3, s[44:47], s85 offen sc1
    s_waitcnt vmcnt(5)
    v_mfma_f32_16x16x32_bf16 v[136:139], v[64:67], a[0:3], v[136:139]
    v_add_u32 v3, 65536, v3
    buffer_load_dwordx4 v[88:91], v3, s[44:47], s80 offen sc1
    buffer_load_dwordx4 v[92:95], v3, s[44:47], s81 offen sc1
    buffer_load_dwordx4 v[96:99], v3, s[44:47], s82 offen sc1
    v_fmac_f32 v40, v16, v28
    v_fmac_f32 v41, v17, v28
    v_fmac_f32 v42, v18, v28
    v_fmac_f32 v43, v19, v28
    v_mfma_f32_16x16x32_bf16 v[112:115], v[64:67], a[24:27], 0
    v_mul_f32 v40, v40, v29
    v_mul_f32 v41, v41, v29
    v_mul_f32 v42, v42, v29
    v_mul_f32 v43, v43, v29
    v_mfma_f32_16x16x32_bf16 v[116:119], v[64:67], a[48:51], 0
    v_mul_f32 v32, v40, v40
    v_mul_f32 v33, v41, v41
    v_mul_f32 v34, v42, v42
    v_mul_f32 v35, v43, v43
    v_mfma_f32_16x16x32_bf16 v[120:123], v[64:67], v[168:171], 0
    v_fmamk_f32 v32, v32, 0xbdd2d3e7, v14
    v_fmamk_f32 v33, v33, 0xbdd2d3e7, v14
    v_fmamk_f32 v34, v34, 0xbdd2d3e7, v14
    v_fmamk_f32 v35, v35, 0xbdd2d3e7, v14
    s_waitcnt vmcnt(7)
    v_mfma_f32_16x16x32_bf16 v[136:139], v[68:71], a[4:7], v[136:139]
    buffer_load_dwordx4 v[100:103], v3, s[44:47], s83 offen sc1
    buffer_load_dwordx4 v[64:67], v3, s[44:47], s84 offen sc1
    v_mul_f32 v32, v32, v40
    v_mul_f32 v33, v33, v41
    v_mul_f32 v34, v34, v42
    v_mul_f32_e64 v35, v35, v43
    v_mfma_f32_16x16x32_bf16 v[112:115], v[68:71], a[28:31], v[112:115]
    v_exp_f32 v32, v32
    v_exp_f32 v33, v33
    v_exp_f32 v34, v34
    v_exp_f32 v35, v35
    v_mfma_f32_16x16x32_bf16 v[116:119], v[68:71], a[52:55], v[116:119]
    v_add_f32 v32, 1.0, v32
    v_add_f32 v33, 1.0, v33
    v_add_f32 v34, 1.0, v34
    v_add_f32 v35, 1.0, v35
    v_mfma_f32_16x16x32_bf16 v[120:123], v[68:71], v[172:175], v[120:123]
    v_rcp_f32 v32, v32
    v_rcp_f32 v33, v33
    v_rcp_f32 v34, v34
    v_rcp_f32_e64 v35, v35
    s_waitcnt vmcnt(8)
    v_mfma_f32_16x16x32_bf16 v[136:139], v[72:75], a[8:11], v[136:139]
    buffer_load_dwordx4 v[68:71], v3, s[44:47], s85 offen sc1
    v_mul_f32 v40, v40, v32
    v_mul_f32 v41, v41, v33
    v_mul_f32 v42, v42, v34
    v_mul_f32 v43, v43, v35
    v_mfma_f32_16x16x32_bf16 v[112:115], v[72:75], a[32:35], v[112:115]
    v_cvt_pk_bf16_f32 v40, v40, v41
    v_cvt_pk_bf16_f32 v41, v42, v43
    v_fmac_f32 v44, v20, v28
    v_fmac_f32 v45, v21, v28
    v_mfma_f32_16x16x32_bf16 v[116:119], v[72:75], a[56:59], v[116:119]
    v_fmac_f32 v46, v22, v28
    v_fmac_f32 v47, v23, v28
    v_mul_f32 v44, v44, v29
    v_mul_f32 v45, v45, v29
    v_mfma_f32_16x16x32_bf16 v[120:123], v[72:75], v[176:179], v[120:123]
    v_mul_f32 v46, v46, v29
    v_mul_f32 v47, v47, v29
    v_mul_f32 v32, v44, v44
    v_mul_f32_e64 v33, v45, v45
    s_waitcnt vmcnt(8)
    v_mfma_f32_16x16x32_bf16 v[136:139], v[76:79], a[12:15], v[136:139]
    v_add_u32 v3, 65536, v3
    buffer_load_dwordx4 v[72:75], v3, s[44:47], s80 offen sc1
    v_mul_f32 v34, v46, v46
    v_mul_f32 v35, v47, v47
    v_fmamk_f32 v32, v32, 0xbdd2d3e7, v14
    v_fmamk_f32 v33, v33, 0xbdd2d3e7, v14
    v_mfma_f32_16x16x32_bf16 v[112:115], v[76:79], a[36:39], v[112:115]
    v_fmamk_f32 v34, v34, 0xbdd2d3e7, v14
    v_fmamk_f32 v35, v35, 0xbdd2d3e7, v14
    v_mul_f32 v32, v32, v44
    v_mul_f32 v33, v33, v45
    v_mfma_f32_16x16x32_bf16 v[116:119], v[76:79], a[60:63], v[116:119]
    v_mul_f32 v34, v34, v46
    v_mul_f32 v35, v35, v47
    v_exp_f32 v32, v32
    v_exp_f32 v33, v33
    v_mfma_f32_16x16x32_bf16 v[120:123], v[76:79], v[180:183], v[120:123]
    v_exp_f32 v34, v34
    v_exp_f32 v35, v35
    v_add_f32 v32, 1.0, v32
    v_add_f32_e64 v33, 1.0, v33
    s_waitcnt vmcnt(8)
    v_mfma_f32_16x16x32_bf16 v[136:139], v[80:83], a[16:19], v[136:139]
    buffer_load_dwordx4 v[76:79], v3, s[44:47], s81 offen sc1
    v_add_f32 v34, 1.0, v34
    v_add_f32 v35, 1.0, v35
    v_rcp_f32 v32, v32
    v_rcp_f32 v33, v33
    v_mfma_f32_16x16x32_bf16 v[112:115], v[80:83], a[40:43], v[112:115]
    v_rcp_f32 v34, v34
    v_rcp_f32 v35, v35
    v_mul_f32 v44, v44, v32
    v_mul_f32 v45, v45, v33
    v_mfma_f32_16x16x32_bf16 v[116:119], v[80:83], v[160:163], v[116:119]
    v_mul_f32 v46, v46, v34
    v_mul_f32 v47, v47, v35
    v_cvt_pk_bf16_f32 v44, v44, v45
    v_cvt_pk_bf16_f32 v45, v46, v47
    v_mfma_f32_16x16x32_bf16 v[120:123], v[80:83], v[184:187], v[120:123]
    v_fmac_f32 v48, v24, v28
    v_fmac_f32 v49, v25, v28
    v_fmac_f32 v50, v26, v28
    v_fmac_f32_e64 v51, v27, v28
    s_waitcnt vmcnt(8)
    v_mfma_f32_16x16x32_bf16 v[136:139], v[84:87], a[20:23], v[136:139]
    buffer_load_dwordx4 v[80:83], v3, s[44:47], s82 offen sc1
    v_mul_f32 v48, v48, v29
    v_mul_f32 v49, v49, v29
    v_mul_f32 v50, v50, v29
    v_mul_f32 v51, v51, v29
    v_mfma_f32_16x16x32_bf16 v[112:115], v[84:87], a[44:47], v[112:115]
    v_mul_f32 v32, v48, v48
    v_mul_f32 v33, v49, v49
    v_mul_f32 v34, v50, v50
    v_mul_f32 v35, v51, v51
    v_mfma_f32_16x16x32_bf16 v[116:119], v[84:87], v[164:167], v[116:119]
    v_fmamk_f32 v32, v32, 0xbdd2d3e7, v14
    v_fmamk_f32 v33, v33, 0xbdd2d3e7, v14
    v_fmamk_f32 v34, v34, 0xbdd2d3e7, v14
    v_fmamk_f32 v35, v35, 0xbdd2d3e7, v14
    v_mfma_f32_16x16x32_bf16 v[120:123], v[84:87], v[188:191], v[120:123]
    v_mul_f32 v32, v32, v48
    v_mul_f32 v33, v33, v49
    v_mul_f32 v34, v34, v50
    v_mul_f32_e64 v35, v35, v51
    s_waitcnt vmcnt(8)
    v_mfma_f32_16x16x32_bf16 v[140:143], v[88:91], a[0:3], v[140:143]
    buffer_load_dwordx4 v[84:87], v3, s[44:47], s83 offen sc1
    v_exp_f32 v32, v32
    v_exp_f32 v33, v33
    v_exp_f32 v34, v34
    v_exp_f32 v35, v35
    v_mfma_f32_16x16x32_bf16 v[124:127], v[88:91], a[24:27], 0
    v_add_f32 v32, 1.0, v32
    v_add_f32 v33, 1.0, v33
    v_add_f32 v34, 1.0, v34
    v_add_f32 v35, 1.0, v35
    v_mfma_f32_16x16x32_bf16 v[128:131], v[88:91], a[48:51], 0
    v_rcp_f32 v32, v32
    v_rcp_f32 v33, v33
    v_rcp_f32 v34, v34
    v_rcp_f32 v35, v35
    v_mfma_f32_16x16x32_bf16 v[132:135], v[88:91], v[168:171], 0
    v_mul_f32 v48, v48, v32
    v_mul_f32 v49, v49, v33
    v_mul_f32 v50, v50, v34
    v_mul_f32_e64 v51, v51, v35
    s_waitcnt vmcnt(8)
    v_mfma_f32_16x16x32_bf16 v[140:143], v[92:95], a[4:7], v[140:143]
    buffer_load_dwordx4 v[88:91], v3, s[44:47], s84 offen sc1
    v_cvt_pk_bf16_f32 v48, v48, v49
    v_cvt_pk_bf16_f32 v49, v50, v51
    v_fmac_f32 v52, v16, v30
    v_fmac_f32 v53, v17, v30
    v_mfma_f32_16x16x32_bf16 v[124:127], v[92:95], a[28:31], v[124:127]
    v_fmac_f32 v54, v18, v30
    v_fmac_f32 v55, v19, v30
    v_mul_f32 v52, v52, v31
    v_mul_f32 v53, v53, v31
    v_mfma_f32_16x16x32_bf16 v[128:131], v[92:95], a[52:55], v[128:131]
    v_mul_f32 v54, v54, v31
    v_mul_f32 v55, v55, v31
    v_mul_f32 v32, v52, v52
    v_mul_f32 v33, v53, v53
    v_mfma_f32_16x16x32_bf16 v[132:135], v[92:95], v[172:175], v[132:135]
    v_mul_f32 v34, v54, v54
    v_mul_f32 v35, v55, v55
    v_fmamk_f32 v32, v32, 0xbdd2d3e7, v14
    v_fmamk_f32 v33, v33, 0xbdd2d3e7, v14
    ds_write_b128 v5, v[112:115]
    ds_write_b128 v6, v[116:119]
    ds_write_b128 v7, v[120:123]
    s_waitcnt vmcnt(8)
    v_mfma_f32_16x16x32_bf16 v[140:143], v[96:99], a[8:11], v[140:143]
    buffer_load_dwordx4 v[92:95], v3, s[44:47], s85 offen sc1
    v_fmamk_f32 v34, v34, 0xbdd2d3e7, v14
    v_fmamk_f32 v35, v35, 0xbdd2d3e7, v14
    v_mul_f32 v32, v32, v52
    v_mul_f32_e64 v33, v33, v53
    v_mfma_f32_16x16x32_bf16 v[124:127], v[96:99], a[32:35], v[124:127]
    v_mul_f32 v34, v34, v54
    v_mul_f32 v35, v35, v55
    v_exp_f32 v32, v32
    v_exp_f32 v33, v33
    v_mfma_f32_16x16x32_bf16 v[128:131], v[96:99], a[56:59], v[128:131]
    v_exp_f32 v34, v34
    v_exp_f32 v35, v35
    v_add_f32 v32, 1.0, v32
    v_add_f32 v33, 1.0, v33
    v_mfma_f32_16x16x32_bf16 v[132:135], v[96:99], v[176:179], v[132:135]
    v_add_f32 v34, 1.0, v34
    v_add_f32 v35, 1.0, v35
    v_rcp_f32 v32, v32
    v_rcp_f32_e64 v33, v33
    s_waitcnt vmcnt(8)
    v_mfma_f32_16x16x32_bf16 v[140:143], v[100:103], a[12:15], v[140:143]
    v_add_u32 v3, 65536, v3
    buffer_load_dwordx4 v[96:99], v3, s[44:47], s80 offen sc1
    v_rcp_f32 v34, v34
    v_rcp_f32 v35, v35
    v_mul_f32 v52, v52, v32
    v_mul_f32 v53, v53, v33
    v_mfma_f32_16x16x32_bf16 v[124:127], v[100:103], a[36:39], v[124:127]
    v_mul_f32 v54, v54, v34
    v_mul_f32 v55, v55, v35
    v_cvt_pk_bf16_f32 v52, v52, v53
    v_cvt_pk_bf16_f32 v53, v54, v55
    v_mfma_f32_16x16x32_bf16 v[128:131], v[100:103], a[60:63], v[128:131]
    v_fmac_f32 v56, v20, v30
    v_fmac_f32 v57, v21, v30
    v_fmac_f32 v58, v22, v30
    v_fmac_f32 v59, v23, v30
    v_mfma_f32_16x16x32_bf16 v[132:135], v[100:103], v[180:183], v[132:135]
    v_mul_f32 v56, v56, v31
    v_mul_f32 v57, v57, v31
    v_mul_f32 v58, v58, v31
    v_mul_f32_e64 v59, v59, v31
    s_waitcnt vmcnt(8)
    v_mfma_f32_16x16x32_bf16 v[140:143], v[64:67], a[16:19], v[140:143]
    buffer_load_dwordx4 v[100:103], v3, s[44:47], s81 offen sc1
    v_mul_f32 v32, v56, v56
    v_mul_f32 v33, v57, v57
    v_mul_f32 v34, v58, v58
    v_mul_f32 v35, v59, v59
    v_mfma_f32_16x16x32_bf16 v[124:127], v[64:67], a[40:43], v[124:127]
    v_fmamk_f32 v32, v32, 0xbdd2d3e7, v14
    v_fmamk_f32 v33, v33, 0xbdd2d3e7, v14
    v_fmamk_f32 v34, v34, 0xbdd2d3e7, v14
    v_fmamk_f32 v35, v35, 0xbdd2d3e7, v14
    v_mfma_f32_16x16x32_bf16 v[128:131], v[64:67], v[160:163], v[128:131]
    v_mul_f32 v32, v32, v56
    v_mul_f32 v33, v33, v57
    v_mul_f32 v34, v34, v58
    v_mul_f32 v35, v35, v59
    v_mfma_f32_16x16x32_bf16 v[132:135], v[64:67], v[184:187], v[132:135]
    v_exp_f32 v32, v32
    v_exp_f32 v33, v33
    v_exp_f32 v34, v34
    v_exp_f32_e64 v35, v35
    s_waitcnt vmcnt(8)
    v_mfma_f32_16x16x32_bf16 v[140:143], v[68:71], a[20:23], v[140:143]
    buffer_load_dwordx4 v[64:67], v3, s[44:47], s82 offen sc1
    v_add_f32 v32, 1.0, v32
    v_add_f32 v33, 1.0, v33
    v_add_f32 v34, 1.0, v34
    v_add_f32 v35, 1.0, v35
    v_mfma_f32_16x16x32_bf16 v[124:127], v[68:71], a[44:47], v[124:127]
    v_rcp_f32 v32, v32
    v_rcp_f32 v33, v33
    v_rcp_f32 v34, v34
    v_rcp_f32 v35, v35
    v_mfma_f32_16x16x32_bf16 v[128:131], v[68:71], v[164:167], v[128:131]
    v_mul_f32 v56, v56, v32
    v_mul_f32 v57, v57, v33
    v_mul_f32 v58, v58, v34
    v_mul_f32 v59, v59, v35
    v_mfma_f32_16x16x32_bf16 v[132:135], v[68:71], v[188:191], v[132:135]
    v_cvt_pk_bf16_f32 v56, v56, v57
    v_cvt_pk_bf16_f32 v57, v58, v59
    v_fmac_f32 v60, v24, v30
    v_fmac_f32_e64 v61, v25, v30
    s_waitcnt vmcnt(8)
    v_mfma_f32_16x16x32_bf16 v[144:147], v[72:75], a[0:3], v[144:147]
    buffer_load_dwordx4 v[68:71], v3, s[44:47], s83 offen sc1
    v_fmac_f32 v62, v26, v30
    v_fmac_f32 v63, v27, v30
    v_mul_f32 v60, v60, v31
    v_mul_f32 v61, v61, v31
    v_mfma_f32_16x16x32_bf16 v[112:115], v[72:75], a[24:27], 0
    v_mul_f32 v62, v62, v31
    v_mul_f32 v63, v63, v31
    v_mul_f32 v32, v60, v60
    v_mul_f32 v33, v61, v61
    v_mfma_f32_16x16x32_bf16 v[116:119], v[72:75], a[48:51], 0
    v_mul_f32 v34, v62, v62
    v_mul_f32 v35, v63, v63
    v_fmamk_f32 v32, v32, 0xbdd2d3e7, v14
    v_fmamk_f32 v33, v33, 0xbdd2d3e7, v14
    v_mfma_f32_16x16x32_bf16 v[120:123], v[72:75], v[168:171], 0
    v_fmamk_f32 v34, v34, 0xbdd2d3e7, v14
    v_fmamk_f32 v35, v35, 0xbdd2d3e7, v14
    v_mul_f32 v32, v32, v60
    v_mul_f32_e64 v33, v33, v61
    s_waitcnt vmcnt(8)
    v_mfma_f32_16x16x32_bf16 v[144:147], v[76:79], a[4:7], v[144:147]
    buffer_load_dwordx4 v[72:75], v3, s[44:47], s84 offen sc1
    v_mul_f32 v34, v34, v62
    v_mul_f32 v35, v35, v63
    v_exp_f32 v32, v32
    v_exp_f32 v33, v33
    v_mfma_f32_16x16x32_bf16 v[112:115], v[76:79], a[28:31], v[112:115]
    v_exp_f32 v34, v34
    v_exp_f32 v35, v35
    v_add_f32 v32, 1.0, v32
    v_add_f32 v33, 1.0, v33
    v_mfma_f32_16x16x32_bf16 v[116:119], v[76:79], a[52:55], v[116:119]
    v_add_f32 v34, 1.0, v34
    v_add_f32 v35, 1.0, v35
    v_rcp_f32 v32, v32
    v_rcp_f32 v33, v33
    v_mfma_f32_16x16x32_bf16 v[120:123], v[76:79], v[172:175], v[120:123]
    v_rcp_f32 v34, v34
    v_rcp_f32 v35, v35
    v_mul_f32 v60, v60, v32
    v_mul_f32 v61, v61, v33
    v_add_u32 v5, 28672, v5
    v_add_u32 v6, 28672, v6
    v_add_u32 v7, 28672, v7
    ds_write_b128 v5, v[124:127]
    ds_write_b128 v6, v[128:131]
    ds_write_b128 v7, v[132:135]
    s_waitcnt vmcnt(8)
    v_mfma_f32_16x16x32_bf16 v[144:147], v[80:83], a[8:11], v[144:147]
    buffer_load_dwordx4 v[76:79], v3, s[44:47], s85 offen sc1
    v_mul_f32 v62, v62, v34
    v_mul_f32_e64 v63, v63, v35
    v_cvt_pk_bf16_f32 v60, v60, v61
    v_cvt_pk_bf16_f32 v61, v62, v63
    v_mfma_f32_16x16x32_bf16 v[112:115], v[80:83], a[32:35], v[112:115]
    buffer_store_dwordx2 v[40:41], v8, s[44:47], s20 offen offset:0
    buffer_store_dwordx2 v[44:45], v8, s[44:47], s20 offen offset:512
    buffer_store_dwordx2 v[48:49], v8, s[44:47], s20 offen offset:1024
    buffer_store_dwordx2 v[52:53], v8, s[44:47], s21 offen offset:0
    buffer_store_dwordx2 v[56:57], v8, s[44:47], s21 offen offset:512
    buffer_store_dwordx2 v[60:61], v8, s[44:47], s21 offen offset:1024
    v_mfma_f32_16x16x32_bf16 v[116:119], v[80:83], a[56:59], v[116:119]
    v_mfma_f32_16x16x32_bf16 v[120:123], v[80:83], v[176:179], v[120:123]
    s_waitcnt vmcnt(14)
    v_mfma_f32_16x16x32_bf16 v[144:147], v[84:87], a[12:15], v[144:147]
    v_add_u32 v3, 65536, v3
    buffer_load_dwordx4 v[80:83], v3, s[44:47], s80 offen sc1
    v_mfma_f32_16x16x32_bf16 v[112:115], v[84:87], a[36:39], v[112:115]
    v_mfma_f32_16x16x32_bf16 v[116:119], v[84:87], a[60:63], v[116:119]
    v_mfma_f32_16x16x32_bf16 v[120:123], v[84:87], v[180:183], v[120:123]
    s_waitcnt vmcnt(14)
    v_mfma_f32_16x16x32_bf16 v[144:147], v[88:91], a[16:19], v[144:147]
    buffer_load_dwordx4 v[84:87], v3, s[44:47], s81 offen sc1
    v_mfma_f32_16x16x32_bf16 v[112:115], v[88:91], a[40:43], v[112:115]
    v_mfma_f32_16x16x32_bf16 v[116:119], v[88:91], v[160:163], v[116:119]
    v_mfma_f32_16x16x32_bf16 v[120:123], v[88:91], v[184:187], v[120:123]
    s_waitcnt lgkmcnt(0)
    s_barrier
    s_waitcnt vmcnt(14)
    v_mfma_f32_16x16x32_bf16 v[144:147], v[92:95], a[20:23], v[144:147]
    buffer_load_dwordx4 v[88:91], v3, s[44:47], s82 offen sc1
    ds_read_b128 v[16:19], v4 offset:0
    ds_read_b128 v[20:23], v4 offset:1024
    ds_read_b128 v[24:27], v4 offset:2048
    ds_read_b128 v[28:31], v4 offset:3072
    ds_read_b128 v[32:35], v4 offset:4096
    ds_read_b128 v[40:43], v4 offset:5120
    ds_read_b128 v[44:47], v4 offset:6144
    v_mfma_f32_16x16x32_bf16 v[112:115], v[92:95], a[44:47], v[112:115]
    v_mfma_f32_16x16x32_bf16 v[116:119], v[92:95], v[164:167], v[116:119]
    s_waitcnt lgkmcnt(6)
    v_add_f32_e64 v136, v136, v16
    v_mfma_f32_16x16x32_bf16 v[120:123], v[92:95], v[188:191], v[120:123]
    v_add_f32 v137, v137, v17
    v_add_f32 v138, v138, v18
    v_add_f32 v139, v139, v19
    s_waitcnt lgkmcnt(5)
    v_add_f32 v136, v136, v20
    s_waitcnt vmcnt(14)
    v_mfma_f32_16x16x32_bf16 v[148:151], v[96:99], a[0:3], v[148:151]
    buffer_load_dwordx4 v[92:95], v3, s[44:47], s83 offen sc1
    v_add_f32 v137, v137, v21
    v_add_f32 v138, v138, v22
    v_add_f32 v139, v139, v23
    s_waitcnt lgkmcnt(4)
    v_add_f32_e64 v136, v136, v24
    v_mfma_f32_16x16x32_bf16 v[124:127], v[96:99], a[24:27], 0
    v_add_f32 v137, v137, v25
    v_add_f32 v138, v138, v26
    v_add_f32 v139, v139, v27
    s_waitcnt lgkmcnt(3)
    v_add_f32_e64 v136, v136, v28
    v_mfma_f32_16x16x32_bf16 v[128:131], v[96:99], a[48:51], 0
    v_add_f32 v137, v137, v29
    v_add_f32 v138, v138, v30
    v_add_f32 v139, v139, v31
    s_waitcnt lgkmcnt(2)
    v_add_f32_e64 v136, v136, v32
    v_mfma_f32_16x16x32_bf16 v[132:135], v[96:99], v[168:171], 0
    v_add_f32 v137, v137, v33
    v_add_f32 v138, v138, v34
    v_add_f32 v139, v139, v35
    s_waitcnt lgkmcnt(1)
    v_add_f32 v136, v136, v40
    s_waitcnt vmcnt(14)
    v_mfma_f32_16x16x32_bf16 v[148:151], v[100:103], a[4:7], v[148:151]
    buffer_load_dwordx4 v[96:99], v3, s[44:47], s84 offen sc1
    v_add_f32 v137, v137, v41
    v_add_f32 v138, v138, v42
    v_add_f32 v139, v139, v43
    s_waitcnt lgkmcnt(0)
    v_add_f32_e64 v136, v136, v44
    v_mfma_f32_16x16x32_bf16 v[124:127], v[100:103], a[28:31], v[124:127]
    v_add_f32 v137, v137, v45
    v_add_f32 v138, v138, v46
    v_add_f32_e64 v139, v139, v47
    v_add_u32 v4, 28672, v4
    v_mfma_f32_16x16x32_bf16 v[128:131], v[100:103], a[52:55], v[128:131]
    ds_read_b128 v[16:19], v4 offset:0
    ds_read_b128 v[20:23], v4 offset:1024
    ds_read_b128 v[24:27], v4 offset:2048
    ds_read_b128 v[28:31], v4 offset:3072
    ds_read_b128 v[32:35], v4 offset:4096
    ds_read_b128 v[40:43], v4 offset:5120
    ds_read_b128 v[44:47], v4 offset:6144
    v_mfma_f32_16x16x32_bf16 v[132:135], v[100:103], v[172:175], v[132:135]
    v_add_u32 v5, 28672, v5
    v_add_u32 v6, 28672, v6
    v_add_u32 v7, 28672, v7
    ds_write_b128 v5, v[112:115]
    ds_write_b128 v6, v[116:119]
    ds_write_b128 v7, v[120:123]
    s_waitcnt vmcnt(14)
    v_mfma_f32_16x16x32_bf16 v[148:151], v[64:67], a[8:11], v[148:151]
    buffer_load_dwordx4 v[100:103], v3, s[44:47], s85 offen sc1
    s_waitcnt lgkmcnt(9)
    v_add_f32_e64 v140, v140, v16
    v_mfma_f32_16x16x32_bf16 v[124:127], v[64:67], a[32:35], v[124:127]
    v_add_f32 v141, v141, v17
    v_add_f32 v142, v142, v18
    v_add_f32 v143, v143, v19
    s_waitcnt lgkmcnt(8)
    v_add_f32_e64 v140, v140, v20
    v_mfma_f32_16x16x32_bf16 v[128:131], v[64:67], a[56:59], v[128:131]
    v_add_f32 v141, v141, v21
    v_add_f32 v142, v142, v22
    v_add_f32 v143, v143, v23
    s_waitcnt lgkmcnt(7)
    v_add_f32_e64 v140, v140, v24
    v_mfma_f32_16x16x32_bf16 v[132:135], v[64:67], v[176:179], v[132:135]
    v_add_f32 v141, v141, v25
    v_add_f32 v142, v142, v26
    v_add_f32 v143, v143, v27
    s_waitcnt lgkmcnt(6)
    v_add_f32 v140, v140, v28
    s_waitcnt vmcnt(14)
    v_mfma_f32_16x16x32_bf16 v[148:151], v[68:71], a[12:15], v[148:151]
    v_add_u32 v3, 65536, v3
    buffer_load_dwordx4 v[64:67], v3, s[44:47], s80 offen sc1
    v_add_f32 v141, v141, v29
    v_add_f32 v142, v142, v30
    v_add_f32 v143, v143, v31
    s_waitcnt lgkmcnt(5)
    v_add_f32_e64 v140, v140, v32
    v_mfma_f32_16x16x32_bf16 v[124:127], v[68:71], a[36:39], v[124:127]
    v_add_f32 v141, v141, v33
    v_add_f32 v142, v142, v34
    v_add_f32 v143, v143, v35
    s_waitcnt lgkmcnt(4)
    v_add_f32_e64 v140, v140, v40
    v_mfma_f32_16x16x32_bf16 v[128:131], v[68:71], a[60:63], v[128:131]
    v_add_f32 v141, v141, v41
    v_add_f32 v142, v142, v42
    v_add_f32 v143, v143, v43
    s_waitcnt lgkmcnt(3)
    v_add_f32_e64 v140, v140, v44
    v_mfma_f32_16x16x32_bf16 v[132:135], v[68:71], v[180:183], v[132:135]
    v_add_f32 v141, v141, v45
    v_add_f32 v142, v142, v46
    v_add_f32 v143, v143, v47
    s_waitcnt vmcnt(7)
    s_mov_b32 s99, s22
    s_lshl_b32 s72, s99, 2
    s_add_u32 s72, s72, 24576
    v_mov_b32 v10, s96
    v_mov_b32_e64 v11, 0
    s_mov_b64 exec, 1
    s_cmp_eq_u32 s97, 0
    s_cbranch_scc1 fs_slow_20
    buffer_store_dword v10, v11, s[44:47], s72 offen
    s_branch fs_done_21
fs_slow_20:
    buffer_wbl2 sc1
    s_waitcnt vmcnt(0)
    buffer_store_dword v10, v11, s[44:47], s72 offen sc1
fs_done_21:
    s_mov_b64 exec, -1
    v_mfma_f32_16x16x32_bf16 v[148:151], v[72:75], a[16:19], v[148:151]
    buffer_load_dwordx4 v[68:71], v3, s[44:47], s81 offen sc1
    v_mfma_f32_16x16x32_bf16 v[124:127], v[72:75], a[40:43], v[124:127]
    v_mfma_f32_16x16x32_bf16 v[128:131], v[72:75], v[160:163], v[128:131]
    v_mfma_f32_16x16x32_bf16 v[132:135], v[72:75], v[184:187], v[132:135]
    v_mfma_f32_16x16x32_bf16 v[148:151], v[76:79], a[20:23], v[148:151]
    buffer_load_dwordx4 v[72:75], v3, s[44:47], s82 offen sc1
    v_mfma_f32_16x16x32_bf16 v[124:127], v[76:79], a[44:47], v[124:127]
    v_mfma_f32_16x16x32_bf16 v[128:131], v[76:79], v[164:167], v[128:131]
    v_mfma_f32_16x16x32_bf16 v[132:135], v[76:79], v[188:191], v[132:135]
    s_waitcnt vmcnt(8)
    v_mfma_f32_16x16x32_bf16 v[152:155], v[80:83], a[0:3], v[152:155]
    buffer_load_dwordx4 v[76:79], v3, s[44:47], s83 offen sc1
    v_mfma_f32_16x16x32_bf16 v[112:115], v[80:83], a[24:27], 0
    v_mfma_f32_16x16x32_bf16 v[116:119], v[80:83], a[48:51], 0
    v_mfma_f32_16x16x32_bf16 v[120:123], v[80:83], v[168:171], 0
    s_waitcnt vmcnt(8)
    v_mfma_f32_16x16x32_bf16 v[152:155], v[84:87], a[4:7], v[152:155]
    buffer_load_dwordx4 v[80:83], v3, s[44:47], s84 offen sc1
    v_mfma_f32_16x16x32_bf16 v[112:115], v[84:87], a[28:31], v[112:115]
    v_mfma_f32_16x16x32_bf16 v[116:119], v[84:87], a[52:55], v[116:119]
    v_mfma_f32_16x16x32_bf16 v[120:123], v[84:87], v[172:175], v[120:123]
    v_add_u32 v5, 28672, v5
    v_add_u32 v6, 28672, v6
    v_add_u32 v7, 28672, v7
    ds_write_b128 v5, v[124:127]
    ds_write_b128 v6, v[128:131]
    ds_write_b128 v7, v[132:135]
    s_waitcnt vmcnt(8)
    v_mfma_f32_16x16x32_bf16 v[152:155], v[88:91], a[8:11], v[152:155]
    buffer_load_dwordx4 v[84:87], v3, s[44:47], s85 offen sc1
    v_mfma_f32_16x16x32_bf16 v[112:115], v[88:91], a[32:35], v[112:115]
    v_mfma_f32_16x16x32_bf16 v[116:119], v[88:91], a[56:59], v[116:119]
    v_mfma_f32_16x16x32_bf16 v[120:123], v[88:91], v[176:179], v[120:123]
    buffer_load_dword v15, v9, s[44:47], 0 offen sc1
    s_waitcnt vmcnt(9)
    v_mfma_f32_16x16x32_bf16 v[152:155], v[92:95], a[12:15], v[152:155]
    v_mfma_f32_16x16x32_bf16 v[112:115], v[92:95], a[36:39], v[112:115]
    v_mfma_f32_16x16x32_bf16 v[116:119], v[92:95], a[60:63], v[116:119]
    v_mfma_f32_16x16x32_bf16 v[120:123], v[92:95], v[180:183], v[120:123]
    s_waitcnt vmcnt(8)
    v_mfma_f32_16x16x32_bf16 v[152:155], v[96:99], a[16:19], v[152:155]
    v_mfma_f32_16x16x32_bf16 v[112:115], v[96:99], a[40:43], v[112:115]
    v_mfma_f32_16x16x32_bf16 v[116:119], v[96:99], v[160:163], v[116:119]
    v_mfma_f32_16x16x32_bf16 v[120:123], v[96:99], v[184:187], v[120:123]
    s_waitcnt lgkmcnt(0)
    s_barrier
    s_waitcnt vmcnt(7)
    v_mfma_f32_16x16x32_bf16 v[152:155], v[100:103], a[20:23], v[152:155]
    v_add_u32 v4, 28672, v4
    ds_read_b128 v[16:19], v4 offset:0
    ds_read_b128 v[20:23], v4 offset:1024
    ds_read_b128 v[24:27], v4 offset:2048
    ds_read_b128 v[28:31], v4 offset:3072
    ds_read_b128 v[32:35], v4 offset:4096
    ds_read_b128 v[40:43], v4 offset:5120
    ds_read_b128 v[44:47], v4 offset:6144
    v_mfma_f32_16x16x32_bf16 v[112:115], v[100:103], a[44:47], v[112:115]
    v_mfma_f32_16x16x32_bf16 v[116:119], v[100:103], v[164:167], v[116:119]
    v_mfma_f32_16x16x32_bf16 v[120:123], v[100:103], v[188:191], v[120:123]
    s_waitcnt lgkmcnt(6)
    v_add_f32 v144, v144, v16
    v_add_f32 v145, v145, v17
    v_add_f32 v146, v146, v18
    v_add_f32_e64 v147, v147, v19
    s_waitcnt vmcnt(6)
    v_mfma_f32_16x16x32_bf16 v[156:159], v[64:67], a[0:3], v[156:159]
    s_waitcnt lgkmcnt(5)
    v_add_f32 v144, v144, v20
    v_add_f32 v145, v145, v21
    v_add_f32 v146, v146, v22
    v_add_f32_e64 v147, v147, v23
    v_mfma_f32_16x16x32_bf16 v[124:127], v[64:67], a[24:27], 0
    s_waitcnt lgkmcnt(4)
    v_add_f32 v144, v144, v24
    v_add_f32 v145, v145, v25
    v_add_f32 v146, v146, v26
    v_add_f32_e64 v147, v147, v27
    v_mfma_f32_16x16x32_bf16 v[128:131], v[64:67], a[48:51], 0
    s_waitcnt lgkmcnt(3)
    v_add_f32 v144, v144, v28
    v_add_f32 v145, v145, v29
    v_add_f32 v146, v146, v30
    v_add_f32_e64 v147, v147, v31
    v_mfma_f32_16x16x32_bf16 v[132:135], v[64:67], v[168:171], 0
    s_waitcnt lgkmcnt(2)
    v_add_f32 v144, v144, v32
    v_add_f32 v145, v145, v33
    v_add_f32 v146, v146, v34
    v_add_f32 v147, v147, v35
    s_waitcnt vmcnt(0)
    s_mov_b32 s98, 0x100000
f3b_22:
    v_cmp_ne_u32 vcc, s96, v15
    s_cbranch_vccz f3bok_23
    buffer_load_dword v15, v9, s[44:47], 0 offen sc1
    s_waitcnt vmcnt(0)
    s_sub_u32 s98, s98, 1
    s_cbranch_scc0 f3b_22
f3bok_23:
    buffer_load_dwordx2 v[52:53], v8, s[44:47], s70 offen offset:0 sc1
    buffer_load_dwordx2 v[54:55], v8, s[44:47], s70 offen offset:512 sc1
    buffer_load_dwordx2 v[56:57], v8, s[44:47], s70 offen offset:1024 sc1
    buffer_load_dwordx2 v[58:59], v8, s[44:47], s70 offen offset:1536 sc1
    buffer_load_dwordx2 v[60:61], v8, s[44:47], s70 offen offset:2048 sc1
    buffer_load_dwordx2 v[62:63], v8, s[44:47], s70 offen offset:2560 sc1
    v_mfma_f32_16x16x32_bf16 v[156:159], v[68:71], a[4:7], v[156:159]
    s_waitcnt lgkmcnt(1)
    v_add_f32 v144, v144, v40
    v_add_f32 v145, v145, v41
    v_add_f32 v146, v146, v42
    v_add_f32 v147, v147, v43
    v_mfma_f32_16x16x32_bf16 v[124:127], v[68:71], a[28:31], v[124:127]
    s_waitcnt lgkmcnt(0)
    v_add_f32 v144, v144, v44
    v_add_f32 v145, v145, v45
    v_add_f32 v146, v146, v46
    v_add_f32_e64 v147, v147, v47
    v_mfma_f32_16x16x32_bf16 v[128:131], v[68:71], a[52:55], v[128:131]
    v_add_u32 v4, 28672, v4
    ds_read_b128 v[16:19], v4 offset:0
    ds_read_b128 v[20:23], v4 offset:1024
    ds_read_b128 v[24:27], v4 offset:2048
    ds_read_b128 v[28:31], v4 offset:3072
    ds_read_b128 v[32:35], v4 offset:4096
    ds_read_b128 v[40:43], v4 offset:5120
    ds_read_b128 v[44:47], v4 offset:6144
    v_mfma_f32_16x16x32_bf16 v[132:135], v[68:71], v[172:175], v[132:135]
    v_add_u32 v5, -86016, v5
    v_add_u32 v6, -86016, v6
    v_add_u32 v7, -86016, v7
    ds_write_b128 v5, v[112:115]
    ds_write_b128 v6, v[116:119]
    ds_write_b128 v7, v[120:123]
    v_mfma_f32_16x16x32_bf16 v[156:159], v[72:75], a[8:11], v[156:159]
    v_mfma_f32_16x16x32_bf16 v[124:127], v[72:75], a[32:35], v[124:127]
    s_waitcnt lgkmcnt(9)
    v_add_f32 v148, v148, v16
    v_add_f32 v149, v149, v17
    v_add_f32 v150, v150, v18
    v_add_f32_e64 v151, v151, v19
    v_mfma_f32_16x16x32_bf16 v[128:131], v[72:75], a[56:59], v[128:131]
    s_waitcnt lgkmcnt(8)
    v_add_f32 v148, v148, v20
    v_add_f32 v149, v149, v21
    v_add_f32 v150, v150, v22
    v_add_f32_e64 v151, v151, v23
    v_mfma_f32_16x16x32_bf16 v[132:135], v[72:75], v[176:179], v[132:135]
    s_waitcnt lgkmcnt(7)
    v_add_f32 v148, v148, v24
    v_add_f32 v149, v149, v25
    v_add_f32 v150, v150, v26
    v_add_f32_e64 v151, v151, v27
    v_mfma_f32_16x16x32_bf16 v[156:159], v[76:79], a[12:15], v[156:159]
    s_waitcnt lgkmcnt(6)
    v_add_f32 v148, v148, v28
    v_add_f32 v149, v149, v29
    v_add_f32 v150, v150, v30
    v_add_f32_e64 v151, v151, v31
    v_mfma_f32_16x16x32_bf16 v[124:127], v[76:79], a[36:39], v[124:127]
    s_waitcnt lgkmcnt(5)
    v_add_f32 v148, v148, v32
    v_add_f32 v149, v149, v33
    v_add_f32 v150, v150, v34
    v_add_f32_e64 v151, v151, v35
    v_mfma_f32_16x16x32_bf16 v[128:131], v[76:79], a[60:63], v[128:131]
    s_waitcnt lgkmcnt(4)
    v_add_f32 v148, v148, v40
    v_add_f32 v149, v149, v41
    v_add_f32 v150, v150, v42
    v_add_f32_e64 v151, v151, v43
    v_mfma_f32_16x16x32_bf16 v[132:135], v[76:79], v[180:183], v[132:135]
    s_waitcnt lgkmcnt(3)
    v_add_f32 v148, v148, v44
    v_add_f32 v149, v149, v45
    v_add_f32 v150, v150, v46
    v_add_f32_e64 v151, v151, v47
    v_mfma_f32_16x16x32_bf16 v[156:159], v[80:83], a[16:19], v[156:159]
    v_mfma_f32_16x16x32_bf16 v[124:127], v[80:83], a[40:43], v[124:127]
    v_mfma_f32_16x16x32_bf16 v[128:131], v[80:83], v[160:163], v[128:131]
    v_mfma_f32_16x16x32_bf16 v[132:135], v[80:83], v[184:187], v[132:135]
    s_waitcnt lgkmcnt(0)
    s_barrier
    v_mfma_f32_16x16x32_bf16 v[156:159], v[84:87], a[20:23], v[156:159]
    v_add_u32 v4, -86016, v4
    ds_read_b128 v[16:19], v4 offset:0
    ds_read_b128 v[20:23], v4 offset:1024
    ds_read_b128 v[24:27], v4 offset:2048
    ds_read_b128 v[28:31], v4 offset:3072
    ds_read_b128 v[32:35], v4 offset:4096
    ds_read_b128 v[40:43], v4 offset:5120
    ds_read_b128 v[44:47], v4 offset:6144
    v_mfma_f32_16x16x32_bf16 v[124:127], v[84:87], a[44:47], v[124:127]
    v_mfma_f32_16x16x32_bf16 v[128:131], v[84:87], v[164:167], v[128:131]
    v_mfma_f32_16x16x32_bf16 v[132:135], v[84:87], v[188:191], v[132:135]
    s_waitcnt lgkmcnt(6)
    v_add_f32 v152, v152, v16
    v_add_f32 v153, v153, v17
    v_add_f32 v154, v154, v18
    v_add_f32_e64 v155, v155, v19
    v_add_u32 v5, 122880, v5
    v_add_u32 v6, 122880, v6
    v_add_u32 v7, 122880, v7
    ds_write_b128 v5, v[124:127]
    ds_write_b128 v6, v[128:131]
    ds_write_b128 v7, v[132:135]
    s_waitcnt lgkmcnt(8)
    v_add_f32 v152, v152, v20
    v_add_f32 v153, v153, v21
    v_add_f32 v154, v154, v22
    v_add_f32 v155, v155, v23
    s_waitcnt lgkmcnt(7)
    v_add_f32 v152, v152, v24
    v_add_f32 v153, v153, v25
    v_add_f32 v154, v154, v26
    v_add_f32 v155, v155, v27
    s_waitcnt lgkmcnt(6)
    v_add_f32 v152, v152, v28
    v_add_f32 v153, v153, v29
    v_add_f32 v154, v154, v30
    v_add_f32 v155, v155, v31
    s_waitcnt lgkmcnt(5)
    v_add_f32 v152, v152, v32
    v_add_f32 v153, v153, v33
    v_add_f32 v154, v154, v34
    v_add_f32 v155, v155, v35
    s_waitcnt lgkmcnt(4)
    v_add_f32 v152, v152, v40
    v_add_f32 v153, v153, v41
    v_add_f32 v154, v154, v42
    v_add_f32 v155, v155, v43
    s_waitcnt lgkmcnt(3)
    v_add_f32 v152, v152, v44
    v_add_f32 v153, v153, v45
    v_add_f32 v154, v154, v46
    v_add_f32 v155, v155, v47
    s_waitcnt vmcnt(0)
    v_lshlrev_b32 v80, 16, v52
    v_and_b32 v81, s55, v52
    v_lshlrev_b32 v82, 16, v53
    v_and_b32_e64 v83, s55, v53
    v_pk_mul_f32 v[80:81], v[80:81], v[136:137]
    v_pk_mul_f32 v[82:83], v[82:83], v[138:139]
    v_cvt_pk_bf16_f32 v64, v80, v81
    v_cvt_pk_bf16_f32 v65, v82, v83
    v_lshlrev_b32 v84, 16, v54
    v_and_b32 v85, s55, v54
    v_lshlrev_b32 v86, 16, v55
    v_and_b32 v87, s55, v55
    v_pk_mul_f32 v[84:85], v[84:85], v[140:141]
    v_pk_mul_f32 v[86:87], v[86:87], v[142:143]
    v_cvt_pk_bf16_f32 v66, v84, v85
    v_cvt_pk_bf16_f32 v67, v86, v87
    buffer_store_dwordx4 v[64:67], v2, s[44:47], s70 offen offset:0
    v_lshlrev_b32 v80, 16, v56
    v_and_b32 v81, s55, v56
    v_lshlrev_b32 v82, 16, v57
    v_and_b32 v83, s55, v57
    v_pk_mul_f32 v[80:81], v[80:81], v[144:145]
    v_pk_mul_f32 v[82:83], v[82:83], v[146:147]
    v_cvt_pk_bf16_f32 v68, v80, v81
    v_cvt_pk_bf16_f32 v69, v82, v83
    v_lshlrev_b32 v84, 16, v58
    v_and_b32 v85, s55, v58
    v_lshlrev_b32 v86, 16, v59
    v_and_b32 v87, s55, v59
    v_pk_mul_f32 v[84:85], v[84:85], v[148:149]
    v_pk_mul_f32 v[86:87], v[86:87], v[150:151]
    v_cvt_pk_bf16_f32 v70, v84, v85
    v_cvt_pk_bf16_f32 v71, v86, v87
    buffer_store_dwordx4 v[68:71], v2, s[44:47], s70 offen offset:1024
    s_waitcnt lgkmcnt(0)
    s_barrier
    v_add_u32 v4, 122880, v4
    ds_read_b128 v[16:19], v4 offset:0
    ds_read_b128 v[20:23], v4 offset:1024
    ds_read_b128 v[24:27], v4 offset:2048
    ds_read_b128 v[28:31], v4 offset:3072
    ds_read_b128 v[32:35], v4 offset:4096
    ds_read_b128 v[40:43], v4 offset:5120
    ds_read_b128 v[44:47], v4 offset:6144
    v_lshlrev_b32 v80, 16, v60
    v_and_b32 v81, s55, v60
    v_lshlrev_b32 v82, 16, v61
    v_and_b32_e64 v83, s55, v61
    s_waitcnt lgkmcnt(6)
    v_pk_add_f32 v[156:157], v[156:157], v[16:17]
    v_pk_add_f32 v[158:159], v[158:159], v[18:19]
    s_waitcnt lgkmcnt(5)
    v_pk_add_f32 v[156:157], v[156:157], v[20:21]
    v_pk_add_f32 v[158:159], v[158:159], v[22:23]
    s_waitcnt lgkmcnt(4)
    v_pk_add_f32 v[156:157], v[156:157], v[24:25]
    v_pk_add_f32 v[158:159], v[158:159], v[26:27]
    s_waitcnt lgkmcnt(3)
    v_pk_add_f32 v[156:157], v[156:157], v[28:29]
    v_pk_add_f32 v[158:159], v[158:159], v[30:31]
    s_waitcnt lgkmcnt(2)
    v_pk_add_f32 v[156:157], v[156:157], v[32:33]
    v_pk_add_f32 v[158:159], v[158:159], v[34:35]
    s_waitcnt lgkmcnt(1)
    v_pk_add_f32 v[156:157], v[156:157], v[40:41]
    v_pk_add_f32 v[158:159], v[158:159], v[42:43]
    s_waitcnt lgkmcnt(0)
    v_pk_add_f32 v[156:157], v[156:157], v[44:45]
    v_pk_add_f32 v[158:159], v[158:159], v[46:47]
    v_pk_mul_f32 v[80:81], v[80:81], v[152:153]
    v_pk_mul_f32 v[82:83], v[82:83], v[154:155]
    v_cvt_pk_bf16_f32 v72, v80, v81
    v_cvt_pk_bf16_f32 v73, v82, v83
    v_lshlrev_b32 v84, 16, v62
    v_and_b32 v85, s55, v62
    v_lshlrev_b32 v86, 16, v63
    v_and_b32 v87, s55, v63
    v_pk_mul_f32 v[84:85], v[84:85], v[156:157]
    v_pk_mul_f32 v[86:87], v[86:87], v[158:159]
    v_cvt_pk_bf16_f32 v74, v84, v85
    v_cvt_pk_bf16_f32 v75, v86, v87
    buffer_store_dwordx4 v[72:75], v2, s[44:47], s70 offen offset:2048
    s_lshl_b32 s99, s64, 3
    s_add_u32 s99, s99, s62
    s_waitcnt vmcnt(0)
    s_lshl_b32 s72, s99, 2
    s_add_u32 s72, s72, 28672
    v_mov_b32 v10, s96
    v_mov_b32_e64 v11, 0
    s_mov_b64 exec, 1
    s_cmp_eq_u32 s97, 0
    s_cbranch_scc1 fs_slow_24
    buffer_store_dword v10, v11, s[44:47], s72 offen
    s_branch fs_done_25
fs_slow_24:
    buffer_wbl2 sc1
    s_waitcnt vmcnt(0)
    buffer_store_dword v10, v11, s[44:47], s72 offen sc1
fs_done_25:
    s_mov_b64 exec, -1
    v_lshlrev_b32 v16, 16, v36
    v_and_b32 v17, s55, v36
    v_lshlrev_b32 v18, 16, v37
    v_and_b32 v19, s55, v37
    v_lshlrev_b32 v20, 16, v38
    v_and_b32 v21, s55, v38
    v_lshlrev_b32 v22, 16, v39
    v_and_b32 v23, s55, v39
    v_lshlrev_b32 v24, 16, v104
    v_and_b32 v25, s55, v104
    v_lshlrev_b32 v26, 16, v105
    v_and_b32 v27, s55, v105
    v_lshlrev_b32 v28, 16, v106
    v_and_b32 v29, s55, v106
    v_lshlrev_b32 v30, 16, v107
    v_and_b32 v31, s55, v107
    v_lshlrev_b32 v32, 16, v108
    v_and_b32 v33, s55, v108
    v_lshlrev_b32 v34, 16, v109
    v_and_b32_e64 v35, s55, v109
    v_add_u32 v5, 61440, v2
    v_and_b32_e64 v10, 15, v1
    v_mul_u32_u24 v10, 2560, v10
    v_lshrrev_b32_e64 v11, 4, v1
    v_lshl_add_u32 v6, v11, 3, v10
    s_lshr_b32 s86, s8, 1
    s_lshl_b32 s86, s86, 5
    s_and_b32 s73, s8, 1
    s_add_u32 s86, s86, s73
    s_mul_i32 s86, s86, 1280
    s_mul_i32 s73, s9, 160
    s_add_u32 s86, s86, s73
    s_mul_i32 s80, s8, 24576
    s_add_u32 s80, s80, 8388608
    s_add_u32 s81, s80, 4096
    s_add_u32 s82, s80, 8192
    s_add_u32 s83, s80, 12288
    s_add_u32 s84, s80, 16384
    s_add_u32 s85, s80, 20480
    s_lshl_b32 s99, s8, 3
    s_lshl_b32 s72, s99, 2
    s_add_u32 s72, s72, 28672
    v_min_u32 v11, 7, v1
    v_lshlrev_b32_e64 v11, 2, v11
    s_mov_b32 s98, 0x100000
poll_26:
    buffer_load_dword v10, v11, s[44:47], s72 offen sc1
    s_waitcnt vmcnt(0)
    v_cmp_ne_u32 vcc, s96, v10
    s_cbranch_vccz polled_27
    s_sub_u32 s98, s98, 1
    s_cbranch_scc0 poll_26
polled_27:
    buffer_load_dwordx4 v[64:67], v2, s[44:47], s80 offen offset:0 sc1
    buffer_load_dwordx4 v[68:71], v2, s[44:47], s80 offen offset:1024 sc1
    buffer_load_dwordx4 v[72:75], v2, s[44:47], s80 offen offset:2048 sc1
    buffer_load_dwordx4 v[76:79], v2, s[44:47], s80 offen offset:3072 sc1
    buffer_load_dwordx4 v[80:83], v2, s[44:47], s81 offen offset:0 sc1
    buffer_load_dwordx4 v[84:87], v2, s[44:47], s81 offen offset:1024 sc1
    buffer_load_dwordx4 v[88:91], v2, s[44:47], s81 offen offset:2048 sc1
    buffer_load_dwordx4 v[92:95], v2, s[44:47], s81 offen offset:3072 sc1
    s_barrier
    ds_read_b128 a[0:3], v2 offset:0
    ds_read_b128 a[4:7], v2 offset:1024
    ds_read_b128 a[8:11], v2 offset:2048
    ds_read_b128 a[12:15], v2 offset:3072
    ds_read_b128 a[16:19], v2 offset:4096
    ds_read_b128 a[20:23], v2 offset:5120
    ds_read_b128 a[24:27], v2 offset:6144
    ds_read_b128 a[28:31], v2 offset:7168
    ds_read_b128 a[32:35], v2 offset:8192
    ds_read_b128 a[36:39], v2 offset:9216
    ds_read_b128 a[40:43], v2 offset:10240
    ds_read_b128 a[44:47], v2 offset:11264
    s_waitcnt vmcnt(7) lgkmcnt(11)
    v_mfma_f32_16x16x32_bf16 v[16:19], a[0:3], v[64:67], v[16:19]
    ds_read_b128 a[48:51], v2 offset:12288
    buffer_load_dwordx4 v[96:99], v2, s[44:47], s82 offen offset:0 sc1
    s_waitcnt lgkmcnt(11)
    v_mfma_f32_16x16x32_bf16 v[20:23], a[4:7], v[64:67], v[20:23]
    ds_read_b128 a[52:55], v2 offset:13312
    s_waitcnt lgkmcnt(11)
    v_mfma_f32_16x16x32_bf16 v[24:27], a[8:11], v[64:67], v[24:27]
    ds_read_b128 a[56:59], v2 offset:14336
    s_waitcnt lgkmcnt(11)
    v_mfma_f32_16x16x32_bf16 v[28:31], a[12:15], v[64:67], v[28:31]
    ds_read_b128 a[60:63], v2 offset:15360
    s_waitcnt lgkmcnt(11)
    v_mfma_f32_16x16x32_bf16 v[32:35], a[16:19], v[64:67], v[32:35]
    ds_read_b128 v[160:163], v2 offset:16384
    s_waitcnt vmcnt(7) lgkmcnt(11)
    v_mfma_f32_16x16x32_bf16 v[16:19], a[20:23], v[68:71], v[16:19]
    ds_read_b128 v[164:167], v2 offset:17408
    buffer_load_dwordx4 v[100:103], v2, s[44:47], s82 offen offset:1024 sc1
    s_waitcnt lgkmcnt(11)
    v_mfma_f32_16x16x32_bf16 v[20:23], a[24:27], v[68:71], v[20:23]
    ds_read_b128 v[168:171], v2 offset:18432
    s_waitcnt lgkmcnt(11)
    v_mfma_f32_16x16x32_bf16 v[24:27], a[28:31], v[68:71], v[24:27]
    ds_read_b128 v[172:175], v2 offset:19456
    s_waitcnt lgkmcnt(11)
    v_mfma_f32_16x16x32_bf16 v[28:31], a[32:35], v[68:71], v[28:31]
    ds_read_b128 v[176:179], v2 offset:20480
    s_waitcnt lgkmcnt(11)
    v_mfma_f32_16x16x32_bf16 v[32:35], a[36:39], v[68:71], v[32:35]
    ds_read_b128 v[180:183], v2 offset:21504
    s_waitcnt vmcnt(7) lgkmcnt(11)
    v_mfma_f32_16x16x32_bf16 v[16:19], a[40:43], v[72:75], v[16:19]
    ds_read_b128 v[184:187], v2 offset:22528
    buffer_load_dwordx4 v[104:107], v2, s[44:47], s82 offen offset:2048 sc1
    s_waitcnt lgkmcnt(11)
    v_mfma_f32_16x16x32_bf16 v[20:23], a[44:47], v[72:75], v[20:23]
    ds_read_b128 v[188:191], v2 offset:23552
    s_waitcnt lgkmcnt(11)
    v_mfma_f32_16x16x32_bf16 v[24:27], a[48:51], v[72:75], v[24:27]
    ds_read_b128 a[0:3], v2 offset:24576
    s_waitcnt lgkmcnt(11)
    v_mfma_f32_16x16x32_bf16 v[28:31], a[52:55], v[72:75], v[28:31]
    ds_read_b128 a[4:7], v2 offset:25600
    s_waitcnt lgkmcnt(11)
    v_mfma_f32_16x16x32_bf16 v[32:35], a[56:59], v[72:75], v[32:35]
    ds_read_b128 a[8:11], v2 offset:26624
    s_waitcnt vmcnt(7) lgkmcnt(11)
    v_mfma_f32_16x16x32_bf16 v[16:19], a[60:63], v[76:79], v[16:19]
    ds_read_b128 a[12:15], v2 offset:27648
    buffer_load_dwordx4 v[108:111], v2, s[44:47], s82 offen offset:3072 sc1
    s_waitcnt lgkmcnt(11)
    v_mfma_f32_16x16x32_bf16 v[20:23], v[160:163], v[76:79], v[20:23]
    ds_read_b128 a[16:19], v2 offset:28672
    s_waitcnt lgkmcnt(11)
    v_mfma_f32_16x16x32_bf16 v[24:27], v[164:167], v[76:79], v[24:27]
    ds_read_b128 a[20:23], v2 offset:29696
    s_waitcnt lgkmcnt(11)
    v_mfma_f32_16x16x32_bf16 v[28:31], v[168:171], v[76:79], v[28:31]
    ds_read_b128 a[24:27], v2 offset:30720
    s_waitcnt lgkmcnt(11)
    v_mfma_f32_16x16x32_bf16 v[32:35], v[172:175], v[76:79], v[32:35]
    ds_read_b128 a[28:31], v2 offset:31744
    s_waitcnt vmcnt(7) lgkmcnt(11)
    v_mfma_f32_16x16x32_bf16 v[16:19], v[176:179], v[80:83], v[16:19]
    ds_read_b128 a[32:35], v2 offset:32768
    buffer_load_dwordx4 v[112:115], v2, s[44:47], s83 offen offset:0 sc1
    s_waitcnt lgkmcnt(11)
    v_mfma_f32_16x16x32_bf16 v[20:23], v[180:183], v[80:83], v[20:23]
    ds_read_b128 a[36:39], v2 offset:33792
    s_waitcnt lgkmcnt(11)
    v_mfma_f32_16x16x32_bf16 v[24:27], v[184:187], v[80:83], v[24:27]
    ds_read_b128 a[40:43], v2 offset:34816
    s_waitcnt lgkmcnt(11)
    v_mfma_f32_16x16x32_bf16 v[28:31], v[188:191], v[80:83], v[28:31]
    ds_read_b128 a[44:47], v2 offset:35840
    s_waitcnt lgkmcnt(11)
    v_mfma_f32_16x16x32_bf16 v[32:35], a[0:3], v[80:83], v[32:35]
    ds_read_b128 a[48:51], v2 offset:36864
    s_waitcnt vmcnt(7) lgkmcnt(11)
    v_mfma_f32_16x16x32_bf16 v[16:19], a[4:7], v[84:87], v[16:19]
    ds_read_b128 a[52:55], v2 offset:37888
    buffer_load_dwordx4 v[116:119], v2, s[44:47], s83 offen offset:1024 sc1
    s_waitcnt lgkmcnt(11)
    v_mfma_f32_16x16x32_bf16 v[20:23], a[8:11], v[84:87], v[20:23]
    ds_read_b128 a[56:59], v2 offset:38912
    s_waitcnt lgkmcnt(11)
    v_mfma_f32_16x16x32_bf16 v[24:27], a[12:15], v[84:87], v[24:27]
    ds_read_b128 a[60:63], v2 offset:39936
    s_waitcnt lgkmcnt(11)
    v_mfma_f32_16x16x32_bf16 v[28:31], a[16:19], v[84:87], v[28:31]
    ds_read_b128 v[160:163], v2 offset:40960
    s_waitcnt lgkmcnt(11)
    v_mfma_f32_16x16x32_bf16 v[32:35], a[20:23], v[84:87], v[32:35]
    ds_read_b128 v[164:167], v2 offset:41984
    s_waitcnt vmcnt(7) lgkmcnt(11)
    v_mfma_f32_16x16x32_bf16 v[16:19], a[24:27], v[88:91], v[16:19]
    ds_read_b128 v[168:171], v2 offset:43008
    buffer_load_dwordx4 v[120:123], v2, s[44:47], s83 offen offset:2048 sc1
    s_waitcnt lgkmcnt(11)
    v_mfma_f32_16x16x32_bf16 v[20:23], a[28:31], v[88:91], v[20:23]
    ds_read_b128 v[172:175], v2 offset:44032
    s_waitcnt lgkmcnt(11)
    v_mfma_f32_16x16x32_bf16 v[24:27], a[32:35], v[88:91], v[24:27]
    ds_read_b128 v[176:179], v2 offset:45056
    s_waitcnt lgkmcnt(11)
    v_mfma_f32_16x16x32_bf16 v[28:31], a[36:39], v[88:91], v[28:31]
    ds_read_b128 v[180:183], v2 offset:46080
    s_waitcnt lgkmcnt(11)
    v_mfma_f32_16x16x32_bf16 v[32:35], a[40:43], v[88:91], v[32:35]
    ds_read_b128 v[184:187], v2 offset:47104
    s_waitcnt vmcnt(7) lgkmcnt(11)
    v_mfma_f32_16x16x32_bf16 v[16:19], a[44:47], v[92:95], v[16:19]
    ds_read_b128 v[188:191], v2 offset:48128
    buffer_load_dwordx4 v[124:127], v2, s[44:47], s83 offen offset:3072 sc1
    s_waitcnt lgkmcnt(11)
    v_mfma_f32_16x16x32_bf16 v[20:23], a[48:51], v[92:95], v[20:23]
    ds_read_b128 a[0:3], v2 offset:49152
    s_waitcnt lgkmcnt(11)
    v_mfma_f32_16x16x32_bf16 v[24:27], a[52:55], v[92:95], v[24:27]
    ds_read_b128 a[4:7], v2 offset:50176
    s_waitcnt lgkmcnt(11)
    v_mfma_f32_16x16x32_bf16 v[28:31], a[56:59], v[92:95], v[28:31]
    ds_read_b128 a[8:11], v2 offset:51200
    s_waitcnt lgkmcnt(11)
    v_mfma_f32_16x16x32_bf16 v[32:35], a[60:63], v[92:95], v[32:35]
    ds_read_b128 a[12:15], v2 offset:52224
    s_waitcnt vmcnt(7) lgkmcnt(11)
    v_mfma_f32_16x16x32_bf16 v[16:19], v[160:163], v[96:99], v[16:19]
    ds_read_b128 a[16:19], v2 offset:53248
    buffer_load_dwordx4 v[128:131], v2, s[44:47], s84 offen offset:0 sc1
    s_waitcnt lgkmcnt(11)
    v_mfma_f32_16x16x32_bf16 v[20:23], v[164:167], v[96:99], v[20:23]
    ds_read_b128 a[20:23], v2 offset:54272
    s_waitcnt lgkmcnt(11)
    v_mfma_f32_16x16x32_bf16 v[24:27], v[168:171], v[96:99], v[24:27]
    ds_read_b128 a[24:27], v2 offset:55296
    s_waitcnt lgkmcnt(11)
    v_mfma_f32_16x16x32_bf16 v[28:31], v[172:175], v[96:99], v[28:31]
    ds_read_b128 a[28:31], v2 offset:56320
    s_waitcnt lgkmcnt(11)
    v_mfma_f32_16x16x32_bf16 v[32:35], v[176:179], v[96:99], v[32:35]
    ds_read_b128 a[32:35], v2 offset:57344
    s_waitcnt vmcnt(7) lgkmcnt(11)
    v_mfma_f32_16x16x32_bf16 v[16:19], v[180:183], v[100:103], v[16:19]
    ds_read_b128 a[36:39], v2 offset:58368
    buffer_load_dwordx4 v[132:135], v2, s[44:47], s84 offen offset:1024 sc1
    s_waitcnt lgkmcnt(11)
    v_mfma_f32_16x16x32_bf16 v[20:23], v[184:187], v[100:103], v[20:23]
    ds_read_b128 a[40:43], v2 offset:59392
    s_waitcnt lgkmcnt(11)
    v_mfma_f32_16x16x32_bf16 v[24:27], v[188:191], v[100:103], v[24:27]
    ds_read_b128 a[44:47], v2 offset:60416
    s_waitcnt lgkmcnt(11)
    v_mfma_f32_16x16x32_bf16 v[28:31], a[0:3], v[100:103], v[28:31]
    s_barrier
    ds_read_b128 a[48:51], v5 offset:0
    s_waitcnt lgkmcnt(11)
    v_mfma_f32_16x16x32_bf16 v[32:35], a[4:7], v[100:103], v[32:35]
    ds_read_b128 a[52:55], v5 offset:1024
    s_waitcnt vmcnt(7) lgkmcnt(11)
    v_mfma_f32_16x16x32_bf16 v[16:19], a[8:11], v[104:107], v[16:19]
    ds_read_b128 a[56:59], v5 offset:2048
    buffer_load_dwordx4 v[136:139], v2, s[44:47], s84 offen offset:2048 sc1
    s_waitcnt lgkmcnt(11)
    v_mfma_f32_16x16x32_bf16 v[20:23], a[12:15], v[104:107], v[20:23]
    ds_read_b128 a[60:63], v5 offset:3072
    s_waitcnt lgkmcnt(11)
    v_mfma_f32_16x16x32_bf16 v[24:27], a[16:19], v[104:107], v[24:27]
    ds_read_b128 v[160:163], v5 offset:4096
    s_waitcnt lgkmcnt(11)
    v_mfma_f32_16x16x32_bf16 v[28:31], a[20:23], v[104:107], v[28:31]
    ds_read_b128 v[164:167], v5 offset:5120
    s_waitcnt lgkmcnt(11)
    v_mfma_f32_16x16x32_bf16 v[32:35], a[24:27], v[104:107], v[32:35]
    ds_read_b128 v[168:171], v5 offset:6144
    s_waitcnt vmcnt(7) lgkmcnt(11)
    v_mfma_f32_16x16x32_bf16 v[16:19], a[28:31], v[108:111], v[16:19]
    ds_read_b128 v[172:175], v5 offset:7168
    buffer_load_dwordx4 v[140:143], v2, s[44:47], s84 offen offset:3072 sc1
    s_waitcnt lgkmcnt(11)
    v_mfma_f32_16x16x32_bf16 v[20:23], a[32:35], v[108:111], v[20:23]
    ds_read_b128 v[176:179], v5 offset:8192
    s_waitcnt lgkmcnt(11)
    v_mfma_f32_16x16x32_bf16 v[24:27], a[36:39], v[108:111], v[24:27]
    ds_read_b128 v[180:183], v5 offset:9216
    s_waitcnt lgkmcnt(11)
    v_mfma_f32_16x16x32_bf16 v[28:31], a[40:43], v[108:111], v[28:31]
    ds_read_b128 v[184:187], v5 offset:10240
    s_waitcnt lgkmcnt(11)
    v_mfma_f32_16x16x32_bf16 v[32:35], a[44:47], v[108:111], v[32:35]
    ds_read_b128 v[188:191], v5 offset:11264
    s_waitcnt vmcnt(7) lgkmcnt(11)
    v_mfma_f32_16x16x32_bf16 v[16:19], a[48:51], v[112:115], v[16:19]
    ds_read_b128 a[0:3], v5 offset:12288
    buffer_load_dwordx4 v[144:147], v2, s[44:47], s85 offen offset:0 sc1
    s_waitcnt lgkmcnt(11)
    v_mfma_f32_16x16x32_bf16 v[20:23], a[52:55], v[112:115], v[20:23]
    ds_read_b128 a[4:7], v5 offset:13312
    s_waitcnt lgkmcnt(11)
    v_mfma_f32_16x16x32_bf16 v[24:27], a[56:59], v[112:115], v[24:27]
    ds_read_b128 a[8:11], v5 offset:14336
    s_waitcnt lgkmcnt(11)
    v_mfma_f32_16x16x32_bf16 v[28:31], a[60:63], v[112:115], v[28:31]
    ds_read_b128 a[12:15], v5 offset:15360
    s_waitcnt lgkmcnt(11)
    v_mfma_f32_16x16x32_bf16 v[32:35], v[160:163], v[112:115], v[32:35]
    ds_read_b128 a[16:19], v5 offset:16384
    s_waitcnt vmcnt(7) lgkmcnt(11)
    v_mfma_f32_16x16x32_bf16 v[16:19], v[164:167], v[116:119], v[16:19]
    ds_read_b128 a[20:23], v5 offset:17408
    buffer_load_dwordx4 v[148:151], v2, s[44:47], s85 offen offset:1024 sc1
    s_waitcnt lgkmcnt(11)
    v_mfma_f32_16x16x32_bf16 v[20:23], v[168:171], v[116:119], v[20:23]
    ds_read_b128 a[24:27], v5 offset:18432
    s_waitcnt lgkmcnt(11)
    v_mfma_f32_16x16x32_bf16 v[24:27], v[172:175], v[116:119], v[24:27]
    ds_read_b128 a[28:31], v5 offset:19456
    s_waitcnt lgkmcnt(11)
    v_mfma_f32_16x16x32_bf16 v[28:31], v[176:179], v[116:119], v[28:31]
    ds_read_b128 a[32:35], v5 offset:20480
    s_waitcnt lgkmcnt(11)
    v_mfma_f32_16x16x32_bf16 v[32:35], v[180:183], v[116:119], v[32:35]
    ds_read_b128 a[36:39], v5 offset:21504
    s_waitcnt vmcnt(7) lgkmcnt(11)
    v_mfma_f32_16x16x32_bf16 v[16:19], v[184:187], v[120:123], v[16:19]
    ds_read_b128 a[40:43], v5 offset:22528
    buffer_load_dwordx4 v[152:155], v2, s[44:47], s85 offen offset:2048 sc1
    s_waitcnt lgkmcnt(11)
    v_mfma_f32_16x16x32_bf16 v[20:23], v[188:191], v[120:123], v[20:23]
    ds_read_b128 a[44:47], v5 offset:23552
    s_waitcnt lgkmcnt(11)
    v_mfma_f32_16x16x32_bf16 v[24:27], a[0:3], v[120:123], v[24:27]
    ds_read_b128 a[48:51], v5 offset:24576
    s_waitcnt lgkmcnt(11)
    v_mfma_f32_16x16x32_bf16 v[28:31], a[4:7], v[120:123], v[28:31]
    ds_read_b128 a[52:55], v5 offset:25600
    s_waitcnt lgkmcnt(11)
    v_mfma_f32_16x16x32_bf16 v[32:35], a[8:11], v[120:123], v[32:35]
    ds_read_b128 a[56:59], v5 offset:26624
    s_waitcnt vmcnt(7) lgkmcnt(11)
    v_mfma_f32_16x16x32_bf16 v[16:19], a[12:15], v[124:127], v[16:19]
    ds_read_b128 a[60:63], v5 offset:27648
    buffer_load_dwordx4 v[156:159], v2, s[44:47], s85 offen offset:3072 sc1
    s_waitcnt lgkmcnt(11)
    v_mfma_f32_16x16x32_bf16 v[20:23], a[16:19], v[124:127], v[20:23]
    ds_read_b128 v[160:163], v5 offset:28672
    s_waitcnt lgkmcnt(11)
    v_mfma_f32_16x16x32_bf16 v[24:27], a[20:23], v[124:127], v[24:27]
    ds_read_b128 v[164:167], v5 offset:29696
    s_waitcnt lgkmcnt(11)
    v_mfma_f32_16x16x32_bf16 v[28:31], a[24:27], v[124:127], v[28:31]
    ds_read_b128 v[168:171], v5 offset:30720
    s_waitcnt lgkmcnt(11)
    v_mfma_f32_16x16x32_bf16 v[32:35], a[28:31], v[124:127], v[32:35]
    ds_read_b128 v[172:175], v5 offset:31744
    s_waitcnt vmcnt(7) lgkmcnt(11)
    v_mfma_f32_16x16x32_bf16 v[16:19], a[32:35], v[128:131], v[16:19]
    ds_read_b128 v[176:179], v5 offset:32768
    s_waitcnt lgkmcnt(11)
    v_mfma_f32_16x16x32_bf16 v[20:23], a[36:39], v[128:131], v[20:23]
    ds_read_b128 v[180:183], v5 offset:33792
    s_waitcnt lgkmcnt(11)
    v_mfma_f32_16x16x32_bf16 v[24:27], a[40:43], v[128:131], v[24:27]
    ds_read_b128 v[184:187], v5 offset:34816
    s_waitcnt lgkmcnt(11)
    v_mfma_f32_16x16x32_bf16 v[28:31], a[44:47], v[128:131], v[28:31]
    ds_read_b128 v[188:191], v5 offset:35840
    s_waitcnt lgkmcnt(11)
    v_mfma_f32_16x16x32_bf16 v[32:35], a[48:51], v[128:131], v[32:35]
    ds_read_b128 a[0:3], v5 offset:36864
    s_waitcnt vmcnt(6) lgkmcnt(11)
    v_mfma_f32_16x16x32_bf16 v[16:19], a[52:55], v[132:135], v[16:19]
    ds_read_b128 a[4:7], v5 offset:37888
    s_waitcnt lgkmcnt(11)
    v_mfma_f32_16x16x32_bf16 v[20:23], a[56:59], v[132:135], v[20:23]
    ds_read_b128 a[8:11], v5 offset:38912
    s_waitcnt lgkmcnt(11)
    v_mfma_f32_16x16x32_bf16 v[24:27], a[60:63], v[132:135], v[24:27]
    ds_read_b128 a[12:15], v5 offset:39936
    s_waitcnt lgkmcnt(11)
    v_mfma_f32_16x16x32_bf16 v[28:31], v[160:163], v[132:135], v[28:31]
    ds_read_b128 a[16:19], v5 offset:40960
    s_waitcnt lgkmcnt(11)
    v_mfma_f32_16x16x32_bf16 v[32:35], v[164:167], v[132:135], v[32:35]
    ds_read_b128 a[20:23], v5 offset:41984
    s_waitcnt vmcnt(5) lgkmcnt(11)
    v_mfma_f32_16x16x32_bf16 v[16:19], v[168:171], v[136:139], v[16:19]
    ds_read_b128 a[24:27], v5 offset:43008
    s_waitcnt lgkmcnt(11)
    v_mfma_f32_16x16x32_bf16 v[20:23], v[172:175], v[136:139], v[20:23]
    ds_read_b128 a[28:31], v5 offset:44032
    s_waitcnt lgkmcnt(11)
    v_mfma_f32_16x16x32_bf16 v[24:27], v[176:179], v[136:139], v[24:27]
    ds_read_b128 a[32:35], v5 offset:45056
    s_waitcnt lgkmcnt(11)
    v_mfma_f32_16x16x32_bf16 v[28:31], v[180:183], v[136:139], v[28:31]
    ds_read_b128 a[36:39], v5 offset:46080
    s_waitcnt lgkmcnt(11)
    v_mfma_f32_16x16x32_bf16 v[32:35], v[184:187], v[136:139], v[32:35]
    ds_read_b128 a[40:43], v5 offset:47104
    s_waitcnt vmcnt(4) lgkmcnt(11)
    v_mfma_f32_16x16x32_bf16 v[16:19], v[188:191], v[140:143], v[16:19]
    ds_read_b128 a[44:47], v5 offset:48128
    s_waitcnt lgkmcnt(11)
    v_mfma_f32_16x16x32_bf16 v[20:23], a[0:3], v[140:143], v[20:23]
    ds_read_b128 a[48:51], v5 offset:49152
    s_waitcnt lgkmcnt(11)
    v_mfma_f32_16x16x32_bf16 v[24:27], a[4:7], v[140:143], v[24:27]
    ds_read_b128 a[52:55], v5 offset:50176
    s_waitcnt lgkmcnt(11)
    v_mfma_f32_16x16x32_bf16 v[28:31], a[8:11], v[140:143], v[28:31]
    ds_read_b128 a[56:59], v5 offset:51200
    s_waitcnt lgkmcnt(11)
    v_mfma_f32_16x16x32_bf16 v[32:35], a[12:15], v[140:143], v[32:35]
    ds_read_b128 a[60:63], v5 offset:52224
    s_waitcnt vmcnt(3) lgkmcnt(11)
    v_mfma_f32_16x16x32_bf16 v[16:19], a[16:19], v[144:147], v[16:19]
    ds_read_b128 v[160:163], v5 offset:53248
    s_waitcnt lgkmcnt(11)
    v_mfma_f32_16x16x32_bf16 v[20:23], a[20:23], v[144:147], v[20:23]
    ds_read_b128 v[164:167], v5 offset:54272
    s_waitcnt lgkmcnt(11)
    v_mfma_f32_16x16x32_bf16 v[24:27], a[24:27], v[144:147], v[24:27]
    ds_read_b128 v[168:171], v5 offset:55296
    s_waitcnt lgkmcnt(11)
    v_mfma_f32_16x16x32_bf16 v[28:31], a[28:31], v[144:147], v[28:31]
    ds_read_b128 v[172:175], v5 offset:56320
    s_waitcnt lgkmcnt(11)
    v_mfma_f32_16x16x32_bf16 v[32:35], a[32:35], v[144:147], v[32:35]
    ds_read_b128 v[176:179], v5 offset:57344
    s_waitcnt vmcnt(2) lgkmcnt(11)
    v_mfma_f32_16x16x32_bf16 v[16:19], a[36:39], v[148:151], v[16:19]
    ds_read_b128 v[180:183], v5 offset:58368
    s_waitcnt lgkmcnt(11)
    v_mfma_f32_16x16x32_bf16 v[20:23], a[40:43], v[148:151], v[20:23]
    ds_read_b128 v[184:187], v5 offset:59392
    s_waitcnt lgkmcnt(11)
    v_mfma_f32_16x16x32_bf16 v[24:27], a[44:47], v[148:151], v[24:27]
    ds_read_b128 v[188:191], v5 offset:60416
    s_waitcnt lgkmcnt(11)
    v_mfma_f32_16x16x32_bf16 v[28:31], a[48:51], v[148:151], v[28:31]
    s_waitcnt lgkmcnt(10)
    v_mfma_f32_16x16x32_bf16 v[32:35], a[52:55], v[148:151], v[32:35]
    s_waitcnt vmcnt(1) lgkmcnt(9)
    v_mfma_f32_16x16x32_bf16 v[16:19], a[56:59], v[152:155], v[16:19]
    s_waitcnt lgkmcnt(8)
    v_mfma_f32_16x16x32_bf16 v[20:23], a[60:63], v[152:155], v[20:23]
    s_waitcnt lgkmcnt(7)
    v_mfma_f32_16x16x32_bf16 v[24:27], v[160:163], v[152:155], v[24:27]
    s_waitcnt lgkmcnt(6)
    v_mfma_f32_16x16x32_bf16 v[28:31], v[164:167], v[152:155], v[28:31]
    s_waitcnt lgkmcnt(5)
    v_mfma_f32_16x16x32_bf16 v[32:35], v[168:171], v[152:155], v[32:35]
    s_waitcnt vmcnt(0) lgkmcnt(4)
    v_mfma_f32_16x16x32_bf16 v[16:19], v[172:175], v[156:159], v[16:19]
    s_waitcnt lgkmcnt(3)
    v_mfma_f32_16x16x32_bf16 v[20:23], v[176:179], v[156:159], v[20:23]
    s_waitcnt lgkmcnt(2)
    v_mfma_f32_16x16x32_bf16 v[24:27], v[180:183], v[156:159], v[24:27]
    s_waitcnt lgkmcnt(1)
    v_mfma_f32_16x16x32_bf16 v[28:31], v[184:187], v[156:159], v[28:31]
    s_waitcnt lgkmcnt(0)
    v_mfma_f32_16x16x32_bf16 v[32:35], v[188:191], v[156:159], v[32:35]
    v_cvt_pk_bf16_f32 v36, v16, v17
    v_cvt_pk_bf16_f32 v37, v18, v19
    buffer_store_dwordx2 v[36:37], v6, s[40:43], s86 offen offset:0
    v_cvt_pk_bf16_f32 v38, v20, v21
    v_cvt_pk_bf16_f32 v39, v22, v23
    buffer_store_dwordx2 v[38:39], v6, s[40:43], s86 offen offset:32
    v_cvt_pk_bf16_f32 v40, v24, v25
    v_cvt_pk_bf16_f32 v41, v26, v27
    buffer_store_dwordx2 v[40:41], v6, s[40:43], s86 offen offset:64
    v_cvt_pk_bf16_f32 v42, v28, v29
    v_cvt_pk_bf16_f32 v43, v30, v31
    buffer_store_dwordx2 v[42:43], v6, s[40:43], s86 offen offset:96
    v_cvt_pk_bf16_f32 v44, v32, v33
    v_cvt_pk_bf16_f32 v45, v34, v35
    buffer_store_dwordx2 v[44:45], v6, s[40:43], s86 offen offset:128
    s_or_b32 s72, s53, s52
    s_or_b32 s72, s72, s54
    s_cmp_lg_u32 s72, 0
    s_cbranch_scc1 skip_28
    v_mov_b32 v10, s96
    v_mov_b32 v11, 0
    s_mov_b64 exec, 1
    buffer_store_dword v10, v11, s[44:47], 0 offen
    s_mov_b64 exec, -1
skip_28:
END:
    s_endpgm
XPROG:
    s_nop 4
    s_mov_b64 s[94:95], s[48:49]
    s_mul_i32 s86, s52, 4608
    s_add_u32 s86, s86, 145408
    s_lshl_b32 s87, s70, 6
    s_add_u32 s87, s87, s69
    s_lshl_b32 s72, s87, 2
    s_add_u32 s72, s72, s52
    s_mul_i32 s73, s72, 3277
    s_lshr_b32 s73, s73, 16
    s_mul_i32 s74, s73, 20
    s_sub_u32 s74, s72, s74
    s_mul_i32 s84, s73, 40
    s_add_u32 s84, s84, s74
    s_lshl_b32 s84, s84, 10
    s_add_u32 s84, s84, 12582912
    s_lshl_b32 s75, s74, 5
    s_sub_u32 s76, 960, s75
    s_cmp_ge_u32 s74, 10
    s_cselect_b32 s75, s76, s75
    s_cselect_b32 s76, -1, 1
    v_lshrrev_b32_e64 v10, 2, v1
    v_mul_lo_u32 v11, v10, s76
    v_add_u32 v11, s75, v11
    s_lshl_b32 s76, s76, 4
    v_add_u32_e64 v12, s76, v11
    v_cmp_eq_u32 vcc, 640, v11
    v_mov_b32 v13, 320
    s_nop 0
    v_cndmask_b32 v11, v11, v13, vcc
    v_and_b32 v13, 3, v1
    v_lshlrev_b32 v13, 4, v13
    s_lshl_b32 s73, s73, 6
    s_movk_i32 s77, 3072
    v_mad_u32_u24 v4, v11, s77, v13
    v_mad_u32_u24 v5, v12, s77, v13
    v_add_u32 v4, s73, v4
    v_add_u32_e64 v5, s73, v5
    s_lshl_b32 s72, s87, 1
    s_and_b32 s73, s52, 1
    s_add_u32 s72, s72, s73
    s_mul_i32 s73, s72, 2731
    s_lshr_b32 s73, s73, 16
    s_mul_i32 s74, s73, 24
    s_sub_u32 s74, s72, s74
    s_lshl_b32 s75, s73, 1
    s_add_u32 s75, s75, 0
    s_mul_i32 s76, s75, 52
    s_lshr_b32 s76, s76, 8
    s_mul_i32 s76, s76, 115
    s_add_u32 s75, s75, s76
    s_mul_i32 s76, s74, 5
    s_add_u32 s75, s75, s76
    s_lshl_b32 s85, s75, 10
    s_add_u32 s85, s85, 14680064
    s_lshl_b32 s75, s73, 1
    s_add_u32 s75, s75, 1
    s_mul_i32 s76, s75, 52
    s_lshr_b32 s76, s76, 8
    s_mul_i32 s76, s76, 115
    s_add_u32 s75, s75, s76
    s_mul_i32 s76, s74, 5
    s_add_u32 s75, s75, s76
    s_lshl_b32 s83, s75, 10
    s_add_u32 s83, s83, 14680064
    s_mul_i32 s74, s74, 40960
    s_lshl_b32 s73, s73, 6
    s_add_u32 s74, s74, s73
    v_mul_u32_u24 v6, 1280, v10
    v_add3_u32 v6, v6, v13, s74
    v_add_u32 v7, 20480, v6
    s_cmp_ge_u32 s87, 240
    s_cselect_b32 s72, 0x40000000, 0
    s_cmp_lt_u32 s52, 2
    s_cselect_b32 s73, 0x40000000, s72
    s_add_u32 s84, s84, s72
    s_add_u32 s85, s85, s73
    s_add_u32 s83, s83, s73
    s_waitcnt lgkmcnt(0)
    s_load_dword s96, s[44:45], 0
    s_getreg_b32 s99, hwreg(HW_REG_XCC_ID, 0, 4)
    s_mov_b64 s[4:5], s[94:95]
    s_mov_b32 s6, CODE_BYTES
    s_mov_b32 s81, s72
    s_mov_b32 s82, s73
    s_add_u32 m0, s86, 0
    s_nop 0
    buffer_load_dwordx4 v4, s[24:27], s81 offen lds
    s_add_u32 m0, s86, 1024
    s_nop 0
    buffer_load_dwordx4 v5, s[24:27], s81 offen lds
    s_add_u32 m0, s86, 2048
    s_nop 0
    buffer_load_dwordx4 v6, s[36:39], s82 offen lds
    s_add_u32 m0, s86, 3072
    s_nop 0
    buffer_load_dwordx4 v7, s[36:39], s82 offen lds
    s_mul_i32 s72, s70, 80
    s_lshl_b32 s73, s52, 4
    s_add_u32 s73, s73, s72
    v_and_b32 v8, 15, v1
    v_add_u32 v9, s73, v8
    v_cmp_eq_u32 vcc, 0, v9
    v_mov_b32 v10, 320
    s_nop 0
    v_cndmask_b32 v9, v9, v10, vcc
    v_cvt_f32_u32 v9, v9
    s_add_u32 s72, s72, 64
    v_add_u32 v8, s72, v8
    v_cvt_f32_u32_e64 v8, v8
    s_setprio 1
    v_mul_f32 v168, 0x3acccccd, v9
    v_lshrrev_b32 v169, 4, v1
    v_lshlrev_b32 v169, 3, v169
    v_cvt_f32_u32 v169, v169
    v_mul_f32 v169, v169, v168
    v_cos_f32 v170, v168
    v_sin_f32 v172, v168
    v_sin_f32_e64 v173, -v168
    v_add_f32 v174, v170, v170
    v_mov_b32 v138, v169
    v_fmamk_f32 v154, v168, 0x42000000, v169
    v_cos_f32_e64 v136, v138
    v_sin_f32_e64 v137, -v138
    v_cos_f32_e64 v152, v154
    v_sin_f32_e64 v153, -v154
    v_pk_mul_f32 v[138:139], v[136:137], v[170:171] op_sel_hi:[1,0]
    v_pk_mul_f32 v[154:155], v[152:153], v[170:171] op_sel_hi:[1,0]
    v_pk_fma_f32 v[138:139], v[136:137], v[172:173], v[138:139] op_sel:[1,0,0] op_sel_hi:[0,1,1]
    v_pk_fma_f32 v[154:155], v[152:153], v[172:173], v[154:155] op_sel:[1,0,0] op_sel_hi:[0,1,1]
    v_pk_fma_f32 v[140:141], v[174:175], v[138:139], v[136:137] op_sel_hi:[0,1,1] neg_lo:[0,0,1] neg_hi:[0,0,1]
    v_pk_fma_f32 v[156:157], v[174:175], v[154:155], v[152:153] op_sel_hi:[0,1,1] neg_lo:[0,0,1] neg_hi:[0,0,1]
    v_pk_fma_f32 v[142:143], v[174:175], v[140:141], v[138:139] op_sel_hi:[0,1,1] neg_lo:[0,0,1] neg_hi:[0,0,1]
    v_pk_fma_f32 v[158:159], v[174:175], v[156:157], v[154:155] op_sel_hi:[0,1,1] neg_lo:[0,0,1] neg_hi:[0,0,1]
    v_pk_fma_f32 v[144:145], v[174:175], v[142:143], v[140:141] op_sel_hi:[0,1,1] neg_lo:[0,0,1] neg_hi:[0,0,1]
    v_pk_fma_f32 v[160:161], v[174:175], v[158:159], v[156:157] op_sel_hi:[0,1,1] neg_lo:[0,0,1] neg_hi:[0,0,1]
    v_pk_fma_f32 v[146:147], v[174:175], v[144:145], v[142:143] op_sel_hi:[0,1,1] neg_lo:[0,0,1] neg_hi:[0,0,1]
    v_pk_fma_f32 v[162:163], v[174:175], v[160:161], v[158:159] op_sel_hi:[0,1,1] neg_lo:[0,0,1] neg_hi:[0,0,1]
    v_pk_fma_f32 v[148:149], v[174:175], v[146:147], v[144:145] op_sel_hi:[0,1,1] neg_lo:[0,0,1] neg_hi:[0,0,1]
    v_pk_fma_f32 v[164:165], v[174:175], v[162:163], v[160:161] op_sel_hi:[0,1,1] neg_lo:[0,0,1] neg_hi:[0,0,1]
    v_pk_fma_f32 v[150:151], v[174:175], v[148:149], v[146:147] op_sel_hi:[0,1,1] neg_lo:[0,0,1] neg_hi:[0,0,1]
    v_pk_fma_f32 v[166:167], v[174:175], v[164:165], v[162:163] op_sel_hi:[0,1,1] neg_lo:[0,0,1] neg_hi:[0,0,1]
    v_cvt_pk_bf16_f32 v16, v136, v138
    v_cvt_pk_bf16_f32 v56, v137, v139
    v_cvt_pk_bf16_f32 v17, v140, v142
    v_cvt_pk_bf16_f32 v57, v141, v143
    v_cvt_pk_bf16_f32 v18, v144, v146
    v_cvt_pk_bf16_f32 v58, v145, v147
    v_cvt_pk_bf16_f32 v19, v148, v150
    v_cvt_pk_bf16_f32 v59, v149, v151
    v_cvt_pk_bf16_f32 v20, v152, v154
    v_cvt_pk_bf16_f32 v60, v153, v155
    v_cvt_pk_bf16_f32 v21, v156, v158
    v_cvt_pk_bf16_f32 v61, v157, v159
    v_cvt_pk_bf16_f32 v22, v160, v162
    v_cvt_pk_bf16_f32 v62, v161, v163
    v_cvt_pk_bf16_f32 v23, v164, v166
    v_cvt_pk_bf16_f32 v63, v165, v167
    v_fmamk_f32 v138, v168, 0x42800000, v169
    v_fmamk_f32 v154, v168, 0x42c00000, v169
    v_cos_f32_e64 v136, v138
    v_sin_f32_e64 v137, -v138
    v_cos_f32_e64 v152, v154
    v_sin_f32_e64 v153, -v154
    v_pk_mul_f32 v[138:139], v[136:137], v[170:171] op_sel_hi:[1,0]
    v_pk_mul_f32 v[154:155], v[152:153], v[170:171] op_sel_hi:[1,0]
    v_pk_fma_f32 v[138:139], v[136:137], v[172:173], v[138:139] op_sel:[1,0,0] op_sel_hi:[0,1,1]
    v_pk_fma_f32 v[154:155], v[152:153], v[172:173], v[154:155] op_sel:[1,0,0] op_sel_hi:[0,1,1]
    v_pk_fma_f32 v[140:141], v[174:175], v[138:139], v[136:137] op_sel_hi:[0,1,1] neg_lo:[0,0,1] neg_hi:[0,0,1]
    v_pk_fma_f32 v[156:157], v[174:175], v[154:155], v[152:153] op_sel_hi:[0,1,1] neg_lo:[0,0,1] neg_hi:[0,0,1]
    v_pk_fma_f32 v[142:143], v[174:175], v[140:141], v[138:139] op_sel_hi:[0,1,1] neg_lo:[0,0,1] neg_hi:[0,0,1]
    v_pk_fma_f32 v[158:159], v[174:175], v[156:157], v[154:155] op_sel_hi:[0,1,1] neg_lo:[0,0,1] neg_hi:[0,0,1]
    v_pk_fma_f32 v[144:145], v[174:175], v[142:143], v[140:141] op_sel_hi:[0,1,1] neg_lo:[0,0,1] neg_hi:[0,0,1]
    v_pk_fma_f32 v[160:161], v[174:175], v[158:159], v[156:157] op_sel_hi:[0,1,1] neg_lo:[0,0,1] neg_hi:[0,0,1]
    v_pk_fma_f32 v[146:147], v[174:175], v[144:145], v[142:143] op_sel_hi:[0,1,1] neg_lo:[0,0,1] neg_hi:[0,0,1]
    v_pk_fma_f32 v[162:163], v[174:175], v[160:161], v[158:159] op_sel_hi:[0,1,1] neg_lo:[0,0,1] neg_hi:[0,0,1]
    v_pk_fma_f32 v[148:149], v[174:175], v[146:147], v[144:145] op_sel_hi:[0,1,1] neg_lo:[0,0,1] neg_hi:[0,0,1]
    v_pk_fma_f32 v[164:165], v[174:175], v[162:163], v[160:161] op_sel_hi:[0,1,1] neg_lo:[0,0,1] neg_hi:[0,0,1]
    v_pk_fma_f32 v[150:151], v[174:175], v[148:149], v[146:147] op_sel_hi:[0,1,1] neg_lo:[0,0,1] neg_hi:[0,0,1]
    v_pk_fma_f32 v[166:167], v[174:175], v[164:165], v[162:163] op_sel_hi:[0,1,1] neg_lo:[0,0,1] neg_hi:[0,0,1]
    v_cvt_pk_bf16_f32 v24, v136, v138
    v_cvt_pk_bf16_f32 v64, v137, v139
    v_cvt_pk_bf16_f32 v25, v140, v142
    v_cvt_pk_bf16_f32 v65, v141, v143
    v_cvt_pk_bf16_f32 v26, v144, v146
    v_cvt_pk_bf16_f32 v66, v145, v147
    v_cvt_pk_bf16_f32 v27, v148, v150
    v_cvt_pk_bf16_f32 v67, v149, v151
    v_cvt_pk_bf16_f32 v28, v152, v154
    v_cvt_pk_bf16_f32 v68, v153, v155
    v_cvt_pk_bf16_f32 v29, v156, v158
    v_cvt_pk_bf16_f32 v69, v157, v159
    v_cvt_pk_bf16_f32 v30, v160, v162
    v_cvt_pk_bf16_f32 v70, v161, v163
    v_cvt_pk_bf16_f32 v31, v164, v166
    v_cvt_pk_bf16_f32 v71, v165, v167
    v_fmamk_f32 v138, v168, 0x43000000, v169
    v_fmamk_f32 v154, v168, 0x43200000, v169
    v_cos_f32_e64 v136, v138
    v_sin_f32_e64 v137, -v138
    v_cos_f32_e64 v152, v154
    v_sin_f32_e64 v153, -v154
    v_pk_mul_f32 v[138:139], v[136:137], v[170:171] op_sel_hi:[1,0]
    v_pk_mul_f32 v[154:155], v[152:153], v[170:171] op_sel_hi:[1,0]
    v_pk_fma_f32 v[138:139], v[136:137], v[172:173], v[138:139] op_sel:[1,0,0] op_sel_hi:[0,1,1]
    v_pk_fma_f32 v[154:155], v[152:153], v[172:173], v[154:155] op_sel:[1,0,0] op_sel_hi:[0,1,1]
    v_pk_fma_f32 v[140:141], v[174:175], v[138:139], v[136:137] op_sel_hi:[0,1,1] neg_lo:[0,0,1] neg_hi:[0,0,1]
    v_pk_fma_f32 v[156:157], v[174:175], v[154:155], v[152:153] op_sel_hi:[0,1,1] neg_lo:[0,0,1] neg_hi:[0,0,1]
    v_pk_fma_f32 v[142:143], v[174:175], v[140:141], v[138:139] op_sel_hi:[0,1,1] neg_lo:[0,0,1] neg_hi:[0,0,1]
    v_pk_fma_f32 v[158:159], v[174:175], v[156:157], v[154:155] op_sel_hi:[0,1,1] neg_lo:[0,0,1] neg_hi:[0,0,1]
    v_pk_fma_f32 v[144:145], v[174:175], v[142:143], v[140:141] op_sel_hi:[0,1,1] neg_lo:[0,0,1] neg_hi:[0,0,1]
    v_pk_fma_f32 v[160:161], v[174:175], v[158:159], v[156:157] op_sel_hi:[0,1,1] neg_lo:[0,0,1] neg_hi:[0,0,1]
    v_pk_fma_f32 v[146:147], v[174:175], v[144:145], v[142:143] op_sel_hi:[0,1,1] neg_lo:[0,0,1] neg_hi:[0,0,1]
    v_pk_fma_f32 v[162:163], v[174:175], v[160:161], v[158:159] op_sel_hi:[0,1,1] neg_lo:[0,0,1] neg_hi:[0,0,1]
    v_pk_fma_f32 v[148:149], v[174:175], v[146:147], v[144:145] op_sel_hi:[0,1,1] neg_lo:[0,0,1] neg_hi:[0,0,1]
    v_pk_fma_f32 v[164:165], v[174:175], v[162:163], v[160:161] op_sel_hi:[0,1,1] neg_lo:[0,0,1] neg_hi:[0,0,1]
    v_pk_fma_f32 v[150:151], v[174:175], v[148:149], v[146:147] op_sel_hi:[0,1,1] neg_lo:[0,0,1] neg_hi:[0,0,1]
    v_pk_fma_f32 v[166:167], v[174:175], v[164:165], v[162:163] op_sel_hi:[0,1,1] neg_lo:[0,0,1] neg_hi:[0,0,1]
    v_cvt_pk_bf16_f32 v32, v136, v138
    v_cvt_pk_bf16_f32 v72, v137, v139
    v_cvt_pk_bf16_f32 v33, v140, v142
    v_cvt_pk_bf16_f32 v73, v141, v143
    v_cvt_pk_bf16_f32 v34, v144, v146
    v_cvt_pk_bf16_f32 v74, v145, v147
    v_cvt_pk_bf16_f32 v35, v148, v150
    v_cvt_pk_bf16_f32 v75, v149, v151
    v_cvt_pk_bf16_f32 v36, v152, v154
    v_cvt_pk_bf16_f32 v76, v153, v155
    v_cvt_pk_bf16_f32 v37, v156, v158
    v_cvt_pk_bf16_f32 v77, v157, v159
    v_cvt_pk_bf16_f32 v38, v160, v162
    v_cvt_pk_bf16_f32 v78, v161, v163
    v_cvt_pk_bf16_f32 v39, v164, v166
    v_cvt_pk_bf16_f32 v79, v165, v167
    v_fmamk_f32 v138, v168, 0x43400000, v169
    v_fmamk_f32 v154, v168, 0x43600000, v169
    v_cos_f32_e64 v136, v138
    v_sin_f32_e64 v137, -v138
    v_cos_f32_e64 v152, v154
    v_sin_f32_e64 v153, -v154
    v_pk_mul_f32 v[138:139], v[136:137], v[170:171] op_sel_hi:[1,0]
    v_pk_mul_f32 v[154:155], v[152:153], v[170:171] op_sel_hi:[1,0]
    v_pk_fma_f32 v[138:139], v[136:137], v[172:173], v[138:139] op_sel:[1,0,0] op_sel_hi:[0,1,1]
    v_pk_fma_f32 v[154:155], v[152:153], v[172:173], v[154:155] op_sel:[1,0,0] op_sel_hi:[0,1,1]
    v_pk_fma_f32 v[140:141], v[174:175], v[138:139], v[136:137] op_sel_hi:[0,1,1] neg_lo:[0,0,1] neg_hi:[0,0,1]
    v_pk_fma_f32 v[156:157], v[174:175], v[154:155], v[152:153] op_sel_hi:[0,1,1] neg_lo:[0,0,1] neg_hi:[0,0,1]
    v_pk_fma_f32 v[142:143], v[174:175], v[140:141], v[138:139] op_sel_hi:[0,1,1] neg_lo:[0,0,1] neg_hi:[0,0,1]
    v_pk_fma_f32 v[158:159], v[174:175], v[156:157], v[154:155] op_sel_hi:[0,1,1] neg_lo:[0,0,1] neg_hi:[0,0,1]
    v_pk_fma_f32 v[144:145], v[174:175], v[142:143], v[140:141] op_sel_hi:[0,1,1] neg_lo:[0,0,1] neg_hi:[0,0,1]
    v_pk_fma_f32 v[160:161], v[174:175], v[158:159], v[156:157] op_sel_hi:[0,1,1] neg_lo:[0,0,1] neg_hi:[0,0,1]
    v_pk_fma_f32 v[146:147], v[174:175], v[144:145], v[142:143] op_sel_hi:[0,1,1] neg_lo:[0,0,1] neg_hi:[0,0,1]
    v_pk_fma_f32 v[162:163], v[174:175], v[160:161], v[158:159] op_sel_hi:[0,1,1] neg_lo:[0,0,1] neg_hi:[0,0,1]
    v_pk_fma_f32 v[148:149], v[174:175], v[146:147], v[144:145] op_sel_hi:[0,1,1] neg_lo:[0,0,1] neg_hi:[0,0,1]
    v_pk_fma_f32 v[164:165], v[174:175], v[162:163], v[160:161] op_sel_hi:[0,1,1] neg_lo:[0,0,1] neg_hi:[0,0,1]
    v_pk_fma_f32 v[150:151], v[174:175], v[148:149], v[146:147] op_sel_hi:[0,1,1] neg_lo:[0,0,1] neg_hi:[0,0,1]
    v_pk_fma_f32 v[166:167], v[174:175], v[164:165], v[162:163] op_sel_hi:[0,1,1] neg_lo:[0,0,1] neg_hi:[0,0,1]
    v_cvt_pk_bf16_f32 v40, v136, v138
    v_cvt_pk_bf16_f32 v80, v137, v139
    v_cvt_pk_bf16_f32 v41, v140, v142
    v_cvt_pk_bf16_f32 v81, v141, v143
    v_cvt_pk_bf16_f32 v42, v144, v146
    v_cvt_pk_bf16_f32 v82, v145, v147
    v_cvt_pk_bf16_f32 v43, v148, v150
    v_cvt_pk_bf16_f32 v83, v149, v151
    v_cvt_pk_bf16_f32 v44, v152, v154
    v_cvt_pk_bf16_f32 v84, v153, v155
    v_cvt_pk_bf16_f32 v45, v156, v158
    v_cvt_pk_bf16_f32 v85, v157, v159
    v_cvt_pk_bf16_f32 v46, v160, v162
    v_cvt_pk_bf16_f32 v86, v161, v163
    v_cvt_pk_bf16_f32 v47, v164, v166
    v_cvt_pk_bf16_f32 v87, v165, v167
    v_fmamk_f32 v138, v168, 0x43800000, v169
    v_fmamk_f32 v154, v168, 0x43900000, v169
    v_cos_f32_e64 v136, v138
    v_sin_f32_e64 v137, -v138
    v_cos_f32_e64 v152, v154
    v_sin_f32_e64 v153, -v154
    v_pk_mul_f32 v[138:139], v[136:137], v[170:171] op_sel_hi:[1,0]
    v_pk_mul_f32 v[154:155], v[152:153], v[170:171] op_sel_hi:[1,0]
    v_pk_fma_f32 v[138:139], v[136:137], v[172:173], v[138:139] op_sel:[1,0,0] op_sel_hi:[0,1,1]
    v_pk_fma_f32 v[154:155], v[152:153], v[172:173], v[154:155] op_sel:[1,0,0] op_sel_hi:[0,1,1]
    v_pk_fma_f32 v[140:141], v[174:175], v[138:139], v[136:137] op_sel_hi:[0,1,1] neg_lo:[0,0,1] neg_hi:[0,0,1]
    v_pk_fma_f32 v[156:157], v[174:175], v[154:155], v[152:153] op_sel_hi:[0,1,1] neg_lo:[0,0,1] neg_hi:[0,0,1]
    v_pk_fma_f32 v[142:143], v[174:175], v[140:141], v[138:139] op_sel_hi:[0,1,1] neg_lo:[0,0,1] neg_hi:[0,0,1]
    v_pk_fma_f32 v[158:159], v[174:175], v[156:157], v[154:155] op_sel_hi:[0,1,1] neg_lo:[0,0,1] neg_hi:[0,0,1]
    v_pk_fma_f32 v[144:145], v[174:175], v[142:143], v[140:141] op_sel_hi:[0,1,1] neg_lo:[0,0,1] neg_hi:[0,0,1]
    v_pk_fma_f32 v[160:161], v[174:175], v[158:159], v[156:157] op_sel_hi:[0,1,1] neg_lo:[0,0,1] neg_hi:[0,0,1]
    v_pk_fma_f32 v[146:147], v[174:175], v[144:145], v[142:143] op_sel_hi:[0,1,1] neg_lo:[0,0,1] neg_hi:[0,0,1]
    v_pk_fma_f32 v[162:163], v[174:175], v[160:161], v[158:159] op_sel_hi:[0,1,1] neg_lo:[0,0,1] neg_hi:[0,0,1]
    v_pk_fma_f32 v[148:149], v[174:175], v[146:147], v[144:145] op_sel_hi:[0,1,1] neg_lo:[0,0,1] neg_hi:[0,0,1]
    v_pk_fma_f32 v[164:165], v[174:175], v[162:163], v[160:161] op_sel_hi:[0,1,1] neg_lo:[0,0,1] neg_hi:[0,0,1]
    v_pk_fma_f32 v[150:151], v[174:175], v[148:149], v[146:147] op_sel_hi:[0,1,1] neg_lo:[0,0,1] neg_hi:[0,0,1]
    v_pk_fma_f32 v[166:167], v[174:175], v[164:165], v[162:163] op_sel_hi:[0,1,1] neg_lo:[0,0,1] neg_hi:[0,0,1]
    v_cvt_pk_bf16_f32 v48, v136, v138
    v_cvt_pk_bf16_f32 v88, v137, v139
    v_cvt_pk_bf16_f32 v49, v140, v142
    v_cvt_pk_bf16_f32 v89, v141, v143
    v_cvt_pk_bf16_f32 v50, v144, v146
    v_cvt_pk_bf16_f32 v90, v145, v147
    v_cvt_pk_bf16_f32 v51, v148, v150
    v_cvt_pk_bf16_f32 v91, v149, v151
    v_cvt_pk_bf16_f32 v52, v152, v154
    v_cvt_pk_bf16_f32 v92, v153, v155
    v_cvt_pk_bf16_f32 v53, v156, v158
    v_cvt_pk_bf16_f32 v93, v157, v159
    v_cvt_pk_bf16_f32 v54, v160, v162
    v_cvt_pk_bf16_f32 v94, v161, v163
    v_cvt_pk_bf16_f32 v55, v164, v166
    v_cvt_pk_bf16_f32 v95, v165, v167
    s_cmp_lg_u32 s52, 0
    s_cbranch_scc1 skip_5001
    v_mul_f32 v168, 0x3acccccd, v8
    v_lshrrev_b32 v169, 4, v1
    v_lshlrev_b32 v169, 3, v169
    v_cvt_f32_u32 v169, v169
    v_mul_f32 v169, v169, v168
    v_cos_f32 v170, v168
    v_sin_f32 v172, v168
    v_sin_f32_e64 v173, -v168
    v_add_f32 v174, v170, v170
    v_mov_b32 v138, v169
    v_fmamk_f32 v154, v168, 0x42000000, v169
    v_cos_f32_e64 v136, v138
    v_sin_f32_e64 v137, -v138
    v_cos_f32_e64 v152, v154
    v_sin_f32_e64 v153, -v154
    v_pk_mul_f32 v[138:139], v[136:137], v[170:171] op_sel_hi:[1,0]
    v_pk_mul_f32 v[154:155], v[152:153], v[170:171] op_sel_hi:[1,0]
    v_pk_fma_f32 v[138:139], v[136:137], v[172:173], v[138:139] op_sel:[1,0,0] op_sel_hi:[0,1,1]
    v_pk_fma_f32 v[154:155], v[152:153], v[172:173], v[154:155] op_sel:[1,0,0] op_sel_hi:[0,1,1]
    v_pk_fma_f32 v[140:141], v[174:175], v[138:139], v[136:137] op_sel_hi:[0,1,1] neg_lo:[0,0,1] neg_hi:[0,0,1]
    v_pk_fma_f32 v[156:157], v[174:175], v[154:155], v[152:153] op_sel_hi:[0,1,1] neg_lo:[0,0,1] neg_hi:[0,0,1]
    v_pk_fma_f32 v[142:143], v[174:175], v[140:141], v[138:139] op_sel_hi:[0,1,1] neg_lo:[0,0,1] neg_hi:[0,0,1]
    v_pk_fma_f32 v[158:159], v[174:175], v[156:157], v[154:155] op_sel_hi:[0,1,1] neg_lo:[0,0,1] neg_hi:[0,0,1]
    v_pk_fma_f32 v[144:145], v[174:175], v[142:143], v[140:141] op_sel_hi:[0,1,1] neg_lo:[0,0,1] neg_hi:[0,0,1]
    v_pk_fma_f32 v[160:161], v[174:175], v[158:159], v[156:157] op_sel_hi:[0,1,1] neg_lo:[0,0,1] neg_hi:[0,0,1]
    v_pk_fma_f32 v[146:147], v[174:175], v[144:145], v[142:143] op_sel_hi:[0,1,1] neg_lo:[0,0,1] neg_hi:[0,0,1]
    v_pk_fma_f32 v[162:163], v[174:175], v[160:161], v[158:159] op_sel_hi:[0,1,1] neg_lo:[0,0,1] neg_hi:[0,0,1]
    v_pk_fma_f32 v[148:149], v[174:175], v[146:147], v[144:145] op_sel_hi:[0,1,1] neg_lo:[0,0,1] neg_hi:[0,0,1]
    v_pk_fma_f32 v[164:165], v[174:175], v[162:163], v[160:161] op_sel_hi:[0,1,1] neg_lo:[0,0,1] neg_hi:[0,0,1]
    v_pk_fma_f32 v[150:151], v[174:175], v[148:149], v[146:147] op_sel_hi:[0,1,1] neg_lo:[0,0,1] neg_hi:[0,0,1]
    v_pk_fma_f32 v[166:167], v[174:175], v[164:165], v[162:163] op_sel_hi:[0,1,1] neg_lo:[0,0,1] neg_hi:[0,0,1]
    v_cvt_pk_bf16_f32 v96, v136, v138
    v_cvt_pk_bf16_f32 v97, v140, v142
    v_cvt_pk_bf16_f32 v98, v144, v146
    v_cvt_pk_bf16_f32 v99, v148, v150
    v_cvt_pk_bf16_f32 v100, v152, v154
    v_cvt_pk_bf16_f32 v101, v156, v158
    v_cvt_pk_bf16_f32 v102, v160, v162
    v_cvt_pk_bf16_f32 v103, v164, v166
    v_fmamk_f32 v138, v168, 0x42800000, v169
    v_fmamk_f32 v154, v168, 0x42c00000, v169
    v_cos_f32_e64 v136, v138
    v_sin_f32_e64 v137, -v138
    v_cos_f32_e64 v152, v154
    v_sin_f32_e64 v153, -v154
    v_pk_mul_f32 v[138:139], v[136:137], v[170:171] op_sel_hi:[1,0]
    v_pk_mul_f32 v[154:155], v[152:153], v[170:171] op_sel_hi:[1,0]
    v_pk_fma_f32 v[138:139], v[136:137], v[172:173], v[138:139] op_sel:[1,0,0] op_sel_hi:[0,1,1]
    v_pk_fma_f32 v[154:155], v[152:153], v[172:173], v[154:155] op_sel:[1,0,0] op_sel_hi:[0,1,1]
    v_pk_fma_f32 v[140:141], v[174:175], v[138:139], v[136:137] op_sel_hi:[0,1,1] neg_lo:[0,0,1] neg_hi:[0,0,1]
    v_pk_fma_f32 v[156:157], v[174:175], v[154:155], v[152:153] op_sel_hi:[0,1,1] neg_lo:[0,0,1] neg_hi:[0,0,1]
    v_pk_fma_f32 v[142:143], v[174:175], v[140:141], v[138:139] op_sel_hi:[0,1,1] neg_lo:[0,0,1] neg_hi:[0,0,1]
    v_pk_fma_f32 v[158:159], v[174:175], v[156:157], v[154:155] op_sel_hi:[0,1,1] neg_lo:[0,0,1] neg_hi:[0,0,1]
    v_pk_fma_f32 v[144:145], v[174:175], v[142:143], v[140:141] op_sel_hi:[0,1,1] neg_lo:[0,0,1] neg_hi:[0,0,1]
    v_pk_fma_f32 v[160:161], v[174:175], v[158:159], v[156:157] op_sel_hi:[0,1,1] neg_lo:[0,0,1] neg_hi:[0,0,1]
    v_pk_fma_f32 v[146:147], v[174:175], v[144:145], v[142:143] op_sel_hi:[0,1,1] neg_lo:[0,0,1] neg_hi:[0,0,1]
    v_pk_fma_f32 v[162:163], v[174:175], v[160:161], v[158:159] op_sel_hi:[0,1,1] neg_lo:[0,0,1] neg_hi:[0,0,1]
    v_pk_fma_f32 v[148:149], v[174:175], v[146:147], v[144:145] op_sel_hi:[0,1,1] neg_lo:[0,0,1] neg_hi:[0,0,1]
    v_pk_fma_f32 v[164:165], v[174:175], v[162:163], v[160:161] op_sel_hi:[0,1,1] neg_lo:[0,0,1] neg_hi:[0,0,1]
    v_pk_fma_f32 v[150:151], v[174:175], v[148:149], v[146:147] op_sel_hi:[0,1,1] neg_lo:[0,0,1] neg_hi:[0,0,1]
    v_pk_fma_f32 v[166:167], v[174:175], v[164:165], v[162:163] op_sel_hi:[0,1,1] neg_lo:[0,0,1] neg_hi:[0,0,1]
    v_cvt_pk_bf16_f32 v104, v136, v138
    v_cvt_pk_bf16_f32 v105, v140, v142
    v_cvt_pk_bf16_f32 v106, v144, v146
    v_cvt_pk_bf16_f32 v107, v148, v150
    v_cvt_pk_bf16_f32 v108, v152, v154
    v_cvt_pk_bf16_f32 v109, v156, v158
    v_cvt_pk_bf16_f32 v110, v160, v162
    v_cvt_pk_bf16_f32 v111, v164, v166
    v_fmamk_f32 v138, v168, 0x43000000, v169
    v_fmamk_f32 v154, v168, 0x43200000, v169
    v_cos_f32_e64 v136, v138
    v_sin_f32_e64 v137, -v138
    v_cos_f32_e64 v152, v154
    v_sin_f32_e64 v153, -v154
    v_pk_mul_f32 v[138:139], v[136:137], v[170:171] op_sel_hi:[1,0]
    v_pk_mul_f32 v[154:155], v[152:153], v[170:171] op_sel_hi:[1,0]
    v_pk_fma_f32 v[138:139], v[136:137], v[172:173], v[138:139] op_sel:[1,0,0] op_sel_hi:[0,1,1]
    v_pk_fma_f32 v[154:155], v[152:153], v[172:173], v[154:155] op_sel:[1,0,0] op_sel_hi:[0,1,1]
    v_pk_fma_f32 v[140:141], v[174:175], v[138:139], v[136:137] op_sel_hi:[0,1,1] neg_lo:[0,0,1] neg_hi:[0,0,1]
    v_pk_fma_f32 v[156:157], v[174:175], v[154:155], v[152:153] op_sel_hi:[0,1,1] neg_lo:[0,0,1] neg_hi:[0,0,1]
    v_pk_fma_f32 v[142:143], v[174:175], v[140:141], v[138:139] op_sel_hi:[0,1,1] neg_lo:[0,0,1] neg_hi:[0,0,1]
    v_pk_fma_f32 v[158:159], v[174:175], v[156:157], v[154:155] op_sel_hi:[0,1,1] neg_lo:[0,0,1] neg_hi:[0,0,1]
    v_pk_fma_f32 v[144:145], v[174:175], v[142:143], v[140:141] op_sel_hi:[0,1,1] neg_lo:[0,0,1] neg_hi:[0,0,1]
    v_pk_fma_f32 v[160:161], v[174:175], v[158:159], v[156:157] op_sel_hi:[0,1,1] neg_lo:[0,0,1] neg_hi:[0,0,1]
    v_pk_fma_f32 v[146:147], v[174:175], v[144:145], v[142:143] op_sel_hi:[0,1,1] neg_lo:[0,0,1] neg_hi:[0,0,1]
    v_pk_fma_f32 v[162:163], v[174:175], v[160:161], v[158:159] op_sel_hi:[0,1,1] neg_lo:[0,0,1] neg_hi:[0,0,1]
    v_pk_fma_f32 v[148:149], v[174:175], v[146:147], v[144:145] op_sel_hi:[0,1,1] neg_lo:[0,0,1] neg_hi:[0,0,1]
    v_pk_fma_f32 v[164:165], v[174:175], v[162:163], v[160:161] op_sel_hi:[0,1,1] neg_lo:[0,0,1] neg_hi:[0,0,1]
    v_pk_fma_f32 v[150:151], v[174:175], v[148:149], v[146:147] op_sel_hi:[0,1,1] neg_lo:[0,0,1] neg_hi:[0,0,1]
    v_pk_fma_f32 v[166:167], v[174:175], v[164:165], v[162:163] op_sel_hi:[0,1,1] neg_lo:[0,0,1] neg_hi:[0,0,1]
    v_cvt_pk_bf16_f32 v112, v136, v138
    v_cvt_pk_bf16_f32 v113, v140, v142
    v_cvt_pk_bf16_f32 v114, v144, v146
    v_cvt_pk_bf16_f32 v115, v148, v150
    v_cvt_pk_bf16_f32 v116, v152, v154
    v_cvt_pk_bf16_f32 v117, v156, v158
    v_cvt_pk_bf16_f32 v118, v160, v162
    v_cvt_pk_bf16_f32 v119, v164, v166
    v_fmamk_f32 v138, v168, 0x43400000, v169
    v_fmamk_f32 v154, v168, 0x43600000, v169
    v_cos_f32_e64 v136, v138
    v_sin_f32_e64 v137, -v138
    v_cos_f32_e64 v152, v154
    v_sin_f32_e64 v153, -v154
    v_pk_mul_f32 v[138:139], v[136:137], v[170:171] op_sel_hi:[1,0]
    v_pk_mul_f32 v[154:155], v[152:153], v[170:171] op_sel_hi:[1,0]
    v_pk_fma_f32 v[138:139], v[136:137], v[172:173], v[138:139] op_sel:[1,0,0] op_sel_hi:[0,1,1]
    v_pk_fma_f32 v[154:155], v[152:153], v[172:173], v[154:155] op_sel:[1,0,0] op_sel_hi:[0,1,1]
    v_pk_fma_f32 v[140:141], v[174:175], v[138:139], v[136:137] op_sel_hi:[0,1,1] neg_lo:[0,0,1] neg_hi:[0,0,1]
    v_pk_fma_f32 v[156:157], v[174:175], v[154:155], v[152:153] op_sel_hi:[0,1,1] neg_lo:[0,0,1] neg_hi:[0,0,1]
    v_pk_fma_f32 v[142:143], v[174:175], v[140:141], v[138:139] op_sel_hi:[0,1,1] neg_lo:[0,0,1] neg_hi:[0,0,1]
    v_pk_fma_f32 v[158:159], v[174:175], v[156:157], v[154:155] op_sel_hi:[0,1,1] neg_lo:[0,0,1] neg_hi:[0,0,1]
    v_pk_fma_f32 v[144:145], v[174:175], v[142:143], v[140:141] op_sel_hi:[0,1,1] neg_lo:[0,0,1] neg_hi:[0,0,1]
    v_pk_fma_f32 v[160:161], v[174:175], v[158:159], v[156:157] op_sel_hi:[0,1,1] neg_lo:[0,0,1] neg_hi:[0,0,1]
    v_pk_fma_f32 v[146:147], v[174:175], v[144:145], v[142:143] op_sel_hi:[0,1,1] neg_lo:[0,0,1] neg_hi:[0,0,1]
    v_pk_fma_f32 v[162:163], v[174:175], v[160:161], v[158:159] op_sel_hi:[0,1,1] neg_lo:[0,0,1] neg_hi:[0,0,1]
    v_pk_fma_f32 v[148:149], v[174:175], v[146:147], v[144:145] op_sel_hi:[0,1,1] neg_lo:[0,0,1] neg_hi:[0,0,1]
    v_pk_fma_f32 v[164:165], v[174:175], v[162:163], v[160:161] op_sel_hi:[0,1,1] neg_lo:[0,0,1] neg_hi:[0,0,1]
    v_pk_fma_f32 v[150:151], v[174:175], v[148:149], v[146:147] op_sel_hi:[0,1,1] neg_lo:[0,0,1] neg_hi:[0,0,1]
    v_pk_fma_f32 v[166:167], v[174:175], v[164:165], v[162:163] op_sel_hi:[0,1,1] neg_lo:[0,0,1] neg_hi:[0,0,1]
    v_cvt_pk_bf16_f32 v120, v136, v138
    v_cvt_pk_bf16_f32 v121, v140, v142
    v_cvt_pk_bf16_f32 v122, v144, v146
    v_cvt_pk_bf16_f32 v123, v148, v150
    v_cvt_pk_bf16_f32 v124, v152, v154
    v_cvt_pk_bf16_f32 v125, v156, v158
    v_cvt_pk_bf16_f32 v126, v160, v162
    v_cvt_pk_bf16_f32 v127, v164, v166
    v_fmamk_f32 v138, v168, 0x43800000, v169
    v_fmamk_f32 v154, v168, 0x43900000, v169
    v_cos_f32_e64 v136, v138
    v_sin_f32_e64 v137, -v138
    v_cos_f32_e64 v152, v154
    v_sin_f32_e64 v153, -v154
    v_pk_mul_f32 v[138:139], v[136:137], v[170:171] op_sel_hi:[1,0]
    v_pk_mul_f32 v[154:155], v[152:153], v[170:171] op_sel_hi:[1,0]
    v_pk_fma_f32 v[138:139], v[136:137], v[172:173], v[138:139] op_sel:[1,0,0] op_sel_hi:[0,1,1]
    v_pk_fma_f32 v[154:155], v[152:153], v[172:173], v[154:155] op_sel:[1,0,0] op_sel_hi:[0,1,1]
    v_pk_fma_f32 v[140:141], v[174:175], v[138:139], v[136:137] op_sel_hi:[0,1,1] neg_lo:[0,0,1] neg_hi:[0,0,1]
    v_pk_fma_f32 v[156:157], v[174:175], v[154:155], v[152:153] op_sel_hi:[0,1,1] neg_lo:[0,0,1] neg_hi:[0,0,1]
    v_pk_fma_f32 v[142:143], v[174:175], v[140:141], v[138:139] op_sel_hi:[0,1,1] neg_lo:[0,0,1] neg_hi:[0,0,1]
    v_pk_fma_f32 v[158:159], v[174:175], v[156:157], v[154:155] op_sel_hi:[0,1,1] neg_lo:[0,0,1] neg_hi:[0,0,1]
    v_pk_fma_f32 v[144:145], v[174:175], v[142:143], v[140:141] op_sel_hi:[0,1,1] neg_lo:[0,0,1] neg_hi:[0,0,1]
    v_pk_fma_f32 v[160:161], v[174:175], v[158:159], v[156:157] op_sel_hi:[0,1,1] neg_lo:[0,0,1] neg_hi:[0,0,1]
    v_pk_fma_f32 v[146:147], v[174:175], v[144:145], v[142:143] op_sel_hi:[0,1,1] neg_lo:[0,0,1] neg_hi:[0,0,1]
    v_pk_fma_f32 v[162:163], v[174:175], v[160:161], v[158:159] op_sel_hi:[0,1,1] neg_lo:[0,0,1] neg_hi:[0,0,1]
    v_pk_fma_f32 v[148:149], v[174:175], v[146:147], v[144:145] op_sel_hi:[0,1,1] neg_lo:[0,0,1] neg_hi:[0,0,1]
    v_pk_fma_f32 v[164:165], v[174:175], v[162:163], v[160:161] op_sel_hi:[0,1,1] neg_lo:[0,0,1] neg_hi:[0,0,1]
    v_pk_fma_f32 v[150:151], v[174:175], v[148:149], v[146:147] op_sel_hi:[0,1,1] neg_lo:[0,0,1] neg_hi:[0,0,1]
    v_pk_fma_f32 v[166:167], v[174:175], v[164:165], v[162:163] op_sel_hi:[0,1,1] neg_lo:[0,0,1] neg_hi:[0,0,1]
    v_cvt_pk_bf16_f32 v128, v136, v138
    v_cvt_pk_bf16_f32 v129, v140, v142
    v_cvt_pk_bf16_f32 v130, v144, v146
    v_cvt_pk_bf16_f32 v131, v148, v150
    v_cvt_pk_bf16_f32 v132, v152, v154
    v_cvt_pk_bf16_f32 v133, v156, v158
    v_cvt_pk_bf16_f32 v134, v160, v162
    v_cvt_pk_bf16_f32 v135, v164, v166
skip_5001:
    s_cmp_lg_u32 s52, 1
    s_cbranch_scc1 skip_5002
    v_mul_f32 v168, 0x3acccccd, v8
    v_lshrrev_b32 v169, 4, v1
    v_lshlrev_b32 v169, 3, v169
    v_cvt_f32_u32 v169, v169
    v_mul_f32 v169, v169, v168
    v_cos_f32 v170, v168
    v_sin_f32 v172, v168
    v_sin_f32_e64 v173, -v168
    v_add_f32 v174, v170, v170
    v_mov_b32 v138, v169
    v_fmamk_f32 v154, v168, 0x42000000, v169
    v_cos_f32_e64 v136, v138
    v_sin_f32_e64 v137, -v138
    v_cos_f32_e64 v152, v154
    v_sin_f32_e64 v153, -v154
    v_pk_mul_f32 v[138:139], v[136:137], v[170:171] op_sel_hi:[1,0]
    v_pk_mul_f32 v[154:155], v[152:153], v[170:171] op_sel_hi:[1,0]
    v_pk_fma_f32 v[138:139], v[136:137], v[172:173], v[138:139] op_sel:[1,0,0] op_sel_hi:[0,1,1]
    v_pk_fma_f32 v[154:155], v[152:153], v[172:173], v[154:155] op_sel:[1,0,0] op_sel_hi:[0,1,1]
    v_pk_fma_f32 v[140:141], v[174:175], v[138:139], v[136:137] op_sel_hi:[0,1,1] neg_lo:[0,0,1] neg_hi:[0,0,1]
    v_pk_fma_f32 v[156:157], v[174:175], v[154:155], v[152:153] op_sel_hi:[0,1,1] neg_lo:[0,0,1] neg_hi:[0,0,1]
    v_pk_fma_f32 v[142:143], v[174:175], v[140:141], v[138:139] op_sel_hi:[0,1,1] neg_lo:[0,0,1] neg_hi:[0,0,1]
    v_pk_fma_f32 v[158:159], v[174:175], v[156:157], v[154:155] op_sel_hi:[0,1,1] neg_lo:[0,0,1] neg_hi:[0,0,1]
    v_pk_fma_f32 v[144:145], v[174:175], v[142:143], v[140:141] op_sel_hi:[0,1,1] neg_lo:[0,0,1] neg_hi:[0,0,1]
    v_pk_fma_f32 v[160:161], v[174:175], v[158:159], v[156:157] op_sel_hi:[0,1,1] neg_lo:[0,0,1] neg_hi:[0,0,1]
    v_pk_fma_f32 v[146:147], v[174:175], v[144:145], v[142:143] op_sel_hi:[0,1,1] neg_lo:[0,0,1] neg_hi:[0,0,1]
    v_pk_fma_f32 v[162:163], v[174:175], v[160:161], v[158:159] op_sel_hi:[0,1,1] neg_lo:[0,0,1] neg_hi:[0,0,1]
    v_pk_fma_f32 v[148:149], v[174:175], v[146:147], v[144:145] op_sel_hi:[0,1,1] neg_lo:[0,0,1] neg_hi:[0,0,1]
    v_pk_fma_f32 v[164:165], v[174:175], v[162:163], v[160:161] op_sel_hi:[0,1,1] neg_lo:[0,0,1] neg_hi:[0,0,1]
    v_pk_fma_f32 v[150:151], v[174:175], v[148:149], v[146:147] op_sel_hi:[0,1,1] neg_lo:[0,0,1] neg_hi:[0,0,1]
    v_pk_fma_f32 v[166:167], v[174:175], v[164:165], v[162:163] op_sel_hi:[0,1,1] neg_lo:[0,0,1] neg_hi:[0,0,1]
    v_cvt_pk_bf16_f32 v96, v137, v139
    v_cvt_pk_bf16_f32 v97, v141, v143
    v_cvt_pk_bf16_f32 v98, v145, v147
    v_cvt_pk_bf16_f32 v99, v149, v151
    v_cvt_pk_bf16_f32 v100, v153, v155
    v_cvt_pk_bf16_f32 v101, v157, v159
    v_cvt_pk_bf16_f32 v102, v161, v163
    v_cvt_pk_bf16_f32 v103, v165, v167
    v_fmamk_f32 v138, v168, 0x42800000, v169
    v_fmamk_f32 v154, v168, 0x42c00000, v169
    v_cos_f32_e64 v136, v138
    v_sin_f32_e64 v137, -v138
    v_cos_f32_e64 v152, v154
    v_sin_f32_e64 v153, -v154
    v_pk_mul_f32 v[138:139], v[136:137], v[170:171] op_sel_hi:[1,0]
    v_pk_mul_f32 v[154:155], v[152:153], v[170:171] op_sel_hi:[1,0]
    v_pk_fma_f32 v[138:139], v[136:137], v[172:173], v[138:139] op_sel:[1,0,0] op_sel_hi:[0,1,1]
    v_pk_fma_f32 v[154:155], v[152:153], v[172:173], v[154:155] op_sel:[1,0,0] op_sel_hi:[0,1,1]
    v_pk_fma_f32 v[140:141], v[174:175], v[138:139], v[136:137] op_sel_hi:[0,1,1] neg_lo:[0,0,1] neg_hi:[0,0,1]
    v_pk_fma_f32 v[156:157], v[174:175], v[154:155], v[152:153] op_sel_hi:[0,1,1] neg_lo:[0,0,1] neg_hi:[0,0,1]
    v_pk_fma_f32 v[142:143], v[174:175], v[140:141], v[138:139] op_sel_hi:[0,1,1] neg_lo:[0,0,1] neg_hi:[0,0,1]
    v_pk_fma_f32 v[158:159], v[174:175], v[156:157], v[154:155] op_sel_hi:[0,1,1] neg_lo:[0,0,1] neg_hi:[0,0,1]
    v_pk_fma_f32 v[144:145], v[174:175], v[142:143], v[140:141] op_sel_hi:[0,1,1] neg_lo:[0,0,1] neg_hi:[0,0,1]
    v_pk_fma_f32 v[160:161], v[174:175], v[158:159], v[156:157] op_sel_hi:[0,1,1] neg_lo:[0,0,1] neg_hi:[0,0,1]
    v_pk_fma_f32 v[146:147], v[174:175], v[144:145], v[142:143] op_sel_hi:[0,1,1] neg_lo:[0,0,1] neg_hi:[0,0,1]
    v_pk_fma_f32 v[162:163], v[174:175], v[160:161], v[158:159] op_sel_hi:[0,1,1] neg_lo:[0,0,1] neg_hi:[0,0,1]
    v_pk_fma_f32 v[148:149], v[174:175], v[146:147], v[144:145] op_sel_hi:[0,1,1] neg_lo:[0,0,1] neg_hi:[0,0,1]
    v_pk_fma_f32 v[164:165], v[174:175], v[162:163], v[160:161] op_sel_hi:[0,1,1] neg_lo:[0,0,1] neg_hi:[0,0,1]
    v_pk_fma_f32 v[150:151], v[174:175], v[148:149], v[146:147] op_sel_hi:[0,1,1] neg_lo:[0,0,1] neg_hi:[0,0,1]
    v_pk_fma_f32 v[166:167], v[174:175], v[164:165], v[162:163] op_sel_hi:[0,1,1] neg_lo:[0,0,1] neg_hi:[0,0,1]
    v_cvt_pk_bf16_f32 v104, v137, v139
    v_cvt_pk_bf16_f32 v105, v141, v143
    v_cvt_pk_bf16_f32 v106, v145, v147
    v_cvt_pk_bf16_f32 v107, v149, v151
    v_cvt_pk_bf16_f32 v108, v153, v155
    v_cvt_pk_bf16_f32 v109, v157, v159
    v_cvt_pk_bf16_f32 v110, v161, v163
    v_cvt_pk_bf16_f32 v111, v165, v167
    v_fmamk_f32 v138, v168, 0x43000000, v169
    v_fmamk_f32 v154, v168, 0x43200000, v169
    v_cos_f32_e64 v136, v138
    v_sin_f32_e64 v137, -v138
    v_cos_f32_e64 v152, v154
    v_sin_f32_e64 v153, -v154
    v_pk_mul_f32 v[138:139], v[136:137], v[170:171] op_sel_hi:[1,0]
    v_pk_mul_f32 v[154:155], v[152:153], v[170:171] op_sel_hi:[1,0]
    v_pk_fma_f32 v[138:139], v[136:137], v[172:173], v[138:139] op_sel:[1,0,0] op_sel_hi:[0,1,1]
    v_pk_fma_f32 v[154:155], v[152:153], v[172:173], v[154:155] op_sel:[1,0,0] op_sel_hi:[0,1,1]
    v_pk_fma_f32 v[140:141], v[174:175], v[138:139], v[136:137] op_sel_hi:[0,1,1] neg_lo:[0,0,1] neg_hi:[0,0,1]
    v_pk_fma_f32 v[156:157], v[174:175], v[154:155], v[152:153] op_sel_hi:[0,1,1] neg_lo:[0,0,1] neg_hi:[0,0,1]
    v_pk_fma_f32 v[142:143], v[174:175], v[140:141], v[138:139] op_sel_hi:[0,1,1] neg_lo:[0,0,1] neg_hi:[0,0,1]
    v_pk_fma_f32 v[158:159], v[174:175], v[156:157], v[154:155] op_sel_hi:[0,1,1] neg_lo:[0,0,1] neg_hi:[0,0,1]
    v_pk_fma_f32 v[144:145], v[174:175], v[142:143], v[140:141] op_sel_hi:[0,1,1] neg_lo:[0,0,1] neg_hi:[0,0,1]
    v_pk_fma_f32 v[160:161], v[174:175], v[158:159], v[156:157] op_sel_hi:[0,1,1] neg_lo:[0,0,1] neg_hi:[0,0,1]
    v_pk_fma_f32 v[146:147], v[174:175], v[144:145], v[142:143] op_sel_hi:[0,1,1] neg_lo:[0,0,1] neg_hi:[0,0,1]
    v_pk_fma_f32 v[162:163], v[174:175], v[160:161], v[158:159] op_sel_hi:[0,1,1] neg_lo:[0,0,1] neg_hi:[0,0,1]
    v_pk_fma_f32 v[148:149], v[174:175], v[146:147], v[144:145] op_sel_hi:[0,1,1] neg_lo:[0,0,1] neg_hi:[0,0,1]
    v_pk_fma_f32 v[164:165], v[174:175], v[162:163], v[160:161] op_sel_hi:[0,1,1] neg_lo:[0,0,1] neg_hi:[0,0,1]
    v_pk_fma_f32 v[150:151], v[174:175], v[148:149], v[146:147] op_sel_hi:[0,1,1] neg_lo:[0,0,1] neg_hi:[0,0,1]
    v_pk_fma_f32 v[166:167], v[174:175], v[164:165], v[162:163] op_sel_hi:[0,1,1] neg_lo:[0,0,1] neg_hi:[0,0,1]
    v_cvt_pk_bf16_f32 v112, v137, v139
    v_cvt_pk_bf16_f32 v113, v141, v143
    v_cvt_pk_bf16_f32 v114, v145, v147
    v_cvt_pk_bf16_f32 v115, v149, v151
    v_cvt_pk_bf16_f32 v116, v153, v155
    v_cvt_pk_bf16_f32 v117, v157, v159
    v_cvt_pk_bf16_f32 v118, v161, v163
    v_cvt_pk_bf16_f32 v119, v165, v167
    v_fmamk_f32 v138, v168, 0x43400000, v169
    v_fmamk_f32 v154, v168, 0x43600000, v169
    v_cos_f32_e64 v136, v138
    v_sin_f32_e64 v137, -v138
    v_cos_f32_e64 v152, v154
    v_sin_f32_e64 v153, -v154
    v_pk_mul_f32 v[138:139], v[136:137], v[170:171] op_sel_hi:[1,0]
    v_pk_mul_f32 v[154:155], v[152:153], v[170:171] op_sel_hi:[1,0]
    v_pk_fma_f32 v[138:139], v[136:137], v[172:173], v[138:139] op_sel:[1,0,0] op_sel_hi:[0,1,1]
    v_pk_fma_f32 v[154:155], v[152:153], v[172:173], v[154:155] op_sel:[1,0,0] op_sel_hi:[0,1,1]
    v_pk_fma_f32 v[140:141], v[174:175], v[138:139], v[136:137] op_sel_hi:[0,1,1] neg_lo:[0,0,1] neg_hi:[0,0,1]
    v_pk_fma_f32 v[156:157], v[174:175], v[154:155], v[152:153] op_sel_hi:[0,1,1] neg_lo:[0,0,1] neg_hi:[0,0,1]
    v_pk_fma_f32 v[142:143], v[174:175], v[140:141], v[138:139] op_sel_hi:[0,1,1] neg_lo:[0,0,1] neg_hi:[0,0,1]
    v_pk_fma_f32 v[158:159], v[174:175], v[156:157], v[154:155] op_sel_hi:[0,1,1] neg_lo:[0,0,1] neg_hi:[0,0,1]
    v_pk_fma_f32 v[144:145], v[174:175], v[142:143], v[140:141] op_sel_hi:[0,1,1] neg_lo:[0,0,1] neg_hi:[0,0,1]
    v_pk_fma_f32 v[160:161], v[174:175], v[158:159], v[156:157] op_sel_hi:[0,1,1] neg_lo:[0,0,1] neg_hi:[0,0,1]
    v_pk_fma_f32 v[146:147], v[174:175], v[144:145], v[142:143] op_sel_hi:[0,1,1] neg_lo:[0,0,1] neg_hi:[0,0,1]
    v_pk_fma_f32 v[162:163], v[174:175], v[160:161], v[158:159] op_sel_hi:[0,1,1] neg_lo:[0,0,1] neg_hi:[0,0,1]
    v_pk_fma_f32 v[148:149], v[174:175], v[146:147], v[144:145] op_sel_hi:[0,1,1] neg_lo:[0,0,1] neg_hi:[0,0,1]
    v_pk_fma_f32 v[164:165], v[174:175], v[162:163], v[160:161] op_sel_hi:[0,1,1] neg_lo:[0,0,1] neg_hi:[0,0,1]
    v_pk_fma_f32 v[150:151], v[174:175], v[148:149], v[146:147] op_sel_hi:[0,1,1] neg_lo:[0,0,1] neg_hi:[0,0,1]
    v_pk_fma_f32 v[166:167], v[174:175], v[164:165], v[162:163] op_sel_hi:[0,1,1] neg_lo:[0,0,1] neg_hi:[0,0,1]
    v_cvt_pk_bf16_f32 v120, v137, v139
    v_cvt_pk_bf16_f32 v121, v141, v143
    v_cvt_pk_bf16_f32 v122, v145, v147
    v_cvt_pk_bf16_f32 v123, v149, v151
    v_cvt_pk_bf16_f32 v124, v153, v155
    v_cvt_pk_bf16_f32 v125, v157, v159
    v_cvt_pk_bf16_f32 v126, v161, v163
    v_cvt_pk_bf16_f32 v127, v165, v167
    v_fmamk_f32 v138, v168, 0x43800000, v169
    v_fmamk_f32 v154, v168, 0x43900000, v169
    v_cos_f32_e64 v136, v138
    v_sin_f32_e64 v137, -v138
    v_cos_f32_e64 v152, v154
    v_sin_f32_e64 v153, -v154
    v_pk_mul_f32 v[138:139], v[136:137], v[170:171] op_sel_hi:[1,0]
    v_pk_mul_f32 v[154:155], v[152:153], v[170:171] op_sel_hi:[1,0]
    v_pk_fma_f32 v[138:139], v[136:137], v[172:173], v[138:139] op_sel:[1,0,0] op_sel_hi:[0,1,1]
    v_pk_fma_f32 v[154:155], v[152:153], v[172:173], v[154:155] op_sel:[1,0,0] op_sel_hi:[0,1,1]
    v_pk_fma_f32 v[140:141], v[174:175], v[138:139], v[136:137] op_sel_hi:[0,1,1] neg_lo:[0,0,1] neg_hi:[0,0,1]
    v_pk_fma_f32 v[156:157], v[174:175], v[154:155], v[152:153] op_sel_hi:[0,1,1] neg_lo:[0,0,1] neg_hi:[0,0,1]
    v_pk_fma_f32 v[142:143], v[174:175], v[140:141], v[138:139] op_sel_hi:[0,1,1] neg_lo:[0,0,1] neg_hi:[0,0,1]
    v_pk_fma_f32 v[158:159], v[174:175], v[156:157], v[154:155] op_sel_hi:[0,1,1] neg_lo:[0,0,1] neg_hi:[0,0,1]
    v_pk_fma_f32 v[144:145], v[174:175], v[142:143], v[140:141] op_sel_hi:[0,1,1] neg_lo:[0,0,1] neg_hi:[0,0,1]
    v_pk_fma_f32 v[160:161], v[174:175], v[158:159], v[156:157] op_sel_hi:[0,1,1] neg_lo:[0,0,1] neg_hi:[0,0,1]
    v_pk_fma_f32 v[146:147], v[174:175], v[144:145], v[142:143] op_sel_hi:[0,1,1] neg_lo:[0,0,1] neg_hi:[0,0,1]
    v_pk_fma_f32 v[162:163], v[174:175], v[160:161], v[158:159] op_sel_hi:[0,1,1] neg_lo:[0,0,1] neg_hi:[0,0,1]
    v_pk_fma_f32 v[148:149], v[174:175], v[146:147], v[144:145] op_sel_hi:[0,1,1] neg_lo:[0,0,1] neg_hi:[0,0,1]
    v_pk_fma_f32 v[164:165], v[174:175], v[162:163], v[160:161] op_sel_hi:[0,1,1] neg_lo:[0,0,1] neg_hi:[0,0,1]
    v_pk_fma_f32 v[150:151], v[174:175], v[148:149], v[146:147] op_sel_hi:[0,1,1] neg_lo:[0,0,1] neg_hi:[0,0,1]
    v_pk_fma_f32 v[166:167], v[174:175], v[164:165], v[162:163] op_sel_hi:[0,1,1] neg_lo:[0,0,1] neg_hi:[0,0,1]
    v_cvt_pk_bf16_f32 v128, v137, v139
    v_cvt_pk_bf16_f32 v129, v141, v143
    v_cvt_pk_bf16_f32 v130, v145, v147
    v_cvt_pk_bf16_f32 v131, v149, v151
    v_cvt_pk_bf16_f32 v132, v153, v155
    v_cvt_pk_bf16_f32 v133, v157, v159
    v_cvt_pk_bf16_f32 v134, v161, v163
    v_cvt_pk_bf16_f32 v135, v165, v167
skip_5002:
    s_waitcnt lgkmcnt(0)
    s_mul_i32 s96, s96, 0x2C9277B5
    s_add_u32 s96, s96, 0xAC564B05
    s_cmp_lg_u32 s52, 3
    s_cbranch_scc1 skip_5003
    s_lshl_b32 s72, s53, 5
    s_add_u32 s72, s72, s54
    s_lshl_b32 s72, s72, 2
    s_add_u32 s72, s72, 32768
    s_add_u32 s99, s99, s96
    v_mov_b32 v10, s99
    v_mov_b32 v11, 0
    s_mov_b64 exec, 1
    buffer_store_dword v10, v11, s[44:47], s72 offen sc1
    s_mov_b64 exec, -1
skip_5003:
    v_lshrrev_b32 v10, 4, v1
    v_bfe_u32 v11, v1, 2, 2
    v_lshl_add_u32 v12, v10, 3, v11
    v_lshl_add_u32 v13, v10, 2, v11
    v_and_b32 v10, 3, v1
    v_lshlrev_b32 v10, 3, v10
    v_add_u32_e64 v10, s86, v10
    v_lshl_add_u32 v12, v12, 6, v10
    v_lshl_add_u32 v13, v13, 6, v10
    s_waitcnt vmcnt(0)
    ds_read_b64_tr_b16 v[176:177], v12 offset:0
    ds_read_b64_tr_b16 v[184:185], v13 offset:2048
    ds_read_b64_tr_b16 v[178:179], v12 offset:256
    ds_read_b64_tr_b16 v[186:187], v13 offset:3072
    ds_read_b64_tr_b16 v[180:181], v12 offset:32
    ds_read_b64_tr_b16 v[188:189], v13 offset:2080
    ds_read_b64_tr_b16 v[182:183], v12 offset:288
    ds_read_b64_tr_b16 v[190:191], v13 offset:3104
    s_waitcnt lgkmcnt(0)
    s_add_u32 s72, s84, 20480
    s_mov_b32 s73, s83
    buffer_store_dwordx4 v[176:179], v2, s[44:47], s84 offen sc1
    buffer_store_dwordx4 v[180:183], v2, s[44:47], s72 offen sc1
    buffer_store_dwordx4 v[184:187], v2, s[44:47], s85 offen sc1
    buffer_store_dwordx4 v[188:191], v2, s[44:47], s73 offen sc1
    v_and_b32 v10, 7, v1
    v_lshrrev_b32_e64 v11, 1, v10
    v_mul_u32_u24 v4, 10272, v11
    v_and_b32_e64 v10, 1, v1
    v_mul_u32_u24 v11, 640, v10
    v_add_u32 v4, v4, v11
    v_lshlrev_b32 v5, 31, v10
    v_or_b32_e64 v5, 1.0, v5
    v_bfe_u32 v10, v1, 3, 1
    v_mul_u32_u24 v11, 1280, v10
    v_add_u32 v4, v4, v11
    v_lshrrev_b32 v10, 4, v1
    v_lshl_add_u32 v4, v10, 4, v4
    v_lshlrev_b32_e64 v6, 4, v10
    s_mul_i32 s76, s70, 81920
    s_lshr_b32 s72, s69, 2
    s_mul_i32 s72, s72, 5120
    s_add_u32 s76, s76, s72
    s_and_b32 s72, s69, 3
    s_lshl_b32 s72, s72, 8
    s_add_u32 s76, s76, s72
    s_add_u32 s76, s76, 65536
    s_lshl_b32 s88, s52, 10
    s_add_u32 s88, s88, s76
    s_mul_i32 s89, s52, 655360
    s_add_u32 s89, s89, s76
    s_add_u32 s89, s89, 4096
    v_lshrrev_b32_e64 v10, 5, v1
    v_mul_u32_u24 v7, 327680, v10
    v_and_b32 v10, 15, v1
    v_lshlrev_b32 v9, 2, v10
    v_lshl_add_u32 v7, v10, 4, v7
    v_bfe_u32 v10, v1, 4, 1
    v_lshl_add_u32 v8, v10, 3, v7
    v_mul_u32_u24 v10, 655360, v10
    v_add_u32 v7, v7, v10
    s_cmp_eq_u32 s52, 0
    s_cselect_b32 s72, 1.0, 0
    v_mul_f32_e64 v3, s72, v5
    s_barrier
    v_add_u32 v10, 144256, v6
    ds_read_b128 v[188:191], v10
    ds_read_b128 v[136:139], v4 offset:0
    ds_read_b128 a[0:3], v4 offset:2560
    ds_read_b128 v[140:143], v4 offset:64
    ds_read_b128 a[4:7], v4 offset:2624
    ds_read_b128 v[144:147], v4 offset:128
    ds_read_b128 a[8:11], v4 offset:2688
    ds_read_b128 v[148:151], v4 offset:192
    ds_read_b128 a[12:15], v4 offset:2752
    ds_read_b128 v[152:155], v4 offset:256
    ds_read_b128 a[16:19], v4 offset:2816
    ds_read_b128 v[156:159], v4 offset:320
    ds_read_b128 a[20:23], v4 offset:2880
    ds_read_b128 v[160:163], v4 offset:384
    ds_read_b128 a[24:27], v4 offset:2944
    ds_read_b128 v[164:167], v4 offset:448
    ds_read_b128 a[28:31], v4 offset:3008
    ds_read_b128 v[168:171], v4 offset:512
    ds_read_b128 a[32:35], v4 offset:3072
    ds_read_b128 v[172:175], v4 offset:576
    ds_read_b128 a[36:39], v4 offset:3136
    s_waitcnt vmcnt(0) lgkmcnt(15)
    v_mul_f32 v176, v5, v188
    v_mul_f32 v184, v3, v188
    v_mul_f32 v177, v5, v189
    v_mul_f32 v185, v3, v189
    v_mul_f32 v178, v5, v190
    v_mul_f32 v186, v3, v190
    v_mul_f32 v179, v5, v191
    v_mul_f32 v187, v3, v191
    s_waitcnt lgkmcnt(15)
    v_mfma_f32_16x16x32_bf16 v[176:179], v[136:139], v[16:19], v[176:179]
    s_waitcnt lgkmcnt(15)
    v_mfma_f32_16x16x32_bf16 v[180:183], a[0:3], v[56:59], 0
    s_waitcnt lgkmcnt(15)
    v_mfma_f32_16x16x32_bf16 v[176:179], v[140:143], v[20:23], v[176:179]
    s_waitcnt lgkmcnt(15)
    v_mfma_f32_16x16x32_bf16 v[180:183], a[4:7], v[60:63], v[180:183]
    s_waitcnt lgkmcnt(15)
    v_mfma_f32_16x16x32_bf16 v[176:179], v[144:147], v[24:27], v[176:179]
    s_waitcnt lgkmcnt(14)
    v_mfma_f32_16x16x32_bf16 v[180:183], a[8:11], v[64:67], v[180:183]
    s_waitcnt lgkmcnt(13)
    v_mfma_f32_16x16x32_bf16 v[176:179], v[148:151], v[28:31], v[176:179]
    s_waitcnt lgkmcnt(12)
    v_mfma_f32_16x16x32_bf16 v[180:183], a[12:15], v[68:71], v[180:183]
    s_waitcnt lgkmcnt(11)
    v_mfma_f32_16x16x32_bf16 v[176:179], v[152:155], v[32:35], v[176:179]
    s_waitcnt lgkmcnt(10)
    v_mfma_f32_16x16x32_bf16 v[180:183], a[16:19], v[72:75], v[180:183]
    s_waitcnt lgkmcnt(9)
    v_mfma_f32_16x16x32_bf16 v[176:179], v[156:159], v[36:39], v[176:179]
    s_waitcnt lgkmcnt(8)
    v_mfma_f32_16x16x32_bf16 v[180:183], a[20:23], v[76:79], v[180:183]
    s_waitcnt lgkmcnt(7)
    v_mfma_f32_16x16x32_bf16 v[176:179], v[160:163], v[40:43], v[176:179]
    s_waitcnt lgkmcnt(6)
    v_mfma_f32_16x16x32_bf16 v[180:183], a[24:27], v[80:83], v[180:183]
    s_waitcnt lgkmcnt(5)
    v_mfma_f32_16x16x32_bf16 v[176:179], v[164:167], v[44:47], v[176:179]
    s_waitcnt lgkmcnt(4)
    v_mfma_f32_16x16x32_bf16 v[180:183], a[28:31], v[84:87], v[180:183]
    s_waitcnt lgkmcnt(3)
    v_mfma_f32_16x16x32_bf16 v[176:179], v[168:171], v[48:51], v[176:179]
    s_waitcnt lgkmcnt(2)
    v_mfma_f32_16x16x32_bf16 v[180:183], a[32:35], v[88:91], v[180:183]
    s_waitcnt lgkmcnt(1)
    v_mfma_f32_16x16x32_bf16 v[176:179], v[172:175], v[52:55], v[176:179]
    s_waitcnt lgkmcnt(0)
    v_mfma_f32_16x16x32_bf16 v[180:183], a[36:39], v[92:95], v[180:183]
    s_cmp_lg_u32 s52, 0
    s_cbranch_scc1 skip_5004
    v_mfma_f32_16x16x32_bf16 v[184:187], v[136:139], v[96:99], v[184:187]
    v_mfma_f32_16x16x32_bf16 v[184:187], v[140:143], v[100:103], v[184:187]
    v_mfma_f32_16x16x32_bf16 v[184:187], v[144:147], v[104:107], v[184:187]
    v_mfma_f32_16x16x32_bf16 v[184:187], v[148:151], v[108:111], v[184:187]
    v_mfma_f32_16x16x32_bf16 v[184:187], v[152:155], v[112:115], v[184:187]
    v_mfma_f32_16x16x32_bf16 v[184:187], v[156:159], v[116:119], v[184:187]
    v_mfma_f32_16x16x32_bf16 v[184:187], v[160:163], v[120:123], v[184:187]
    v_mfma_f32_16x16x32_bf16 v[184:187], v[164:167], v[124:127], v[184:187]
    v_mfma_f32_16x16x32_bf16 v[184:187], v[168:171], v[128:131], v[184:187]
    v_mfma_f32_16x16x32_bf16 v[184:187], v[172:175], v[132:135], v[184:187]
skip_5004:
    s_cmp_lg_u32 s52, 1
    s_cbranch_scc1 skip_5005
    v_mfma_f32_16x16x32_bf16 v[184:187], a[0:3], v[96:99], v[184:187]
    v_mfma_f32_16x16x32_bf16 v[184:187], a[4:7], v[100:103], v[184:187]
    v_mfma_f32_16x16x32_bf16 v[184:187], a[8:11], v[104:107], v[184:187]
    v_mfma_f32_16x16x32_bf16 v[184:187], a[12:15], v[108:111], v[184:187]
    v_mfma_f32_16x16x32_bf16 v[184:187], a[16:19], v[112:115], v[184:187]
    v_mfma_f32_16x16x32_bf16 v[184:187], a[20:23], v[116:119], v[184:187]
    v_mfma_f32_16x16x32_bf16 v[184:187], a[24:27], v[120:123], v[184:187]
    v_mfma_f32_16x16x32_bf16 v[184:187], a[28:31], v[124:127], v[184:187]
    v_mfma_f32_16x16x32_bf16 v[184:187], a[32:35], v[128:131], v[184:187]
    v_mfma_f32_16x16x32_bf16 v[184:187], a[36:39], v[132:135], v[184:187]
skip_5005:
    v_cvt_pk_bf16_f32 v12, v176, v177
    v_cvt_pk_bf16_f32 v13, v178, v179
    v_cvt_pk_bf16_f32 v14, v180, v181
    v_cvt_pk_bf16_f32 v15, v182, v183
    s_nop 0
    v_permlane16_swap_b32 v12, v14
    v_permlane16_swap_b32 v13, v15
    buffer_store_dwordx4 v[12:15], v7, s[44:47], s88 offen sc1
    s_cmp_ge_u32 s52, 2
    s_cbranch_scc1 skip_5006
    s_nop 4
    v_cvt_pk_bf16_f32 v10, v184, v185
    v_cvt_pk_bf16_f32 v11, v186, v187
    buffer_store_dwordx2 v[10:11], v8, s[44:47], s89 offen sc1
skip_5006:
    s_cmp_lg_u32 s69, 0
    s_cbranch_scc1 skip_5007
    s_mul_i32 s74, s70, 320
    s_add_u32 s75, s74, 1409024
    s_lshl_b32 s74, s52, 6
    s_add_u32 s74, s74, s75
    s_mov_b32 exec_lo, 0
    s_mov_b32 exec_hi, 0xffff
    buffer_store_dword v180, v9, s[44:47], s74 offen offset:1280 sc1
    s_cmp_lg_u32 s52, 1
    s_cbranch_scc1 skip_5008
    buffer_store_dword v184, v9, s[44:47], s75 offen offset:1536 sc1
skip_5008:
    s_mov_b64 exec, -1
    v_add_u32 v6, 143616, v6
    v_mov_b32 v4, 144320
    ds_read_b32 v188, v4
    ds_read_b128 a[0:3], v6 offset:0
    ds_read_b128 a[4:7], v6 offset:64
    ds_read_b128 a[8:11], v6 offset:128
    ds_read_b128 a[12:15], v6 offset:192
    ds_read_b128 a[16:19], v6 offset:256
    ds_read_b128 a[20:23], v6 offset:320
    ds_read_b128 a[24:27], v6 offset:384
    ds_read_b128 a[28:31], v6 offset:448
    ds_read_b128 a[32:35], v6 offset:512
    ds_read_b128 a[36:39], v6 offset:576
    s_waitcnt lgkmcnt(0)
    v_mul_f32 v136, v5, v188
    v_mul_f32 v140, v5, v188
    v_mul_f32 v137, v5, v188
    v_mul_f32 v141, v5, v188
    v_mul_f32 v138, v5, v188
    v_mul_f32 v142, v5, v188
    v_mul_f32 v139, v5, v188
    v_mul_f32_e64 v143, v5, v188
    s_nop 0
    v_mfma_f32_16x16x32_bf16 v[136:139], a[0:3], v[16:19], v[136:139]
    v_mfma_f32_16x16x32_bf16 v[140:143], a[0:3], v[96:99], v[140:143]
    v_mfma_f32_16x16x32_bf16 v[136:139], a[4:7], v[20:23], v[136:139]
    v_mfma_f32_16x16x32_bf16 v[140:143], a[4:7], v[100:103], v[140:143]
    v_mfma_f32_16x16x32_bf16 v[136:139], a[8:11], v[24:27], v[136:139]
    v_mfma_f32_16x16x32_bf16 v[140:143], a[8:11], v[104:107], v[140:143]
    v_mfma_f32_16x16x32_bf16 v[136:139], a[12:15], v[28:31], v[136:139]
    v_mfma_f32_16x16x32_bf16 v[140:143], a[12:15], v[108:111], v[140:143]
    v_mfma_f32_16x16x32_bf16 v[136:139], a[16:19], v[32:35], v[136:139]
    v_mfma_f32_16x16x32_bf16 v[140:143], a[16:19], v[112:115], v[140:143]
    v_mfma_f32_16x16x32_bf16 v[136:139], a[20:23], v[36:39], v[136:139]
    v_mfma_f32_16x16x32_bf16 v[140:143], a[20:23], v[116:119], v[140:143]
    v_mfma_f32_16x16x32_bf16 v[136:139], a[24:27], v[40:43], v[136:139]
    v_mfma_f32_16x16x32_bf16 v[140:143], a[24:27], v[120:123], v[140:143]
    v_mfma_f32_16x16x32_bf16 v[136:139], a[28:31], v[44:47], v[136:139]
    v_mfma_f32_16x16x32_bf16 v[140:143], a[28:31], v[124:127], v[140:143]
    v_mfma_f32_16x16x32_bf16 v[136:139], a[32:35], v[48:51], v[136:139]
    v_mfma_f32_16x16x32_bf16 v[140:143], a[32:35], v[128:131], v[140:143]
    v_mfma_f32_16x16x32_bf16 v[136:139], a[36:39], v[52:55], v[136:139]
    v_mfma_f32_16x16x32_bf16 v[140:143], a[36:39], v[132:135], v[140:143]
    s_mov_b64 exec, 0xffff
    s_nop 5
    buffer_store_dword v136, v9, s[44:47], s74 offen sc1
    s_cmp_lg_u32 s52, 0
    s_cbranch_scc1 skip_5009
    buffer_store_dword v140, v9, s[44:47], s75 offen offset:256 sc1
skip_5009:
    s_mov_b64 exec, -1
skip_5007:
    s_setprio 0
    s_sub_u32 s64, s59, s52
    s_lshr_b32 s63, s54, 3
    s_and_b32 s62, s63, 1
    s_lshl_b32 s62, s62, 1
    s_add_u32 s64, s64, s62
    s_lshl_b32 s64, s64, 1
    s_add_u32 s64, s64, s52
    s_and_b32 s62, s54, 7
    s_sub_u32 s61, s64, s52
    s_lshr_b32 s61, s61, 1
    s_lshl_b32 s63, s63, 1
    s_add_u32 s63, s63, s62
    v_mov_b32 v4, 144352
    v_mov_b32_e64 v5, 1
    s_mov_b32 s99, s87
    s_waitcnt vmcnt(0)
    s_mov_b64 exec, 1
    ds_add_rtn_u32 v5, v4, v5
    s_mov_b64 exec, -1
    s_waitcnt lgkmcnt(0)
    v_readfirstlane_b32 s73, v5
    s_nop 0
    s_cmp_lg_u32 s73, 3
    s_cbranch_scc1 skip_5010
    s_lshl_b32 s72, s99, 7
    s_add_u32 s72, s72, 1441792
    v_mov_b32 v10, s96
    v_mov_b32 v11, 0
    s_mov_b64 exec, 1
    buffer_store_dword v10, v11, s[44:47], s72 offen sc1
    s_mov_b64 exec, -1
skip_5010:
    v_lshrrev_b32 v10, 3, v1
    v_mul_u32_u24 v12, 8192, v10
    v_lshrrev_b32 v10, 4, v1
    v_and_b32 v11, 7, v1
    v_xor_b32_e64 v10, v10, v11
    v_lshl_add_u32 v12, v10, 4, v12
    v_xor_b32_e64 v13, 64, v12
    v_add_u32 v13, 65536, v13
    v_and_b32 v10, 15, v1
    v_lshlrev_b32 v14, 7, v10
    v_lshrrev_b32 v10, 1, v10
    v_lshrrev_b32 v11, 4, v1
    v_xor_b32_e64 v10, v10, v11
    v_lshl_add_u32 v14, v10, 4, v14
    v_xor_b32_e64 v15, 64, v14
    s_barrier
    s_waitcnt lgkmcnt(0)
    s_mul_i32 s72, s52, 10240
    s_add_u32 s72, s72, 61696
    s_add_u32 s65, s52, 0
    s_and_b32 s65, s65, 3
    s_lshr_b32 s66, s65, 1
    s_add_u32 s66, s66, s61
    s_lshl_b32 s66, s66, 5
    s_and_b32 s65, s65, 1
    s_add_u32 s65, s65, s66
    s_lshl_b32 s65, s65, 12
    s_lshl_b32 s66, s52, 10
    s_add_u32 s65, s65, s66
    s_mov_b32 s67, s63
    s_add_u32 s68, s67, 3
    s_and_b32 s68, s68, 7
    s_lshl_b32 s68, s68, 7
    s_add_u32 s68, s68, s65
    s_add_u32 m0, s72, 0
    s_nop 0
    buffer_load_dwordx4 v12, s[28:31], s68 offen lds
    s_add_u32 m0, s72, 1024
    s_nop 0
    buffer_load_dwordx4 v13, s[28:31], s68 offen lds
    s_add_u32 s68, s67, 4
    s_and_b32 s68, s68, 7
    s_lshl_b32 s68, s68, 7
    s_add_u32 s68, s68, s65
    s_add_u32 m0, s72, 2048
    s_nop 0
    buffer_load_dwordx4 v12, s[28:31], s68 offen lds
    s_add_u32 m0, s72, 3072
    s_nop 0
    buffer_load_dwordx4 v13, s[28:31], s68 offen lds
    s_add_u32 s68, s67, 5
    s_and_b32 s68, s68, 7
    s_lshl_b32 s68, s68, 7
    s_add_u32 s68, s68, s65
    s_add_u32 m0, s72, 4096
    s_nop 0
    buffer_load_dwordx4 v12, s[28:31], s68 offen lds
    s_add_u32 m0, s72, 5120
    s_nop 0
    buffer_load_dwordx4 v13, s[28:31], s68 offen lds
    s_add_u32 s68, s67, 6
    s_and_b32 s68, s68, 7
    s_lshl_b32 s68, s68, 7
    s_add_u32 s68, s68, s65
    s_add_u32 m0, s72, 6144
    s_nop 0
    buffer_load_dwordx4 v12, s[28:31], s68 offen lds
    s_add_u32 m0, s72, 7168
    s_nop 0
    buffer_load_dwordx4 v13, s[28:31], s68 offen lds
    s_add_u32 s68, s67, 7
    s_and_b32 s68, s68, 7
    s_lshl_b32 s68, s68, 7
    s_add_u32 s68, s68, s65
    s_add_u32 m0, s72, 8192
    s_nop 0
    buffer_load_dwordx4 v12, s[28:31], s68 offen lds
    s_add_u32 m0, s72, 9216
    s_nop 0
    buffer_load_dwordx4 v13, s[28:31], s68 offen lds
    s_mul_i32 s72, s52, 10240
    s_cmp_lt_u32 s52, 2
    s_cselect_b32 s73, 81920, 0
    s_add_u32 s72, s72, s73
    s_add_u32 s72, s72, 20736
    s_add_u32 s65, s52, 1
    s_and_b32 s65, s65, 3
    s_lshr_b32 s66, s65, 1
    s_add_u32 s66, s66, s61
    s_lshl_b32 s66, s66, 5
    s_and_b32 s65, s65, 1
    s_add_u32 s65, s65, s66
    s_lshl_b32 s65, s65, 12
    s_lshl_b32 s66, s52, 10
    s_add_u32 s65, s65, s66
    s_mov_b32 s67, s63
    s_add_u32 s68, s67, 3
    s_and_b32 s68, s68, 7
    s_lshl_b32 s68, s68, 7
    s_add_u32 s68, s68, s65
    s_add_u32 m0, s72, 0
    s_nop 0
    buffer_load_dwordx4 v12, s[28:31], s68 offen lds
    s_add_u32 m0, s72, 1024
    s_nop 0
    buffer_load_dwordx4 v13, s[28:31], s68 offen lds
    s_add_u32 s68, s67, 4
    s_and_b32 s68, s68, 7
    s_lshl_b32 s68, s68, 7
    s_add_u32 s68, s68, s65
    s_add_u32 m0, s72, 2048
    s_nop 0
    buffer_load_dwordx4 v12, s[28:31], s68 offen lds
    s_add_u32 m0, s72, 3072
    s_nop 0
    buffer_load_dwordx4 v13, s[28:31], s68 offen lds
    s_add_u32 s68, s67, 5
    s_and_b32 s68, s68, 7
    s_lshl_b32 s68, s68, 7
    s_add_u32 s68, s68, s65
    s_add_u32 m0, s72, 4096
    s_nop 0
    buffer_load_dwordx4 v12, s[28:31], s68 offen lds
    s_add_u32 m0, s72, 5120
    s_nop 0
    buffer_load_dwordx4 v13, s[28:31], s68 offen lds
    s_add_u32 s68, s67, 6
    s_and_b32 s68, s68, 7
    s_lshl_b32 s68, s68, 7
    s_add_u32 s68, s68, s65
    s_add_u32 m0, s72, 6144
    s_nop 0
    buffer_load_dwordx4 v12, s[28:31], s68 offen lds
    s_add_u32 m0, s72, 7168
    s_nop 0
    buffer_load_dwordx4 v13, s[28:31], s68 offen lds
    s_add_u32 s68, s67, 7
    s_and_b32 s68, s68, 7
    s_lshl_b32 s68, s68, 7
    s_add_u32 s68, s68, s65
    s_add_u32 m0, s72, 8192
    s_nop 0
    buffer_load_dwordx4 v12, s[28:31], s68 offen lds
    s_add_u32 m0, s72, 9216
    s_nop 0
    buffer_load_dwordx4 v13, s[28:31], s68 offen lds
    s_and_b32 s72, s54, 15
    s_lshl_b32 s72, s72, 2
    s_add_u32 s72, s72, s52
    s_mul_i32 s72, s72, 2560
    s_sub_u32 s73, s59, s52
    s_mul_i32 s73, s73, 40960
    s_add_u32 s72, s72, s73
    s_add_u32 s72, s72, 1572864
    s_lshl_b32 s73, s59, 12
    s_lshl_b32 s74, s60, 8
    s_add_u32 s73, s73, s74
    s_add_u32 s73, s73, 11531776
    s_lshl_b32 s74, s59, 10
    s_add_u32 s74, s74, 4191488
    v_mov_b32 v10, s72
    v_mov_b32 v11, s73
    v_cmp_lt_u32 vcc, 19, v1
    s_nop 1
    v_cndmask_b32 v10, v10, v11, vcc
    v_mov_b32 v11, s74
    v_cmp_lt_u32 vcc, 21, v1
    s_nop 1
    v_cndmask_b32 v10, v10, v11, vcc
    v_lshl_add_u32 v10, v1, 7, v10
    s_mov_b64 exec, 0x3fffffff
    buffer_load_dword v4, v10, s[44:47], 0 offen
    s_mov_b64 exec, -1
    s_barrier
    s_cmp_lg_u32 s52, 0
    s_cbranch_scc1 skip_5011
    s_lshl_b32 s72, s54, 7
    v_lshlrev_b32 v10, 12, v1
    s_mov_b64 exec, 0xffff
    buffer_load_dword v4, v10, s[4:7], s72 offen
    s_mov_b64 exec, -1
skip_5011:
    s_mul_i32 s72, s52, 10240
    s_add_u32 s72, s72, 61696
    v_add_u32 v8, s72, v14
    v_add_u32 v9, s72, v15
    s_waitcnt vmcnt(11)
    ds_read_b128 a[0:3], v8 offset:0
    ds_read_b128 a[4:7], v9 offset:0
    ds_read_b128 a[8:11], v8 offset:2048
    ds_read_b128 a[12:15], v9 offset:2048
    ds_read_b128 a[16:19], v8 offset:4096
    ds_read_b128 a[20:23], v9 offset:4096
    ds_read_b128 a[24:27], v8 offset:6144
    ds_read_b128 a[28:31], v9 offset:6144
    ds_read_b128 a[32:35], v8 offset:8192
    ds_read_b128 a[36:39], v9 offset:8192
    s_mul_i32 s72, s52, 10240
    s_cmp_lt_u32 s52, 2
    s_cselect_b32 s73, 81920, 0
    s_add_u32 s72, s72, s73
    s_add_u32 s72, s72, 20736
    v_add_u32 v8, s72, v14
    v_add_u32_e64 v9, s72, v15
    s_waitcnt vmcnt(1)
    ds_read_b128 a[40:43], v8 offset:0
    ds_read_b128 a[44:47], v9 offset:0
    ds_read_b128 a[48:51], v8 offset:2048
    ds_read_b128 a[52:55], v9 offset:2048
    ds_read_b128 a[56:59], v8 offset:4096
    ds_read_b128 a[60:63], v9 offset:4096
    ds_read_b128 v[96:99], v8 offset:6144
    ds_read_b128 v[100:103], v9 offset:6144
    ds_read_b128 v[104:107], v8 offset:8192
    ds_read_b128 v[108:111], v9 offset:8192
    s_waitcnt lgkmcnt(0)
    s_barrier
    s_mul_i32 s65, s60, 61440
    s_add_u32 s65, s65, 13565952
    s_lshr_b32 s67, s54, 4
    s_lshl_b32 s67, s67, 13
    s_mul_i32 s66, s52, 15360
    s_add_u32 s65, s65, s66
    s_add_u32 m0, s66, s67
    s_add_u32 s68, s65, s67
    buffer_load_dwordx4 v2, s[44:47], s68 offen sc1 lds
    s_add_u32 s67, s67, 1024
    s_cmp_eq_u32 s67, 15360
    s_cselect_b32 s67, 0, s67
    s_add_u32 m0, s66, s67
    s_add_u32 s68, s65, s67
    buffer_load_dwordx4 v2, s[44:47], s68 offen sc1 lds
    s_add_u32 s67, s67, 1024
    s_cmp_eq_u32 s67, 15360
    s_cselect_b32 s67, 0, s67
    s_add_u32 m0, s66, s67
    s_add_u32 s68, s65, s67
    buffer_load_dwordx4 v2, s[44:47], s68 offen sc1 lds
    s_add_u32 s67, s67, 1024
    s_cmp_eq_u32 s67, 15360
    s_cselect_b32 s67, 0, s67
    s_add_u32 m0, s66, s67
    s_add_u32 s68, s65, s67
    buffer_load_dwordx4 v2, s[44:47], s68 offen sc1 lds
    s_add_u32 s67, s67, 1024
    s_cmp_eq_u32 s67, 15360
    s_cselect_b32 s67, 0, s67
    s_add_u32 m0, s66, s67
    s_add_u32 s68, s65, s67
    buffer_load_dwordx4 v2, s[44:47], s68 offen sc1 lds
    s_add_u32 s67, s67, 1024
    s_cmp_eq_u32 s67, 15360
    s_cselect_b32 s67, 0, s67
    s_add_u32 m0, s66, s67
    s_add_u32 s68, s65, s67
    buffer_load_dwordx4 v2, s[44:47], s68 offen sc1 lds
    s_add_u32 s67, s67, 1024
    s_cmp_eq_u32 s67, 15360
    s_cselect_b32 s67, 0, s67
    s_add_u32 m0, s66, s67
    s_add_u32 s68, s65, s67
    buffer_load_dwordx4 v2, s[44:47], s68 offen sc1 lds
    s_add_u32 s67, s67, 1024
    s_cmp_eq_u32 s67, 15360
    s_cselect_b32 s67, 0, s67
    s_add_u32 m0, s66, s67
    s_add_u32 s68, s65, s67
    buffer_load_dwordx4 v2, s[44:47], s68 offen sc1 lds
    s_add_u32 s67, s67, 1024
    s_cmp_eq_u32 s67, 15360
    s_cselect_b32 s67, 0, s67
    s_add_u32 m0, s66, s67
    s_add_u32 s68, s65, s67
    buffer_load_dwordx4 v2, s[44:47], s68 offen sc1 lds
    s_add_u32 s67, s67, 1024
    s_cmp_eq_u32 s67, 15360
    s_cselect_b32 s67, 0, s67
    s_add_u32 m0, s66, s67
    s_add_u32 s68, s65, s67
    buffer_load_dwordx4 v2, s[44:47], s68 offen sc1 lds
    s_add_u32 s67, s67, 1024
    s_cmp_eq_u32 s67, 15360
    s_cselect_b32 s67, 0, s67
    s_add_u32 m0, s66, s67
    s_add_u32 s68, s65, s67
    buffer_load_dwordx4 v2, s[44:47], s68 offen sc1 lds
    s_add_u32 s67, s67, 1024
    s_cmp_eq_u32 s67, 15360
    s_cselect_b32 s67, 0, s67
    s_add_u32 m0, s66, s67
    s_add_u32 s68, s65, s67
    buffer_load_dwordx4 v2, s[44:47], s68 offen sc1 lds
    s_add_u32 s67, s67, 1024
    s_cmp_eq_u32 s67, 15360
    s_cselect_b32 s67, 0, s67
    s_add_u32 m0, s66, s67
    s_add_u32 s68, s65, s67
    buffer_load_dwordx4 v2, s[44:47], s68 offen sc1 lds
    s_add_u32 s67, s67, 1024
    s_cmp_eq_u32 s67, 15360
    s_cselect_b32 s67, 0, s67
    s_add_u32 m0, s66, s67
    s_add_u32 s68, s65, s67
    buffer_load_dwordx4 v2, s[44:47], s68 offen sc1 lds
    s_add_u32 s67, s67, 1024
    s_cmp_eq_u32 s67, 15360
    s_cselect_b32 s67, 0, s67
    s_add_u32 m0, s66, s67
    s_add_u32 s68, s65, s67
    buffer_load_dwordx4 v2, s[44:47], s68 offen sc1 lds
    s_barrier
    s_sub_u32 s72, s59, s52
    s_lshl_b32 s72, s72, 2
    s_and_b32 s73, s54, 15
    s_add_u32 s72, s72, s73
    s_lshl_b32 s72, s72, 15
    s_lshl_b32 s73, s52, 13
    s_add_u32 s72, s72, s73
    s_bfe_u32 s73, s54, 0x10002
    s_lshl_b32 s73, s73, 1
    s_add_u32 s73, s73, 2
    v_bfe_u32 v10, v1, 4, 1
    v_bfe_u32 v11, v1, 3, 1
    v_sub_u32 v11, v10, v11
    v_add_u32 v11, s73, v11
    v_and_b32 v11, 3, v11
    v_lshlrev_b32_e64 v10, 12, v10
    v_lshl_add_u32 v10, v11, 10, v10
    v_and_b32_e64 v11, 7, v1
    v_lshl_add_u32 v10, v11, 7, v10
    s_mov_b32 exec_hi, 0
    buffer_load_dword v4, v10, s[28:31], s72 offen
    s_mov_b32 exec_hi, -1
    s_waitcnt vmcnt(1)
    s_barrier
    s_cmp_eq_u32 s52, 3
    s_cbranch_scc1 skip_5012
    s_mul_i32 s72, s52, 20480
    s_add_u32 s72, s72, 0
    v_add_u32 v8, s72, v2
    v_mov_b32 v88, 0x3f803f80
    v_mov_b32 v89, 0x3f803f80
    v_mov_b32 v90, 0x3f803f80
    v_mov_b32 v91, 0x3f803f80
    ds_read_b128 v[16:19], v8 offset:0
    ds_read_b128 v[20:23], v8 offset:1024
    ds_read_b128 v[24:27], v8 offset:2048
    ds_read_b128 v[28:31], v8 offset:3072
    ds_read_b128 v[32:35], v8 offset:4096
    ds_read_b128 v[36:39], v8 offset:5120
    ds_read_b128 v[40:43], v8 offset:6144
    ds_read_b128 v[44:47], v8 offset:7168
    ds_read_b128 v[48:51], v8 offset:8192
    ds_read_b128 v[52:55], v8 offset:9216
    s_waitcnt lgkmcnt(9)
    v_mfma_f32_16x16x32_bf16 v[92:95], v[16:19], v[88:91], 0
    s_waitcnt lgkmcnt(8)
    v_mfma_f32_16x16x32_bf16 v[92:95], v[20:23], v[88:91], v[92:95]
    s_waitcnt lgkmcnt(7)
    v_mfma_f32_16x16x32_bf16 v[92:95], v[24:27], v[88:91], v[92:95]
    s_waitcnt lgkmcnt(6)
    v_mfma_f32_16x16x32_bf16 v[92:95], v[28:31], v[88:91], v[92:95]
    s_waitcnt lgkmcnt(5)
    v_mfma_f32_16x16x32_bf16 v[92:95], v[32:35], v[88:91], v[92:95]
    s_waitcnt lgkmcnt(4)
    v_mfma_f32_16x16x32_bf16 v[92:95], v[36:39], v[88:91], v[92:95]
    s_waitcnt lgkmcnt(3)
    v_mfma_f32_16x16x32_bf16 v[92:95], v[40:43], v[88:91], v[92:95]
    s_waitcnt lgkmcnt(2)
    v_mfma_f32_16x16x32_bf16 v[92:95], v[44:47], v[88:91], v[92:95]
    s_waitcnt lgkmcnt(1)
    v_mfma_f32_16x16x32_bf16 v[92:95], v[48:51], v[88:91], v[92:95]
    s_waitcnt lgkmcnt(0)
    v_mfma_f32_16x16x32_bf16 v[92:95], v[52:55], v[88:91], v[92:95]
    ds_read_b128 v[16:19], v8 offset:10240
    ds_read_b128 v[20:23], v8 offset:11264
    ds_read_b128 v[24:27], v8 offset:12288
    ds_read_b128 v[28:31], v8 offset:13312
    ds_read_b128 v[32:35], v8 offset:14336
    ds_read_b128 v[36:39], v8 offset:15360
    ds_read_b128 v[40:43], v8 offset:16384
    ds_read_b128 v[44:47], v8 offset:17408
    ds_read_b128 v[48:51], v8 offset:18432
    ds_read_b128 v[52:55], v8 offset:19456
    s_waitcnt lgkmcnt(9)
    v_mfma_f32_16x16x32_bf16 v[92:95], v[16:19], v[88:91], v[92:95]
    s_waitcnt lgkmcnt(8)
    v_mfma_f32_16x16x32_bf16 v[92:95], v[20:23], v[88:91], v[92:95]
    s_waitcnt lgkmcnt(7)
    v_mfma_f32_16x16x32_bf16 v[92:95], v[24:27], v[88:91], v[92:95]
    s_waitcnt lgkmcnt(6)
    v_mfma_f32_16x16x32_bf16 v[92:95], v[28:31], v[88:91], v[92:95]
    s_waitcnt lgkmcnt(5)
    v_mfma_f32_16x16x32_bf16 v[92:95], v[32:35], v[88:91], v[92:95]
    s_waitcnt lgkmcnt(4)
    v_mfma_f32_16x16x32_bf16 v[92:95], v[36:39], v[88:91], v[92:95]
    s_waitcnt lgkmcnt(3)
    v_mfma_f32_16x16x32_bf16 v[92:95], v[40:43], v[88:91], v[92:95]
    s_waitcnt lgkmcnt(2)
    v_mfma_f32_16x16x32_bf16 v[92:95], v[44:47], v[88:91], v[92:95]
    s_waitcnt lgkmcnt(1)
    v_mfma_f32_16x16x32_bf16 v[92:95], v[48:51], v[88:91], v[92:95]
    s_waitcnt lgkmcnt(0)
    v_mfma_f32_16x16x32_bf16 v[92:95], v[52:55], v[88:91], v[92:95]
    s_lshl_b32 s72, s52, 6
    s_add_u32 s72, s72, 160768
    v_add_u32 v8, s72, v1
    s_mov_b32 exec_lo, 0x00010001
    s_mov_b32 exec_hi, 0x00010001
    s_nop 2
    ds_write_b128 v8, v[92:95]
    s_mov_b64 exec, -1
    s_waitcnt lgkmcnt(0)
skip_5012:
    s_mul_i32 s88, s52, 14336
    s_lshl_b32 s89, s52, 13
    s_add_u32 s89, s89, 122880
    s_lshl_b32 s90, s52, 11
    s_cmp_lt_u32 s52, 2
    s_cselect_b32 s77, 0, 94208
    s_add_u32 s90, s90, s77
    s_add_u32 s90, s90, 57344
    s_barrier
    s_mul_i32 s65, s60, 61440
    s_add_u32 s65, s65, 12582912
    s_lshr_b32 s67, s54, 4
    s_lshl_b32 s67, s67, 13
    s_mul_i32 s66, s52, 15360
    s_add_u32 s65, s65, s66
    s_add_u32 s66, s66, 61440
    s_add_u32 m0, s66, s67
    s_add_u32 s68, s65, s67
    buffer_load_dwordx4 v2, s[44:47], s68 offen sc1 lds
    s_add_u32 s67, s67, 1024
    s_cmp_eq_u32 s67, 15360
    s_cselect_b32 s67, 0, s67
    s_add_u32 m0, s66, s67
    s_add_u32 s68, s65, s67
    buffer_load_dwordx4 v2, s[44:47], s68 offen sc1 lds
    s_add_u32 s67, s67, 1024
    s_cmp_eq_u32 s67, 15360
    s_cselect_b32 s67, 0, s67
    s_add_u32 m0, s66, s67
    s_add_u32 s68, s65, s67
    buffer_load_dwordx4 v2, s[44:47], s68 offen sc1 lds
    s_add_u32 s67, s67, 1024
    s_cmp_eq_u32 s67, 15360
    s_cselect_b32 s67, 0, s67
    s_add_u32 m0, s66, s67
    s_add_u32 s68, s65, s67
    buffer_load_dwordx4 v2, s[44:47], s68 offen sc1 lds
    s_add_u32 s67, s67, 1024
    s_cmp_eq_u32 s67, 15360
    s_cselect_b32 s67, 0, s67
    s_add_u32 m0, s66, s67
    s_add_u32 s68, s65, s67
    buffer_load_dwordx4 v2, s[44:47], s68 offen sc1 lds
    s_add_u32 s67, s67, 1024
    s_cmp_eq_u32 s67, 15360
    s_cselect_b32 s67, 0, s67
    s_add_u32 m0, s66, s67
    s_add_u32 s68, s65, s67
    buffer_load_dwordx4 v2, s[44:47], s68 offen sc1 lds
    s_add_u32 s67, s67, 1024
    s_cmp_eq_u32 s67, 15360
    s_cselect_b32 s67, 0, s67
    s_add_u32 m0, s66, s67
    s_add_u32 s68, s65, s67
    buffer_load_dwordx4 v2, s[44:47], s68 offen sc1 lds
    s_add_u32 s67, s67, 1024
    s_cmp_eq_u32 s67, 15360
    s_cselect_b32 s67, 0, s67
    s_add_u32 m0, s66, s67
    s_add_u32 s68, s65, s67
    buffer_load_dwordx4 v2, s[44:47], s68 offen sc1 lds
    s_add_u32 s67, s67, 1024
    s_cmp_eq_u32 s67, 15360
    s_cselect_b32 s67, 0, s67
    s_add_u32 m0, s66, s67
    s_add_u32 s68, s65, s67
    buffer_load_dwordx4 v2, s[44:47], s68 offen sc1 lds
    s_add_u32 s67, s67, 1024
    s_cmp_eq_u32 s67, 15360
    s_cselect_b32 s67, 0, s67
    s_add_u32 m0, s66, s67
    s_add_u32 s68, s65, s67
    buffer_load_dwordx4 v2, s[44:47], s68 offen sc1 lds
    s_add_u32 s67, s67, 1024
    s_cmp_eq_u32 s67, 15360
    s_cselect_b32 s67, 0, s67
    s_add_u32 m0, s66, s67
    s_add_u32 s68, s65, s67
    buffer_load_dwordx4 v2, s[44:47], s68 offen sc1 lds
    s_add_u32 s67, s67, 1024
    s_cmp_eq_u32 s67, 15360
    s_cselect_b32 s67, 0, s67
    s_add_u32 m0, s66, s67
    s_add_u32 s68, s65, s67
    buffer_load_dwordx4 v2, s[44:47], s68 offen sc1 lds
    s_add_u32 s67, s67, 1024
    s_cmp_eq_u32 s67, 15360
    s_cselect_b32 s67, 0, s67
    s_add_u32 m0, s66, s67
    s_add_u32 s68, s65, s67
    buffer_load_dwordx4 v2, s[44:47], s68 offen sc1 lds
    s_add_u32 s67, s67, 1024
    s_cmp_eq_u32 s67, 15360
    s_cselect_b32 s67, 0, s67
    s_add_u32 m0, s66, s67
    s_add_u32 s68, s65, s67
    buffer_load_dwordx4 v2, s[44:47], s68 offen sc1 lds
    s_add_u32 s67, s67, 1024
    s_cmp_eq_u32 s67, 15360
    s_cselect_b32 s67, 0, s67
    s_add_u32 m0, s66, s67
    s_add_u32 s68, s65, s67
    buffer_load_dwordx4 v2, s[44:47], s68 offen sc1 lds
    s_barrier
    s_mul_i32 s72, s52, 14336
    s_add_u32 s65, s52, 2
    s_and_b32 s65, s65, 3
    s_lshr_b32 s66, s65, 1
    s_add_u32 s66, s66, s61
    s_lshl_b32 s66, s66, 5
    s_and_b32 s65, s65, 1
    s_add_u32 s65, s65, s66
    s_lshl_b32 s65, s65, 12
    s_lshl_b32 s66, s52, 10
    s_add_u32 s65, s65, s66
    s_mov_b32 s67, s63
    s_add_u32 s68, s67, 3
    s_and_b32 s68, s68, 7
    s_lshl_b32 s68, s68, 7
    s_add_u32 s68, s68, s65
    s_add_u32 m0, s72, 0
    s_nop 0
    buffer_load_dwordx4 v12, s[28:31], s68 offen lds
    s_add_u32 m0, s72, 1024
    s_nop 0
    buffer_load_dwordx4 v13, s[28:31], s68 offen lds
    s_add_u32 s68, s67, 4
    s_and_b32 s68, s68, 7
    s_lshl_b32 s68, s68, 7
    s_add_u32 s68, s68, s65
    s_add_u32 m0, s72, 2048
    s_nop 0
    buffer_load_dwordx4 v12, s[28:31], s68 offen lds
    s_add_u32 m0, s72, 3072
    s_nop 0
    buffer_load_dwordx4 v13, s[28:31], s68 offen lds
    s_add_u32 s68, s67, 5
    s_and_b32 s68, s68, 7
    s_lshl_b32 s68, s68, 7
    s_add_u32 s68, s68, s65
    s_add_u32 m0, s72, 4096
    s_nop 0
    buffer_load_dwordx4 v12, s[28:31], s68 offen lds
    s_add_u32 m0, s72, 5120
    s_nop 0
    buffer_load_dwordx4 v13, s[28:31], s68 offen lds
    s_add_u32 s68, s67, 6
    s_and_b32 s68, s68, 7
    s_lshl_b32 s68, s68, 7
    s_add_u32 s68, s68, s65
    s_add_u32 m0, s72, 6144
    s_nop 0
    buffer_load_dwordx4 v12, s[28:31], s68 offen lds
    s_add_u32 m0, s72, 7168
    s_nop 0
    buffer_load_dwordx4 v13, s[28:31], s68 offen lds
    s_add_u32 s68, s67, 7
    s_and_b32 s68, s68, 7
    s_lshl_b32 s68, s68, 7
    s_add_u32 s68, s68, s65
    s_add_u32 m0, s72, 8192
    s_nop 0
    buffer_load_dwordx4 v12, s[28:31], s68 offen lds
    s_add_u32 m0, s72, 9216
    s_nop 0
    buffer_load_dwordx4 v13, s[28:31], s68 offen lds
    s_add_u32 s65, s52, 2
    s_and_b32 s65, s65, 3
    s_lshr_b32 s66, s65, 1
    s_add_u32 s66, s66, s61
    s_lshl_b32 s66, s66, 5
    s_and_b32 s65, s65, 1
    s_add_u32 s65, s65, s66
    s_lshl_b32 s65, s65, 12
    s_lshl_b32 s66, s52, 10
    s_add_u32 s65, s65, s66
    s_mov_b32 s67, s63
    s_add_u32 s68, s67, 1
    s_and_b32 s68, s68, 7
    s_lshl_b32 s68, s68, 7
    s_add_u32 s68, s68, s65
    s_add_u32 m0, s89, 0
    s_nop 0
    buffer_load_dwordx4 v12, s[28:31], s68 offen lds
    s_add_u32 m0, s89, 1024
    s_nop 0
    buffer_load_dwordx4 v13, s[28:31], s68 offen lds
    s_mov_b32 s87, s72
    s_waitcnt vmcnt(12)
    s_barrier
    s_mov_b32 s72, s87
    s_add_u32 s68, s67, 2
    s_and_b32 s68, s68, 7
    s_lshl_b32 s68, s68, 7
    s_add_u32 s68, s68, s65
    s_add_u32 m0, s89, 2048
    s_nop 0
    buffer_load_dwordx4 v12, s[28:31], s68 offen lds
    s_add_u32 m0, s89, 3072
    s_nop 0
    buffer_load_dwordx4 v13, s[28:31], s68 offen lds
    s_add_u32 s65, s52, 3
    s_and_b32 s65, s65, 3
    s_lshr_b32 s66, s65, 1
    s_add_u32 s66, s66, s61
    s_lshl_b32 s66, s66, 5
    s_and_b32 s65, s65, 1
    s_add_u32 s65, s65, s66
    s_lshl_b32 s65, s65, 12
    s_lshl_b32 s66, s52, 10
    s_add_u32 s65, s65, s66
    s_mov_b32 s67, s63
    s_add_u32 s68, s67, 0
    s_and_b32 s68, s68, 7
    s_lshl_b32 s68, s68, 7
    s_add_u32 s68, s68, s65
    s_add_u32 m0, s89, 4096
    s_nop 0
    buffer_load_dwordx4 v12, s[28:31], s68 offen lds
    s_add_u32 m0, s89, 5120
    s_nop 0
    buffer_load_dwordx4 v13, s[28:31], s68 offen lds
    s_add_u32 s68, s67, 1
    s_and_b32 s68, s68, 7
    s_lshl_b32 s68, s68, 7
    s_add_u32 s68, s68, s65
    s_add_u32 m0, s89, 6144
    s_nop 0
    buffer_load_dwordx4 v12, s[28:31], s68 offen lds
    s_add_u32 m0, s89, 7168
    s_nop 0
    buffer_load_dwordx4 v13, s[28:31], s68 offen lds
    s_add_u32 s68, s67, 2
    s_and_b32 s68, s68, 7
    s_lshl_b32 s68, s68, 7
    s_add_u32 s68, s68, s65
    s_add_u32 m0, s90, 0
    s_nop 0
    buffer_load_dwordx4 v12, s[28:31], s68 offen lds
    s_add_u32 m0, s90, 1024
    s_nop 0
    buffer_load_dwordx4 v13, s[28:31], s68 offen lds
    s_cmp_eq_u32 s52, 3
    s_cbranch_scc1 skip_5013
    s_mul_i32 s72, s52, 20480
    s_add_u32 s72, s72, 61440
    v_add_u32_e64 v8, s72, v2
    v_mov_b32 v88, 0x3f803f80
    v_mov_b32 v89, 0x3f803f80
    v_mov_b32 v90, 0x3f803f80
    v_mov_b32 v91, 0x3f803f80
    ds_read_b128 v[16:19], v8 offset:0
    ds_read_b128 v[20:23], v8 offset:1024
    ds_read_b128 v[24:27], v8 offset:2048
    ds_read_b128 v[28:31], v8 offset:3072
    ds_read_b128 v[32:35], v8 offset:4096
    ds_read_b128 v[36:39], v8 offset:5120
    ds_read_b128 v[40:43], v8 offset:6144
    ds_read_b128 v[44:47], v8 offset:7168
    ds_read_b128 v[48:51], v8 offset:8192
    ds_read_b128 v[52:55], v8 offset:9216
    s_waitcnt lgkmcnt(9)
    v_mfma_f32_16x16x32_bf16 v[92:95], v[16:19], v[88:91], 0
    s_waitcnt lgkmcnt(8)
    v_mfma_f32_16x16x32_bf16 v[92:95], v[20:23], v[88:91], v[92:95]
    s_waitcnt lgkmcnt(7)
    v_mfma_f32_16x16x32_bf16 v[92:95], v[24:27], v[88:91], v[92:95]
    s_waitcnt lgkmcnt(6)
    v_mfma_f32_16x16x32_bf16 v[92:95], v[28:31], v[88:91], v[92:95]
    s_waitcnt lgkmcnt(5)
    v_mfma_f32_16x16x32_bf16 v[92:95], v[32:35], v[88:91], v[92:95]
    s_waitcnt lgkmcnt(4)
    v_mfma_f32_16x16x32_bf16 v[92:95], v[36:39], v[88:91], v[92:95]
    s_waitcnt lgkmcnt(3)
    v_mfma_f32_16x16x32_bf16 v[92:95], v[40:43], v[88:91], v[92:95]
    s_waitcnt lgkmcnt(2)
    v_mfma_f32_16x16x32_bf16 v[92:95], v[44:47], v[88:91], v[92:95]
    s_waitcnt lgkmcnt(1)
    v_mfma_f32_16x16x32_bf16 v[92:95], v[48:51], v[88:91], v[92:95]
    s_waitcnt lgkmcnt(0)
    v_mfma_f32_16x16x32_bf16 v[92:95], v[52:55], v[88:91], v[92:95]
    ds_read_b128 v[16:19], v8 offset:10240
    ds_read_b128 v[20:23], v8 offset:11264
    ds_read_b128 v[24:27], v8 offset:12288
    ds_read_b128 v[28:31], v8 offset:13312
    ds_read_b128 v[32:35], v8 offset:14336
    ds_read_b128 v[36:39], v8 offset:15360
    ds_read_b128 v[40:43], v8 offset:16384
    ds_read_b128 v[44:47], v8 offset:17408
    ds_read_b128 v[48:51], v8 offset:18432
    ds_read_b128 v[52:55], v8 offset:19456
    s_waitcnt lgkmcnt(9)
    v_mfma_f32_16x16x32_bf16 v[92:95], v[16:19], v[88:91], v[92:95]
    s_waitcnt lgkmcnt(8)
    v_mfma_f32_16x16x32_bf16 v[92:95], v[20:23], v[88:91], v[92:95]
    s_waitcnt lgkmcnt(7)
    v_mfma_f32_16x16x32_bf16 v[92:95], v[24:27], v[88:91], v[92:95]
    s_waitcnt lgkmcnt(6)
    v_mfma_f32_16x16x32_bf16 v[92:95], v[28:31], v[88:91], v[92:95]
    s_waitcnt lgkmcnt(5)
    v_mfma_f32_16x16x32_bf16 v[92:95], v[32:35], v[88:91], v[92:95]
    s_waitcnt lgkmcnt(4)
    v_mfma_f32_16x16x32_bf16 v[92:95], v[36:39], v[88:91], v[92:95]
    s_waitcnt lgkmcnt(3)
    v_mfma_f32_16x16x32_bf16 v[92:95], v[40:43], v[88:91], v[92:95]
    s_waitcnt lgkmcnt(2)
    v_mfma_f32_16x16x32_bf16 v[92:95], v[44:47], v[88:91], v[92:95]
    s_waitcnt lgkmcnt(1)
    v_mfma_f32_16x16x32_bf16 v[92:95], v[48:51], v[88:91], v[92:95]
    s_waitcnt lgkmcnt(0)
    v_mfma_f32_16x16x32_bf16 v[92:95], v[52:55], v[88:91], v[92:95]
    s_lshl_b32 s72, s52, 6
    s_add_u32 s72, s72, 160960
    v_add_u32 v8, s72, v1
    s_mov_b32 exec_lo, 0x00010001
    s_mov_b32 exec_hi, 0x00010001
    s_nop 2
    ds_write_b128 v8, v[92:95]
    s_mov_b64 exec, -1
    s_waitcnt lgkmcnt(0)
skip_5013:
    s_mul_i32 s72, s52, 14336
    v_add_u32 v8, s72, v14
    v_add_u32 v9, s72, v15
    s_waitcnt vmcnt(10)
    ds_read_b128 v[112:115], v8 offset:0
    ds_read_b128 v[116:119], v9 offset:0
    ds_read_b128 v[120:123], v8 offset:2048
    ds_read_b128 v[124:127], v9 offset:2048
    ds_read_b128 v[128:131], v8 offset:4096
    ds_read_b128 v[132:135], v9 offset:4096
    ds_read_b128 v[136:139], v8 offset:6144
    ds_read_b128 v[140:143], v9 offset:6144
    ds_read_b128 v[144:147], v8 offset:8192
    ds_read_b128 v[148:151], v9 offset:8192
    s_waitcnt lgkmcnt(0)
    s_mul_i32 s72, s52, 14336
    s_add_u32 s65, s52, 3
    s_and_b32 s65, s65, 3
    s_lshr_b32 s66, s65, 1
    s_add_u32 s66, s66, s61
    s_lshl_b32 s66, s66, 5
    s_and_b32 s65, s65, 1
    s_add_u32 s65, s65, s66
    s_lshl_b32 s65, s65, 12
    s_lshl_b32 s66, s52, 10
    s_add_u32 s65, s65, s66
    s_mov_b32 s67, s63
    s_add_u32 s68, s67, 3
    s_and_b32 s68, s68, 7
    s_lshl_b32 s68, s68, 7
    s_add_u32 s68, s68, s65
    s_add_u32 m0, s72, 0
    s_nop 0
    buffer_load_dwordx4 v12, s[28:31], s68 offen lds
    s_add_u32 m0, s72, 1024
    s_nop 0
    buffer_load_dwordx4 v13, s[28:31], s68 offen lds
    s_add_u32 s68, s67, 4
    s_and_b32 s68, s68, 7
    s_lshl_b32 s68, s68, 7
    s_add_u32 s68, s68, s65
    s_add_u32 m0, s72, 2048
    s_nop 0
    buffer_load_dwordx4 v12, s[28:31], s68 offen lds
    s_add_u32 m0, s72, 3072
    s_nop 0
    buffer_load_dwordx4 v13, s[28:31], s68 offen lds
    s_add_u32 s68, s67, 5
    s_and_b32 s68, s68, 7
    s_lshl_b32 s68, s68, 7
    s_add_u32 s68, s68, s65
    s_add_u32 m0, s72, 4096
    s_nop 0
    buffer_load_dwordx4 v12, s[28:31], s68 offen lds
    s_add_u32 m0, s72, 5120
    s_nop 0
    buffer_load_dwordx4 v13, s[28:31], s68 offen lds
    s_add_u32 s68, s67, 6
    s_and_b32 s68, s68, 7
    s_lshl_b32 s68, s68, 7
    s_add_u32 s68, s68, s65
    s_add_u32 m0, s72, 6144
    s_nop 0
    buffer_load_dwordx4 v12, s[28:31], s68 offen lds
    s_add_u32 m0, s72, 7168
    s_nop 0
    buffer_load_dwordx4 v13, s[28:31], s68 offen lds
    s_add_u32 s68, s67, 7
    s_and_b32 s68, s68, 7
    s_lshl_b32 s68, s68, 7
    s_add_u32 s68, s68, s65
    s_add_u32 m0, s72, 8192
    s_nop 0
    buffer_load_dwordx4 v12, s[28:31], s68 offen lds
    s_add_u32 m0, s72, 9216
    s_nop 0
    buffer_load_dwordx4 v13, s[28:31], s68 offen lds
    s_barrier
    s_mul_i32 s72, s52, 14336
    v_add_u32 v8, s72, v14
    v_add_u32_e64 v9, s72, v15
    s_waitcnt vmcnt(0)
    ds_read_b128 v[152:155], v8 offset:0
    ds_read_b128 v[156:159], v9 offset:0
    ds_read_b128 v[160:163], v8 offset:2048
    ds_read_b128 v[164:167], v9 offset:2048
    ds_read_b128 v[168:171], v8 offset:4096
    ds_read_b128 v[172:175], v9 offset:4096
    ds_read_b128 v[176:179], v8 offset:6144
    ds_read_b128 v[180:183], v9 offset:6144
    ds_read_b128 v[184:187], v8 offset:8192
    ds_read_b128 v[188:191], v9 offset:8192
    s_waitcnt lgkmcnt(0)
    s_add_u32 s65, s52, 0
    s_and_b32 s65, s65, 3
    s_lshr_b32 s66, s65, 1
    s_add_u32 s66, s66, s61
    s_lshl_b32 s66, s66, 5
    s_and_b32 s65, s65, 1
    s_add_u32 s65, s65, s66
    s_lshl_b32 s65, s65, 12
    s_lshl_b32 s66, s52, 10
    s_add_u32 s65, s65, s66
    s_mov_b32 s67, s63
    s_add_u32 s68, s67, 0
    s_and_b32 s68, s68, 7
    s_lshl_b32 s68, s68, 7
    s_add_u32 s68, s68, s65
    s_add_u32 m0, s88, 0
    s_nop 0
    buffer_load_dwordx4 v12, s[28:31], s68 offen lds
    s_add_u32 m0, s88, 1024
    s_nop 0
    buffer_load_dwordx4 v13, s[28:31], s68 offen lds
    s_add_u32 s68, s67, 1
    s_and_b32 s68, s68, 7
    s_lshl_b32 s68, s68, 7
    s_add_u32 s68, s68, s65
    s_add_u32 m0, s88, 2048
    s_nop 0
    buffer_load_dwordx4 v12, s[28:31], s68 offen lds
    s_add_u32 m0, s88, 3072
    s_nop 0
    buffer_load_dwordx4 v13, s[28:31], s68 offen lds
    s_add_u32 s68, s67, 2
    s_and_b32 s68, s68, 7
    s_lshl_b32 s68, s68, 7
    s_add_u32 s68, s68, s65
    s_add_u32 m0, s88, 4096
    s_nop 0
    buffer_load_dwordx4 v12, s[28:31], s68 offen lds
    s_add_u32 m0, s88, 5120
    s_nop 0
    buffer_load_dwordx4 v13, s[28:31], s68 offen lds
    s_add_u32 s65, s52, 1
    s_and_b32 s65, s65, 3
    s_lshr_b32 s66, s65, 1
    s_add_u32 s66, s66, s61
    s_lshl_b32 s66, s66, 5
    s_and_b32 s65, s65, 1
    s_add_u32 s65, s65, s66
    s_lshl_b32 s65, s65, 12
    s_lshl_b32 s66, s52, 10
    s_add_u32 s65, s65, s66
    s_mov_b32 s67, s63
    s_add_u32 s68, s67, 0
    s_and_b32 s68, s68, 7
    s_lshl_b32 s68, s68, 7
    s_add_u32 s68, s68, s65
    s_add_u32 m0, s88, 6144
    s_nop 0
    buffer_load_dwordx4 v12, s[28:31], s68 offen lds
    s_add_u32 m0, s88, 7168
    s_nop 0
    buffer_load_dwordx4 v13, s[28:31], s68 offen lds
    s_add_u32 s68, s67, 1
    s_and_b32 s68, s68, 7
    s_lshl_b32 s68, s68, 7
    s_add_u32 s68, s68, s65
    s_add_u32 m0, s88, 8192
    s_nop 0
    buffer_load_dwordx4 v12, s[28:31], s68 offen lds
    s_add_u32 m0, s88, 9216
    s_nop 0
    buffer_load_dwordx4 v13, s[28:31], s68 offen lds
    s_add_u32 s68, s67, 2
    s_and_b32 s68, s68, 7
    s_lshl_b32 s68, s68, 7
    s_add_u32 s68, s68, s65
    s_add_u32 m0, s88, 10240
    s_nop 0
    buffer_load_dwordx4 v12, s[28:31], s68 offen lds
    s_add_u32 m0, s88, 11264
    s_nop 0
    buffer_load_dwordx4 v13, s[28:31], s68 offen lds
    s_add_u32 s65, s52, 2
    s_and_b32 s65, s65, 3
    s_lshr_b32 s66, s65, 1
    s_add_u32 s66, s66, s61
    s_lshl_b32 s66, s66, 5
    s_and_b32 s65, s65, 1
    s_add_u32 s65, s65, s66
    s_lshl_b32 s65, s65, 12
    s_lshl_b32 s66, s52, 10
    s_add_u32 s65, s65, s66
    s_mov_b32 s67, s63
    s_add_u32 s68, s67, 0
    s_and_b32 s68, s68, 7
    s_lshl_b32 s68, s68, 7
    s_add_u32 s68, s68, s65
    s_add_u32 m0, s88, 12288
    s_nop 0
    buffer_load_dwordx4 v12, s[28:31], s68 offen lds
    s_add_u32 m0, s88, 13312
    s_nop 0
    buffer_load_dwordx4 v13, s[28:31], s68 offen lds
    s_mul_i32 s72, s64, 24576
    s_mul_i32 s73, s62, 3072
    s_add_u32 s72, s72, s73
    s_add_u32 s72, s72, 8388608
    v_lshlrev_b32_e64 v10, 7, v1
    s_mov_b64 exec, 0xffffff
    buffer_load_dword v8, v10, s[44:47], s72 offen
    s_mov_b64 exec, -1
    s_mul_i32 s72, s62, 384
    s_lshl_b32 s73, s52, 4
    s_add_u32 s72, s72, s73
    s_lshl_b32 s72, s72, 10
    s_add_u32 s72, s72, 4718592
    s_lshl_b32 s73, s63, 1
    s_add_u32 s74, s73, 6
    s_and_b32 s74, s74, 15
    s_lshl_b32 s74, s74, 10
    s_add_u32 s80, s74, s72
    s_add_u32 s74, s73, 7
    s_and_b32 s74, s74, 15
    s_lshl_b32 s74, s74, 10
    s_add_u32 s81, s74, s72
    s_add_u32 s74, s73, 8
    s_and_b32 s74, s74, 15
    s_lshl_b32 s74, s74, 10
    s_add_u32 s82, s74, s72
    s_add_u32 s74, s73, 9
    s_and_b32 s74, s74, 15
    s_lshl_b32 s74, s74, 10
    s_add_u32 s83, s74, s72
    s_add_u32 s74, s73, 10
    s_and_b32 s74, s74, 15
    s_lshl_b32 s74, s74, 10
    s_add_u32 s84, s74, s72
    s_add_u32 s74, s73, 11
    s_and_b32 s74, s74, 15
    s_lshl_b32 s74, s74, 10
    s_add_u32 s85, s74, s72
    s_add_u32 s74, s73, 12
    s_and_b32 s74, s74, 15
    s_lshl_b32 s74, s74, 10
    s_add_u32 s86, s74, s72
    s_add_u32 s74, s73, 13
    s_and_b32 s74, s74, 15
    s_lshl_b32 s74, s74, 10
    s_add_u32 s87, s74, s72
    s_add_u32 s74, s73, 14
    s_and_b32 s74, s74, 15
    s_lshl_b32 s74, s74, 10
    s_add_u32 s88, s74, s72
    s_add_u32 s74, s73, 15
    s_and_b32 s74, s74, 15
    s_lshl_b32 s74, s74, 10
    s_add_u32 s89, s74, s72
    v_mov_b32 v3, v2
    s_add_u32 s72, s52, 0
    s_and_b32 s72, s72, 3
    s_mul_i32 s72, s72, 7168
    s_add_u32 s72, s72, 3072
    v_add_u32_e64 v4, s72, v2
    s_add_u32 s72, s52, 1
    s_and_b32 s72, s72, 3
    s_mul_i32 s72, s72, 7168
    s_add_u32 s72, s72, 4096
    v_add_u32_e64 v5, s72, v2
    s_add_u32 s72, s52, 2
    s_and_b32 s72, s72, 3
    s_mul_i32 s72, s72, 7168
    s_add_u32 s72, s72, 5120
    v_add_u32_e64 v6, s72, v2
    s_add_u32 s72, s52, 3
    s_and_b32 s72, s72, 3
    s_mul_i32 s72, s72, 7168
    s_add_u32 s72, s72, 6144
    v_add_u32 v7, s72, v2
    s_cmp_lg_u32 s52, 0
    s_cbranch_scc1 skip_5014
    s_lshl_b32 s72, s54, 7
    v_lshlrev_b32_e64 v10, 12, v1
    s_mov_b64 exec, 0xffff
    buffer_load_dword v8, v10, s[4:7], s72 offen
    s_mov_b64 exec, -1
skip_5014:
    s_waitcnt vmcnt(0)
    s_barrier
    s_cmp_lg_u32 s52, 0
    s_cbranch_scc1 skip_5015
    s_lshl_b32 s99, s62, 5
    s_lshl_b32 s72, s99, 7
    s_add_u32 s72, s72, 1474560
    v_min_u32 v11, 31, v1
    v_lshlrev_b32_e64 v11, 7, v11
    s_mov_b32 s98, 0x100000
poll_5016:
    buffer_load_dword v10, v11, s[44:47], s72 offen sc1
    s_waitcnt vmcnt(0)
    v_cmp_ne_u32 vcc, s96, v10
    s_cbranch_vccz polled_5017
    s_sub_u32 s98, s98, 1
    s_cbranch_scc0 poll_5016
polled_5017:
skip_5015:
    s_barrier
    buffer_load_dwordx4 v[16:19], v3, s[44:47], s80 offen sc1
    buffer_load_dwordx4 v[20:23], v3, s[44:47], s81 offen sc1
    buffer_load_dwordx4 v[24:27], v3, s[44:47], s82 offen sc1
    buffer_load_dwordx4 v[28:31], v3, s[44:47], s83 offen sc1
    buffer_load_dwordx4 v[32:35], v3, s[44:47], s84 offen sc1
    buffer_load_dwordx4 v[36:39], v3, s[44:47], s85 offen sc1
    s_waitcnt vmcnt(5)
    v_mfma_f32_16x16x32_bf16 v[64:67], v[16:19], a[0:3], 0
    buffer_load_dwordx4 v[40:43], v3, s[44:47], s86 offen sc1
    buffer_load_dwordx4 v[44:47], v3, s[44:47], s87 offen sc1
    buffer_load_dwordx4 v[48:51], v3, s[44:47], s88 offen sc1
    v_mfma_f32_16x16x32_bf16 v[68:71], v[16:19], a[40:43], 0
    v_mfma_f32_16x16x32_bf16 v[72:75], v[16:19], v[112:115], 0
    v_mfma_f32_16x16x32_bf16 v[76:79], v[16:19], v[152:155], 0
    s_waitcnt vmcnt(7)
    v_mfma_f32_16x16x32_bf16 v[64:67], v[20:23], a[4:7], v[64:67]
    buffer_load_dwordx4 v[52:55], v3, s[44:47], s89 offen sc1
    v_add_u32 v3, 65536, v3
    buffer_load_dwordx4 v[56:59], v3, s[44:47], s80 offen sc1
    buffer_load_dwordx4 v[60:63], v3, s[44:47], s81 offen sc1
    v_mfma_f32_16x16x32_bf16 v[68:71], v[20:23], a[44:47], v[68:71]
    v_mfma_f32_16x16x32_bf16 v[72:75], v[20:23], v[116:119], v[72:75]
    v_mfma_f32_16x16x32_bf16 v[76:79], v[20:23], v[156:159], v[76:79]
    s_waitcnt vmcnt(9)
    v_mfma_f32_16x16x32_bf16 v[64:67], v[24:27], a[8:11], v[64:67]
    buffer_load_dwordx4 v[16:19], v3, s[44:47], s82 offen sc1
    buffer_load_dwordx4 v[20:23], v3, s[44:47], s83 offen sc1
    v_mfma_f32_16x16x32_bf16 v[68:71], v[24:27], a[48:51], v[68:71]
    v_mfma_f32_16x16x32_bf16 v[72:75], v[24:27], v[120:123], v[72:75]
    v_mfma_f32_16x16x32_bf16 v[76:79], v[24:27], v[160:163], v[76:79]
    s_waitcnt vmcnt(10)
    v_mfma_f32_16x16x32_bf16 v[64:67], v[28:31], a[12:15], v[64:67]
    buffer_load_dwordx4 v[24:27], v3, s[44:47], s84 offen sc1
    v_mfma_f32_16x16x32_bf16 v[68:71], v[28:31], a[52:55], v[68:71]
    v_mfma_f32_16x16x32_bf16 v[72:75], v[28:31], v[124:127], v[72:75]
    v_mfma_f32_16x16x32_bf16 v[76:79], v[28:31], v[164:167], v[76:79]
    s_waitcnt vmcnt(10)
    v_mfma_f32_16x16x32_bf16 v[64:67], v[32:35], a[16:19], v[64:67]
    buffer_load_dwordx4 v[28:31], v3, s[44:47], s85 offen sc1
    v_mfma_f32_16x16x32_bf16 v[68:71], v[32:35], a[56:59], v[68:71]
    v_mfma_f32_16x16x32_bf16 v[72:75], v[32:35], v[128:131], v[72:75]
    v_mfma_f32_16x16x32_bf16 v[76:79], v[32:35], v[168:171], v[76:79]
    s_waitcnt vmcnt(10)
    v_mfma_f32_16x16x32_bf16 v[64:67], v[36:39], a[20:23], v[64:67]
    buffer_load_dwordx4 v[32:35], v3, s[44:47], s86 offen sc1
    v_mfma_f32_16x16x32_bf16 v[68:71], v[36:39], a[60:63], v[68:71]
    v_mfma_f32_16x16x32_bf16 v[72:75], v[36:39], v[132:135], v[72:75]
    v_mfma_f32_16x16x32_bf16 v[76:79], v[36:39], v[172:175], v[76:79]
    s_waitcnt vmcnt(10)
    v_mfma_f32_16x16x32_bf16 v[64:67], v[40:43], a[24:27], v[64:67]
    buffer_load_dwordx4 v[36:39], v3, s[44:47], s87 offen sc1
    v_mfma_f32_16x16x32_bf16 v[68:71], v[40:43], v[96:99], v[68:71]
    v_mfma_f32_16x16x32_bf16 v[72:75], v[40:43], v[136:139], v[72:75]
    v_mfma_f32_16x16x32_bf16 v[76:79], v[40:43], v[176:179], v[76:79]
    s_waitcnt vmcnt(10)
    v_mfma_f32_16x16x32_bf16 v[64:67], v[44:47], a[28:31], v[64:67]
    buffer_load_dwordx4 v[40:43], v3, s[44:47], s88 offen sc1
    v_mfma_f32_16x16x32_bf16 v[68:71], v[44:47], v[100:103], v[68:71]
    v_mfma_f32_16x16x32_bf16 v[72:75], v[44:47], v[140:143], v[72:75]
    v_mfma_f32_16x16x32_bf16 v[76:79], v[44:47], v[180:183], v[76:79]
    s_waitcnt vmcnt(10)
    v_mfma_f32_16x16x32_bf16 v[64:67], v[48:51], a[32:35], v[64:67]
    buffer_load_dwordx4 v[44:47], v3, s[44:47], s89 offen sc1
    v_mfma_f32_16x16x32_bf16 v[68:71], v[48:51], v[104:107], v[68:71]
    v_mfma_f32_16x16x32_bf16 v[72:75], v[48:51], v[144:147], v[72:75]
    v_mfma_f32_16x16x32_bf16 v[76:79], v[48:51], v[184:187], v[76:79]
    s_waitcnt vmcnt(10)
    v_mfma_f32_16x16x32_bf16 v[64:67], v[52:55], a[36:39], v[64:67]
    v_add_u32 v3, 65536, v3
    buffer_load_dwordx4 v[48:51], v3, s[44:47], s80 offen sc1
    v_mfma_f32_16x16x32_bf16 v[68:71], v[52:55], v[108:111], v[68:71]
    v_mfma_f32_16x16x32_bf16 v[72:75], v[52:55], v[148:151], v[72:75]
    v_mfma_f32_16x16x32_bf16 v[76:79], v[52:55], v[188:191], v[76:79]
    s_waitcnt vmcnt(10)
    v_mfma_f32_16x16x32_bf16 v[80:83], v[56:59], a[0:3], 0
    buffer_load_dwordx4 v[52:55], v3, s[44:47], s81 offen sc1
    v_mfma_f32_16x16x32_bf16 v[84:87], v[56:59], a[40:43], 0
    v_mfma_f32_16x16x32_bf16 v[88:91], v[56:59], v[112:115], 0
    v_mfma_f32_16x16x32_bf16 v[92:95], v[56:59], v[152:155], 0
    s_waitcnt vmcnt(10)
    v_mfma_f32_16x16x32_bf16 v[80:83], v[60:63], a[4:7], v[80:83]
    buffer_load_dwordx4 v[56:59], v3, s[44:47], s82 offen sc1
    v_mfma_f32_16x16x32_bf16 v[84:87], v[60:63], a[44:47], v[84:87]
    v_mfma_f32_16x16x32_bf16 v[88:91], v[60:63], v[116:119], v[88:91]
    v_mfma_f32_16x16x32_bf16 v[92:95], v[60:63], v[156:159], v[92:95]
    ds_write_b128 v4, v[64:67]
    ds_write_b128 v5, v[68:71]
    ds_write_b128 v6, v[72:75]
    ds_write_b128 v7, v[76:79]
    s_waitcnt vmcnt(10)
    v_mfma_f32_16x16x32_bf16 v[80:83], v[16:19], a[8:11], v[80:83]
    buffer_load_dwordx4 v[60:63], v3, s[44:47], s83 offen sc1
    v_mfma_f32_16x16x32_bf16 v[84:87], v[16:19], a[48:51], v[84:87]
    v_mfma_f32_16x16x32_bf16 v[88:91], v[16:19], v[120:123], v[88:91]
    v_mfma_f32_16x16x32_bf16 v[92:95], v[16:19], v[160:163], v[92:95]
    s_waitcnt vmcnt(10)
    v_mfma_f32_16x16x32_bf16 v[80:83], v[20:23], a[12:15], v[80:83]
    buffer_load_dwordx4 v[16:19], v3, s[44:47], s84 offen sc1
    v_mfma_f32_16x16x32_bf16 v[84:87], v[20:23], a[52:55], v[84:87]
    v_mfma_f32_16x16x32_bf16 v[88:91], v[20:23], v[124:127], v[88:91]
    v_mfma_f32_16x16x32_bf16 v[92:95], v[20:23], v[164:167], v[92:95]
    s_waitcnt vmcnt(10)
    v_mfma_f32_16x16x32_bf16 v[80:83], v[24:27], a[16:19], v[80:83]
    buffer_load_dwordx4 v[20:23], v3, s[44:47], s85 offen sc1
    v_mfma_f32_16x16x32_bf16 v[84:87], v[24:27], a[56:59], v[84:87]
    v_mfma_f32_16x16x32_bf16 v[88:91], v[24:27], v[128:131], v[88:91]
    v_mfma_f32_16x16x32_bf16 v[92:95], v[24:27], v[168:171], v[92:95]
    s_waitcnt vmcnt(10)
    v_mfma_f32_16x16x32_bf16 v[80:83], v[28:31], a[20:23], v[80:83]
    buffer_load_dwordx4 v[24:27], v3, s[44:47], s86 offen sc1
    v_mfma_f32_16x16x32_bf16 v[84:87], v[28:31], a[60:63], v[84:87]
    v_mfma_f32_16x16x32_bf16 v[88:91], v[28:31], v[132:135], v[88:91]
    v_mfma_f32_16x16x32_bf16 v[92:95], v[28:31], v[172:175], v[92:95]
    s_waitcnt vmcnt(10)
    v_mfma_f32_16x16x32_bf16 v[80:83], v[32:35], a[24:27], v[80:83]
    buffer_load_dwordx4 v[28:31], v3, s[44:47], s87 offen sc1
    v_mfma_f32_16x16x32_bf16 v[84:87], v[32:35], v[96:99], v[84:87]
    v_mfma_f32_16x16x32_bf16 v[88:91], v[32:35], v[136:139], v[88:91]
    v_mfma_f32_16x16x32_bf16 v[92:95], v[32:35], v[176:179], v[92:95]
    s_waitcnt vmcnt(10)
    v_mfma_f32_16x16x32_bf16 v[80:83], v[36:39], a[28:31], v[80:83]
    buffer_load_dwordx4 v[32:35], v3, s[44:47], s88 offen sc1
    v_mfma_f32_16x16x32_bf16 v[84:87], v[36:39], v[100:103], v[84:87]
    v_mfma_f32_16x16x32_bf16 v[88:91], v[36:39], v[140:143], v[88:91]
    v_mfma_f32_16x16x32_bf16 v[92:95], v[36:39], v[180:183], v[92:95]
    s_waitcnt vmcnt(10)
    v_mfma_f32_16x16x32_bf16 v[80:83], v[40:43], a[32:35], v[80:83]
    buffer_load_dwordx4 v[36:39], v3, s[44:47], s89 offen sc1
    v_mfma_f32_16x16x32_bf16 v[84:87], v[40:43], v[104:107], v[84:87]
    v_mfma_f32_16x16x32_bf16 v[88:91], v[40:43], v[144:147], v[88:91]
    v_mfma_f32_16x16x32_bf16 v[92:95], v[40:43], v[184:187], v[92:95]
    s_waitcnt vmcnt(10)
    v_mfma_f32_16x16x32_bf16 v[80:83], v[44:47], a[36:39], v[80:83]
    v_add_u32 v3, 65536, v3
    buffer_load_dwordx4 v[40:43], v3, s[44:47], s80 offen sc1
    v_mfma_f32_16x16x32_bf16 v[84:87], v[44:47], v[108:111], v[84:87]
    v_mfma_f32_16x16x32_bf16 v[88:91], v[44:47], v[148:151], v[88:91]
    v_mfma_f32_16x16x32_bf16 v[92:95], v[44:47], v[188:191], v[92:95]
    s_waitcnt vmcnt(10)
    v_mfma_f32_16x16x32_bf16 v[64:67], v[48:51], a[0:3], 0
    buffer_load_dwordx4 v[44:47], v3, s[44:47], s81 offen sc1
    v_mfma_f32_16x16x32_bf16 v[68:71], v[48:51], a[40:43], 0
    v_mfma_f32_16x16x32_bf16 v[72:75], v[48:51], v[112:115], 0
    v_mfma_f32_16x16x32_bf16 v[76:79], v[48:51], v[152:155], 0
    s_waitcnt vmcnt(10)
    v_mfma_f32_16x16x32_bf16 v[64:67], v[52:55], a[4:7], v[64:67]
    buffer_load_dwordx4 v[48:51], v3, s[44:47], s82 offen sc1
    v_mfma_f32_16x16x32_bf16 v[68:71], v[52:55], a[44:47], v[68:71]
    v_mfma_f32_16x16x32_bf16 v[72:75], v[52:55], v[116:119], v[72:75]
    v_mfma_f32_16x16x32_bf16 v[76:79], v[52:55], v[156:159], v[76:79]
    v_add_u32 v4, 28672, v4
    v_add_u32 v5, 28672, v5
    v_add_u32 v6, 28672, v6
    v_add_u32 v7, 28672, v7
    ds_write_b128 v4, v[80:83]
    ds_write_b128 v5, v[84:87]
    ds_write_b128 v6, v[88:91]
    ds_write_b128 v7, v[92:95]
    s_waitcnt vmcnt(10)
    v_mfma_f32_16x16x32_bf16 v[64:67], v[56:59], a[8:11], v[64:67]
    buffer_load_dwordx4 v[52:55], v3, s[44:47], s83 offen sc1
    v_mfma_f32_16x16x32_bf16 v[68:71], v[56:59], a[48:51], v[68:71]
    v_mfma_f32_16x16x32_bf16 v[72:75], v[56:59], v[120:123], v[72:75]
    v_mfma_f32_16x16x32_bf16 v[76:79], v[56:59], v[160:163], v[76:79]
    s_waitcnt vmcnt(10)
    v_mfma_f32_16x16x32_bf16 v[64:67], v[60:63], a[12:15], v[64:67]
    buffer_load_dwordx4 v[56:59], v3, s[44:47], s84 offen sc1
    v_mfma_f32_16x16x32_bf16 v[68:71], v[60:63], a[52:55], v[68:71]
    v_mfma_f32_16x16x32_bf16 v[72:75], v[60:63], v[124:127], v[72:75]
    v_mfma_f32_16x16x32_bf16 v[76:79], v[60:63], v[164:167], v[76:79]
    s_waitcnt lgkmcnt(0)
    s_barrier
    s_waitcnt vmcnt(10)
    v_mfma_f32_16x16x32_bf16 v[64:67], v[16:19], a[16:19], v[64:67]
    buffer_load_dwordx4 v[60:63], v3, s[44:47], s85 offen sc1
    v_mfma_f32_16x16x32_bf16 v[68:71], v[16:19], a[56:59], v[68:71]
    v_mfma_f32_16x16x32_bf16 v[72:75], v[16:19], v[128:131], v[72:75]
    v_mfma_f32_16x16x32_bf16 v[76:79], v[16:19], v[168:171], v[76:79]
    s_waitcnt vmcnt(10)
    v_mfma_f32_16x16x32_bf16 v[64:67], v[20:23], a[20:23], v[64:67]
    buffer_load_dwordx4 v[16:19], v3, s[44:47], s86 offen sc1
    v_mfma_f32_16x16x32_bf16 v[68:71], v[20:23], a[60:63], v[68:71]
    v_mfma_f32_16x16x32_bf16 v[72:75], v[20:23], v[132:135], v[72:75]
    v_mfma_f32_16x16x32_bf16 v[76:79], v[20:23], v[172:175], v[76:79]
    s_waitcnt vmcnt(10)
    v_mfma_f32_16x16x32_bf16 v[64:67], v[24:27], a[24:27], v[64:67]
    buffer_load_dwordx4 v[20:23], v3, s[44:47], s87 offen sc1
    v_mfma_f32_16x16x32_bf16 v[68:71], v[24:27], v[96:99], v[68:71]
    v_mfma_f32_16x16x32_bf16 v[72:75], v[24:27], v[136:139], v[72:75]
    v_mfma_f32_16x16x32_bf16 v[76:79], v[24:27], v[176:179], v[76:79]
    s_waitcnt vmcnt(10)
    v_mfma_f32_16x16x32_bf16 v[64:67], v[28:31], a[28:31], v[64:67]
    buffer_load_dwordx4 v[24:27], v3, s[44:47], s88 offen sc1
    v_mfma_f32_16x16x32_bf16 v[68:71], v[28:31], v[100:103], v[68:71]
    v_mfma_f32_16x16x32_bf16 v[72:75], v[28:31], v[140:143], v[72:75]
    v_mfma_f32_16x16x32_bf16 v[76:79], v[28:31], v[180:183], v[76:79]
    s_waitcnt vmcnt(10)
    v_mfma_f32_16x16x32_bf16 v[64:67], v[32:35], a[32:35], v[64:67]
    buffer_load_dwordx4 v[28:31], v3, s[44:47], s89 offen sc1
    v_mfma_f32_16x16x32_bf16 v[68:71], v[32:35], v[104:107], v[68:71]
    v_mfma_f32_16x16x32_bf16 v[72:75], v[32:35], v[144:147], v[72:75]
    v_mfma_f32_16x16x32_bf16 v[76:79], v[32:35], v[184:187], v[76:79]
    s_waitcnt vmcnt(10)
    v_mfma_f32_16x16x32_bf16 v[64:67], v[36:39], a[36:39], v[64:67]
    v_add_u32 v3, 65536, v3
    buffer_load_dwordx4 v[32:35], v3, s[44:47], s80 offen sc1
    v_mfma_f32_16x16x32_bf16 v[68:71], v[36:39], v[108:111], v[68:71]
    v_mfma_f32_16x16x32_bf16 v[72:75], v[36:39], v[148:151], v[72:75]
    v_mfma_f32_16x16x32_bf16 v[76:79], v[36:39], v[188:191], v[76:79]
    s_waitcnt vmcnt(10)
    v_mfma_f32_16x16x32_bf16 v[80:83], v[40:43], a[0:3], 0
    buffer_load_dwordx4 v[36:39], v3, s[44:47], s81 offen sc1
    v_mfma_f32_16x16x32_bf16 v[84:87], v[40:43], a[40:43], 0
    v_mfma_f32_16x16x32_bf16 v[88:91], v[40:43], v[112:115], 0
    v_mfma_f32_16x16x32_bf16 v[92:95], v[40:43], v[152:155], 0
    s_waitcnt vmcnt(10)
    v_mfma_f32_16x16x32_bf16 v[80:83], v[44:47], a[4:7], v[80:83]
    buffer_load_dwordx4 v[40:43], v3, s[44:47], s82 offen sc1
    v_mfma_f32_16x16x32_bf16 v[84:87], v[44:47], a[44:47], v[84:87]
    v_mfma_f32_16x16x32_bf16 v[88:91], v[44:47], v[116:119], v[88:91]
    v_mfma_f32_16x16x32_bf16 v[92:95], v[44:47], v[156:159], v[92:95]
    v_add_u32 v4, 28672, v4
    v_add_u32 v5, 28672, v5
    v_add_u32 v6, 28672, v6
    v_add_u32 v7, 28672, v7
    ds_write_b128 v4, v[64:67]
    ds_write_b128 v5, v[68:71]
    ds_write_b128 v6, v[72:75]
    ds_write_b128 v7, v[76:79]
    s_waitcnt vmcnt(10)
    v_mfma_f32_16x16x32_bf16 v[80:83], v[48:51], a[8:11], v[80:83]
    buffer_load_dwordx4 v[44:47], v3, s[44:47], s83 offen sc1
    v_mfma_f32_16x16x32_bf16 v[84:87], v[48:51], a[48:51], v[84:87]
    v_mfma_f32_16x16x32_bf16 v[88:91], v[48:51], v[120:123], v[88:91]
    v_mfma_f32_16x16x32_bf16 v[92:95], v[48:51], v[160:163], v[92:95]
    s_waitcnt vmcnt(10)
    v_mfma_f32_16x16x32_bf16 v[80:83], v[52:55], a[12:15], v[80:83]
    buffer_load_dwordx4 v[48:51], v3, s[44:47], s84 offen sc1
    v_mfma_f32_16x16x32_bf16 v[84:87], v[52:55], a[52:55], v[84:87]
    v_mfma_f32_16x16x32_bf16 v[88:91], v[52:55], v[124:127], v[88:91]
    v_mfma_f32_16x16x32_bf16 v[92:95], v[52:55], v[164:167], v[92:95]
    s_waitcnt vmcnt(10)
    v_mfma_f32_16x16x32_bf16 v[80:83], v[56:59], a[16:19], v[80:83]
    buffer_load_dwordx4 v[52:55], v3, s[44:47], s85 offen sc1
    v_mfma_f32_16x16x32_bf16 v[84:87], v[56:59], a[56:59], v[84:87]
    v_mfma_f32_16x16x32_bf16 v[88:91], v[56:59], v[128:131], v[88:91]
    v_mfma_f32_16x16x32_bf16 v[92:95], v[56:59], v[168:171], v[92:95]
    s_waitcnt vmcnt(10)
    v_mfma_f32_16x16x32_bf16 v[80:83], v[60:63], a[20:23], v[80:83]
    buffer_load_dwordx4 v[56:59], v3, s[44:47], s86 offen sc1
    v_mfma_f32_16x16x32_bf16 v[84:87], v[60:63], a[60:63], v[84:87]
    v_mfma_f32_16x16x32_bf16 v[88:91], v[60:63], v[132:135], v[88:91]
    v_mfma_f32_16x16x32_bf16 v[92:95], v[60:63], v[172:175], v[92:95]
    s_waitcnt vmcnt(10)
    v_mfma_f32_16x16x32_bf16 v[80:83], v[16:19], a[24:27], v[80:83]
    buffer_load_dwordx4 v[60:63], v3, s[44:47], s87 offen sc1
    v_mfma_f32_16x16x32_bf16 v[84:87], v[16:19], v[96:99], v[84:87]
    v_mfma_f32_16x16x32_bf16 v[88:91], v[16:19], v[136:139], v[88:91]
    v_mfma_f32_16x16x32_bf16 v[92:95], v[16:19], v[176:179], v[92:95]
    s_waitcnt vmcnt(10)
    v_mfma_f32_16x16x32_bf16 v[80:83], v[20:23], a[28:31], v[80:83]
    buffer_load_dwordx4 v[16:19], v3, s[44:47], s88 offen sc1
    v_mfma_f32_16x16x32_bf16 v[84:87], v[20:23], v[100:103], v[84:87]
    v_mfma_f32_16x16x32_bf16 v[88:91], v[20:23], v[140:143], v[88:91]
    v_mfma_f32_16x16x32_bf16 v[92:95], v[20:23], v[180:183], v[92:95]
    s_waitcnt vmcnt(10)
    v_mfma_f32_16x16x32_bf16 v[80:83], v[24:27], a[32:35], v[80:83]
    buffer_load_dwordx4 v[20:23], v3, s[44:47], s89 offen sc1
    v_mfma_f32_16x16x32_bf16 v[84:87], v[24:27], v[104:107], v[84:87]
    v_mfma_f32_16x16x32_bf16 v[88:91], v[24:27], v[144:147], v[88:91]
    v_mfma_f32_16x16x32_bf16 v[92:95], v[24:27], v[184:187], v[92:95]
    s_waitcnt vmcnt(10)
    v_mfma_f32_16x16x32_bf16 v[80:83], v[28:31], a[36:39], v[80:83]
    v_add_u32 v3, 65536, v3
    buffer_load_dwordx4 v[24:27], v3, s[44:47], s80 offen sc1
    v_mfma_f32_16x16x32_bf16 v[84:87], v[28:31], v[108:111], v[84:87]
    v_mfma_f32_16x16x32_bf16 v[88:91], v[28:31], v[148:151], v[88:91]
    v_mfma_f32_16x16x32_bf16 v[92:95], v[28:31], v[188:191], v[92:95]
    s_waitcnt vmcnt(10)
    v_mfma_f32_16x16x32_bf16 v[64:67], v[32:35], a[0:3], 0
    buffer_load_dwordx4 v[28:31], v3, s[44:47], s81 offen sc1
    v_mfma_f32_16x16x32_bf16 v[68:71], v[32:35], a[40:43], 0
    v_mfma_f32_16x16x32_bf16 v[72:75], v[32:35], v[112:115], 0
    v_mfma_f32_16x16x32_bf16 v[76:79], v[32:35], v[152:155], 0
    s_waitcnt vmcnt(10)
    v_mfma_f32_16x16x32_bf16 v[64:67], v[36:39], a[4:7], v[64:67]
    buffer_load_dwordx4 v[32:35], v3, s[44:47], s82 offen sc1
    v_mfma_f32_16x16x32_bf16 v[68:71], v[36:39], a[44:47], v[68:71]
    v_mfma_f32_16x16x32_bf16 v[72:75], v[36:39], v[116:119], v[72:75]
    v_mfma_f32_16x16x32_bf16 v[76:79], v[36:39], v[156:159], v[76:79]
    v_add_u32 v4, 28672, v4
    v_add_u32 v5, 28672, v5
    v_add_u32 v6, 28672, v6
    v_add_u32 v7, 28672, v7
    ds_write_b128 v4, v[80:83]
    ds_write_b128 v5, v[84:87]
    ds_write_b128 v6, v[88:91]
    ds_write_b128 v7, v[92:95]
    s_waitcnt vmcnt(10)
    v_mfma_f32_16x16x32_bf16 v[64:67], v[40:43], a[8:11], v[64:67]
    buffer_load_dwordx4 v[36:39], v3, s[44:47], s83 offen sc1
    v_mfma_f32_16x16x32_bf16 v[68:71], v[40:43], a[48:51], v[68:71]
    v_mfma_f32_16x16x32_bf16 v[72:75], v[40:43], v[120:123], v[72:75]
    v_mfma_f32_16x16x32_bf16 v[76:79], v[40:43], v[160:163], v[76:79]
    s_waitcnt vmcnt(10)
    v_mfma_f32_16x16x32_bf16 v[64:67], v[44:47], a[12:15], v[64:67]
    buffer_load_dwordx4 v[40:43], v3, s[44:47], s84 offen sc1
    v_mfma_f32_16x16x32_bf16 v[68:71], v[44:47], a[52:55], v[68:71]
    v_mfma_f32_16x16x32_bf16 v[72:75], v[44:47], v[124:127], v[72:75]
    v_mfma_f32_16x16x32_bf16 v[76:79], v[44:47], v[164:167], v[76:79]
    s_waitcnt lgkmcnt(0)
    s_barrier
    s_waitcnt vmcnt(10)
    v_mfma_f32_16x16x32_bf16 v[64:67], v[48:51], a[16:19], v[64:67]
    buffer_load_dwordx4 v[44:47], v3, s[44:47], s85 offen sc1
    v_mfma_f32_16x16x32_bf16 v[68:71], v[48:51], a[56:59], v[68:71]
    v_mfma_f32_16x16x32_bf16 v[72:75], v[48:51], v[128:131], v[72:75]
    v_mfma_f32_16x16x32_bf16 v[76:79], v[48:51], v[168:171], v[76:79]
    s_waitcnt vmcnt(10)
    v_mfma_f32_16x16x32_bf16 v[64:67], v[52:55], a[20:23], v[64:67]
    buffer_load_dwordx4 v[48:51], v3, s[44:47], s86 offen sc1
    v_mfma_f32_16x16x32_bf16 v[68:71], v[52:55], a[60:63], v[68:71]
    v_mfma_f32_16x16x32_bf16 v[72:75], v[52:55], v[132:135], v[72:75]
    v_mfma_f32_16x16x32_bf16 v[76:79], v[52:55], v[172:175], v[76:79]
    s_waitcnt vmcnt(10)
    v_mfma_f32_16x16x32_bf16 v[64:67], v[56:59], a[24:27], v[64:67]
    buffer_load_dwordx4 v[52:55], v3, s[44:47], s87 offen sc1
    v_mfma_f32_16x16x32_bf16 v[68:71], v[56:59], v[96:99], v[68:71]
    v_mfma_f32_16x16x32_bf16 v[72:75], v[56:59], v[136:139], v[72:75]
    v_mfma_f32_16x16x32_bf16 v[76:79], v[56:59], v[176:179], v[76:79]
    s_waitcnt vmcnt(10)
    v_mfma_f32_16x16x32_bf16 v[64:67], v[60:63], a[28:31], v[64:67]
    buffer_load_dwordx4 v[56:59], v3, s[44:47], s88 offen sc1
    v_mfma_f32_16x16x32_bf16 v[68:71], v[60:63], v[100:103], v[68:71]
    v_mfma_f32_16x16x32_bf16 v[72:75], v[60:63], v[140:143], v[72:75]
    v_mfma_f32_16x16x32_bf16 v[76:79], v[60:63], v[180:183], v[76:79]
    s_waitcnt vmcnt(10)
    v_mfma_f32_16x16x32_bf16 v[64:67], v[16:19], a[32:35], v[64:67]
    buffer_load_dwordx4 v[60:63], v3, s[44:47], s89 offen sc1
    v_mfma_f32_16x16x32_bf16 v[68:71], v[16:19], v[104:107], v[68:71]
    v_mfma_f32_16x16x32_bf16 v[72:75], v[16:19], v[144:147], v[72:75]
    v_mfma_f32_16x16x32_bf16 v[76:79], v[16:19], v[184:187], v[76:79]
    s_waitcnt vmcnt(10)
    v_mfma_f32_16x16x32_bf16 v[64:67], v[20:23], a[36:39], v[64:67]
    v_mfma_f32_16x16x32_bf16 v[68:71], v[20:23], v[108:111], v[68:71]
    v_mfma_f32_16x16x32_bf16 v[72:75], v[20:23], v[148:151], v[72:75]
    v_mfma_f32_16x16x32_bf16 v[76:79], v[20:23], v[188:191], v[76:79]
    s_waitcnt vmcnt(9)
    v_mfma_f32_16x16x32_bf16 v[80:83], v[24:27], a[0:3], 0
    v_mfma_f32_16x16x32_bf16 v[84:87], v[24:27], a[40:43], 0
    v_mfma_f32_16x16x32_bf16 v[88:91], v[24:27], v[112:115], 0
    v_mfma_f32_16x16x32_bf16 v[92:95], v[24:27], v[152:155], 0
    s_waitcnt vmcnt(8)
    v_mfma_f32_16x16x32_bf16 v[80:83], v[28:31], a[4:7], v[80:83]
    v_mfma_f32_16x16x32_bf16 v[84:87], v[28:31], a[44:47], v[84:87]
    v_mfma_f32_16x16x32_bf16 v[88:91], v[28:31], v[116:119], v[88:91]
    v_mfma_f32_16x16x32_bf16 v[92:95], v[28:31], v[156:159], v[92:95]
    v_add_u32 v4, -86016, v4
    v_add_u32 v5, -86016, v5
    v_add_u32 v6, -86016, v6
    v_add_u32 v7, -86016, v7
    ds_write_b128 v4, v[64:67]
    ds_write_b128 v5, v[68:71]
    ds_write_b128 v6, v[72:75]
    ds_write_b128 v7, v[76:79]
    s_waitcnt vmcnt(7)
    v_mfma_f32_16x16x32_bf16 v[80:83], v[32:35], a[8:11], v[80:83]
    v_mfma_f32_16x16x32_bf16 v[84:87], v[32:35], a[48:51], v[84:87]
    v_mfma_f32_16x16x32_bf16 v[88:91], v[32:35], v[120:123], v[88:91]
    v_mfma_f32_16x16x32_bf16 v[92:95], v[32:35], v[160:163], v[92:95]
    s_waitcnt vmcnt(6)
    v_mfma_f32_16x16x32_bf16 v[80:83], v[36:39], a[12:15], v[80:83]
    v_mfma_f32_16x16x32_bf16 v[84:87], v[36:39], a[52:55], v[84:87]
    v_mfma_f32_16x16x32_bf16 v[88:91], v[36:39], v[124:127], v[88:91]
    v_mfma_f32_16x16x32_bf16 v[92:95], v[36:39], v[164:167], v[92:95]
    s_waitcnt lgkmcnt(0)
    s_barrier
    s_waitcnt vmcnt(5)
    v_mfma_f32_16x16x32_bf16 v[80:83], v[40:43], a[16:19], v[80:83]
    v_mfma_f32_16x16x32_bf16 v[84:87], v[40:43], a[56:59], v[84:87]
    v_mfma_f32_16x16x32_bf16 v[88:91], v[40:43], v[128:131], v[88:91]
    v_mfma_f32_16x16x32_bf16 v[92:95], v[40:43], v[168:171], v[92:95]
    s_waitcnt vmcnt(4)
    v_mfma_f32_16x16x32_bf16 v[80:83], v[44:47], a[20:23], v[80:83]
    v_mfma_f32_16x16x32_bf16 v[84:87], v[44:47], a[60:63], v[84:87]
    v_mfma_f32_16x16x32_bf16 v[88:91], v[44:47], v[132:135], v[88:91]
    v_mfma_f32_16x16x32_bf16 v[92:95], v[44:47], v[172:175], v[92:95]
    s_waitcnt vmcnt(3)
    v_mfma_f32_16x16x32_bf16 v[80:83], v[48:51], a[24:27], v[80:83]
    v_mfma_f32_16x16x32_bf16 v[84:87], v[48:51], v[96:99], v[84:87]
    v_mfma_f32_16x16x32_bf16 v[88:91], v[48:51], v[136:139], v[88:91]
    v_mfma_f32_16x16x32_bf16 v[92:95], v[48:51], v[176:179], v[92:95]
    s_waitcnt vmcnt(2)
    v_mfma_f32_16x16x32_bf16 v[80:83], v[52:55], a[28:31], v[80:83]
    v_mfma_f32_16x16x32_bf16 v[84:87], v[52:55], v[100:103], v[84:87]
    v_mfma_f32_16x16x32_bf16 v[88:91], v[52:55], v[140:143], v[88:91]
    v_mfma_f32_16x16x32_bf16 v[92:95], v[52:55], v[180:183], v[92:95]
    s_waitcnt vmcnt(1)
    v_mfma_f32_16x16x32_bf16 v[80:83], v[56:59], a[32:35], v[80:83]
    v_mfma_f32_16x16x32_bf16 v[84:87], v[56:59], v[104:107], v[84:87]
    v_mfma_f32_16x16x32_bf16 v[88:91], v[56:59], v[144:147], v[88:91]
    v_mfma_f32_16x16x32_bf16 v[92:95], v[56:59], v[184:187], v[92:95]
    s_waitcnt vmcnt(0)
    v_mfma_f32_16x16x32_bf16 v[80:83], v[60:63], a[36:39], v[80:83]
    v_mfma_f32_16x16x32_bf16 v[84:87], v[60:63], v[108:111], v[84:87]
    v_mfma_f32_16x16x32_bf16 v[88:91], v[60:63], v[148:151], v[88:91]
    v_mfma_f32_16x16x32_bf16 v[92:95], v[60:63], v[188:191], v[92:95]
    v_add_u32 v4, 122880, v4
    v_add_u32 v5, 122880, v5
    v_add_u32 v6, 122880, v6
    v_add_u32 v7, 122880, v7
    s_nop 0
    ds_write_b128 v4, v[80:83]
    ds_write_b128 v5, v[84:87]
    ds_write_b128 v6, v[88:91]
    ds_write_b128 v7, v[92:95]
    s_waitcnt lgkmcnt(0)
    s_barrier
    s_setprio 0
    s_sub_u32 s76, s59, s52
    s_lshr_b32 s63, s54, 3
    s_and_b32 s62, s63, 1
    s_lshl_b32 s62, s62, 1
    s_add_u32 s76, s76, s62
    s_lshl_b32 s76, s76, 1
    s_add_u32 s76, s76, s52
    s_and_b32 s62, s54, 7
    s_mul_i32 s65, s62, 122880
    s_add_u32 s65, s65, 14680064
    s_lshl_b32 s67, s63, 12
    s_mul_i32 s66, s52, 15360
    s_add_u32 s65, s65, s66
    s_add_u32 m0, s66, s67
    s_add_u32 s68, s65, s67
    buffer_load_dwordx4 v2, s[44:47], s68 offen sc1 lds
    s_add_u32 s67, s67, 1024
    s_cmp_eq_u32 s67, 15360
    s_cselect_b32 s67, 0, s67
    s_add_u32 m0, s66, s67
    s_add_u32 s68, s65, s67
    buffer_load_dwordx4 v2, s[44:47], s68 offen sc1 lds
    s_add_u32 s67, s67, 1024
    s_cmp_eq_u32 s67, 15360
    s_cselect_b32 s67, 0, s67
    s_add_u32 m0, s66, s67
    s_add_u32 s68, s65, s67
    buffer_load_dwordx4 v2, s[44:47], s68 offen sc1 lds
    s_add_u32 s67, s67, 1024
    s_cmp_eq_u32 s67, 15360
    s_cselect_b32 s67, 0, s67
    s_add_u32 m0, s66, s67
    s_add_u32 s68, s65, s67
    buffer_load_dwordx4 v2, s[44:47], s68 offen sc1 lds
    s_add_u32 s67, s67, 1024
    s_cmp_eq_u32 s67, 15360
    s_cselect_b32 s67, 0, s67
    s_add_u32 m0, s66, s67
    s_add_u32 s68, s65, s67
    buffer_load_dwordx4 v2, s[44:47], s68 offen sc1 lds
    s_add_u32 s67, s67, 1024
    s_cmp_eq_u32 s67, 15360
    s_cselect_b32 s67, 0, s67
    s_add_u32 m0, s66, s67
    s_add_u32 s68, s65, s67
    buffer_load_dwordx4 v2, s[44:47], s68 offen sc1 lds
    s_add_u32 s67, s67, 1024
    s_cmp_eq_u32 s67, 15360
    s_cselect_b32 s67, 0, s67
    s_add_u32 m0, s66, s67
    s_add_u32 s68, s65, s67
    buffer_load_dwordx4 v2, s[44:47], s68 offen sc1 lds
    s_add_u32 s67, s67, 1024
    s_cmp_eq_u32 s67, 15360
    s_cselect_b32 s67, 0, s67
    s_add_u32 m0, s66, s67
    s_add_u32 s68, s65, s67
    buffer_load_dwordx4 v2, s[44:47], s68 offen sc1 lds
    s_add_u32 s67, s67, 1024
    s_cmp_eq_u32 s67, 15360
    s_cselect_b32 s67, 0, s67
    s_add_u32 m0, s66, s67
    s_add_u32 s68, s65, s67
    buffer_load_dwordx4 v2, s[44:47], s68 offen sc1 lds
    s_add_u32 s67, s67, 1024
    s_cmp_eq_u32 s67, 15360
    s_cselect_b32 s67, 0, s67
    s_add_u32 m0, s66, s67
    s_add_u32 s68, s65, s67
    buffer_load_dwordx4 v2, s[44:47], s68 offen sc1 lds
    s_add_u32 s67, s67, 1024
    s_cmp_eq_u32 s67, 15360
    s_cselect_b32 s67, 0, s67
    s_add_u32 m0, s66, s67
    s_add_u32 s68, s65, s67
    buffer_load_dwordx4 v2, s[44:47], s68 offen sc1 lds
    s_add_u32 s67, s67, 1024
    s_cmp_eq_u32 s67, 15360
    s_cselect_b32 s67, 0, s67
    s_add_u32 m0, s66, s67
    s_add_u32 s68, s65, s67
    buffer_load_dwordx4 v2, s[44:47], s68 offen sc1 lds
    s_add_u32 s67, s67, 1024
    s_cmp_eq_u32 s67, 15360
    s_cselect_b32 s67, 0, s67
    s_add_u32 m0, s66, s67
    s_add_u32 s68, s65, s67
    buffer_load_dwordx4 v2, s[44:47], s68 offen sc1 lds
    s_add_u32 s67, s67, 1024
    s_cmp_eq_u32 s67, 15360
    s_cselect_b32 s67, 0, s67
    s_add_u32 m0, s66, s67
    s_add_u32 s68, s65, s67
    buffer_load_dwordx4 v2, s[44:47], s68 offen sc1 lds
    s_add_u32 s67, s67, 1024
    s_cmp_eq_u32 s67, 15360
    s_cselect_b32 s67, 0, s67
    s_add_u32 m0, s66, s67
    s_add_u32 s68, s65, s67
    buffer_load_dwordx4 v2, s[44:47], s68 offen sc1 lds
    s_mul_i32 s65, s62, 122880
    s_add_u32 s65, s65, 14741504
    s_lshl_b32 s67, s63, 12
    s_mul_i32 s66, s52, 15360
    s_add_u32 s65, s65, s66
    s_add_u32 s66, s66, 61440
    s_add_u32 m0, s66, s67
    s_add_u32 s68, s65, s67
    buffer_load_dwordx4 v2, s[44:47], s68 offen sc1 lds
    s_add_u32 s67, s67, 1024
    s_cmp_eq_u32 s67, 15360
    s_cselect_b32 s67, 0, s67
    s_add_u32 m0, s66, s67
    s_add_u32 s68, s65, s67
    buffer_load_dwordx4 v2, s[44:47], s68 offen sc1 lds
    s_add_u32 s67, s67, 1024
    s_cmp_eq_u32 s67, 15360
    s_cselect_b32 s67, 0, s67
    s_add_u32 m0, s66, s67
    s_add_u32 s68, s65, s67
    buffer_load_dwordx4 v2, s[44:47], s68 offen sc1 lds
    s_add_u32 s67, s67, 1024
    s_cmp_eq_u32 s67, 15360
    s_cselect_b32 s67, 0, s67
    s_add_u32 m0, s66, s67
    s_add_u32 s68, s65, s67
    buffer_load_dwordx4 v2, s[44:47], s68 offen sc1 lds
    s_add_u32 s67, s67, 1024
    s_cmp_eq_u32 s67, 15360
    s_cselect_b32 s67, 0, s67
    s_add_u32 m0, s66, s67
    s_add_u32 s68, s65, s67
    buffer_load_dwordx4 v2, s[44:47], s68 offen sc1 lds
    s_add_u32 s67, s67, 1024
    s_cmp_eq_u32 s67, 15360
    s_cselect_b32 s67, 0, s67
    s_add_u32 m0, s66, s67
    s_add_u32 s68, s65, s67
    buffer_load_dwordx4 v2, s[44:47], s68 offen sc1 lds
    s_add_u32 s67, s67, 1024
    s_cmp_eq_u32 s67, 15360
    s_cselect_b32 s67, 0, s67
    s_add_u32 m0, s66, s67
    s_add_u32 s68, s65, s67
    buffer_load_dwordx4 v2, s[44:47], s68 offen sc1 lds
    s_add_u32 s67, s67, 1024
    s_cmp_eq_u32 s67, 15360
    s_cselect_b32 s67, 0, s67
    s_add_u32 m0, s66, s67
    s_add_u32 s68, s65, s67
    buffer_load_dwordx4 v2, s[44:47], s68 offen sc1 lds
    s_add_u32 s67, s67, 1024
    s_cmp_eq_u32 s67, 15360
    s_cselect_b32 s67, 0, s67
    s_add_u32 m0, s66, s67
    s_add_u32 s68, s65, s67
    buffer_load_dwordx4 v2, s[44:47], s68 offen sc1 lds
    s_add_u32 s67, s67, 1024
    s_cmp_eq_u32 s67, 15360
    s_cselect_b32 s67, 0, s67
    s_add_u32 m0, s66, s67
    s_add_u32 s68, s65, s67
    buffer_load_dwordx4 v2, s[44:47], s68 offen sc1 lds
    s_add_u32 s67, s67, 1024
    s_cmp_eq_u32 s67, 15360
    s_cselect_b32 s67, 0, s67
    s_add_u32 m0, s66, s67
    s_add_u32 s68, s65, s67
    buffer_load_dwordx4 v2, s[44:47], s68 offen sc1 lds
    s_add_u32 s67, s67, 1024
    s_cmp_eq_u32 s67, 15360
    s_cselect_b32 s67, 0, s67
    s_add_u32 m0, s66, s67
    s_add_u32 s68, s65, s67
    buffer_load_dwordx4 v2, s[44:47], s68 offen sc1 lds
    s_add_u32 s67, s67, 1024
    s_cmp_eq_u32 s67, 15360
    s_cselect_b32 s67, 0, s67
    s_add_u32 m0, s66, s67
    s_add_u32 s68, s65, s67
    buffer_load_dwordx4 v2, s[44:47], s68 offen sc1 lds
    s_add_u32 s67, s67, 1024
    s_cmp_eq_u32 s67, 15360
    s_cselect_b32 s67, 0, s67
    s_add_u32 m0, s66, s67
    s_add_u32 s68, s65, s67
    buffer_load_dwordx4 v2, s[44:47], s68 offen sc1 lds
    s_add_u32 s67, s67, 1024
    s_cmp_eq_u32 s67, 15360
    s_cselect_b32 s67, 0, s67
    s_add_u32 m0, s66, s67
    s_add_u32 s68, s65, s67
    buffer_load_dwordx4 v2, s[44:47], s68 offen sc1 lds
    s_waitcnt vmcnt(15)
    s_barrier
    s_waitcnt vmcnt(0)
    s_barrier
    s_endpgm
CODE_END:
.set CODE_BYTES, CODE_END - sequential_preLN__spectral_fnet__mixer_gmlp__prompt_kernel - 128
.section .rodata,"a"
.p2align 6
.amdhsa_kernel sequential_preLN__spectral_fnet__mixer_gmlp__prompt_kernel
  .amdhsa_next_free_vgpr 256
  .amdhsa_next_free_sgpr 102
  .amdhsa_accum_offset 192
  .amdhsa_group_segment_fixed_size 0
  .amdhsa_kernarg_size 104
  .amdhsa_user_sgpr_count 2
  .amdhsa_user_sgpr_kernarg_segment_ptr 1
  .amdhsa_system_sgpr_workgroup_id_x 1
.end_amdhsa_kernel
```
